```python
import torch

def _softmax(x, axis=-1):
    return torch.softmax(x, dim=axis)
def _gelu(x):
    return torch.nn.functional.gelu(x, approximate="tanh")
def _silu(x):
    return torch.nn.functional.silu(x)
def _sigmoid(x):
    return torch.sigmoid(x)
def _layernorm(x, axis=-1, eps=1e-5):
    m = x.mean(dim=axis, keepdim=True)
    v = x.var(dim=axis, keepdim=True, unbiased=False)
    return (x - m) / torch.sqrt(v + eps)
def _scatter_add(tgt, idx, src, axis=0):
    return tgt.clone().index_add_(axis, idx, src)
def _segment_sum(src, seg, n):
    out = torch.zeros((n,) + src.shape[1:], dtype=src.dtype)
    return out.index_add_(0, seg, src)
def _pad(x, pw):
    flat = tuple(v for pair in reversed(pw) for v in pair)
    return torch.nn.functional.pad(x, flat)

kernel_name = 'parallel_sum__grouped_kv_mqa__glu_gated_swiglu__prompt'

def setup_inputs():

    _w = (lambda a: (lambda t: t.to(torch.bfloat16) if t.is_floating_point() else t)(torch.as_tensor(a)))
    def _A_setup():
        B, S, D, H = 1, 2048, 576, 32
        Dh = D // H
        return {
            "x": _w((lambda *s: torch.randn(*s, dtype=torch.bfloat16) * 0.05)(B, S, D)),
            "wq": _w((lambda *s: torch.randn(*s, dtype=torch.bfloat16) * 0.05)(D, H * Dh)),
            "wk": _w((lambda *s: torch.randn(*s, dtype=torch.bfloat16) * 0.05)(D, Dh)),
            "wv": _w((lambda *s: torch.randn(*s, dtype=torch.bfloat16) * 0.05)(D, Dh)),
            "wo": _w((lambda *s: torch.randn(*s, dtype=torch.bfloat16) * 0.05)(H * Dh, D)),
        }
    _A_in = _A_setup()

    def _B_setup():
        B, S, D, F = 1, 2048, 576, 4608
        return {
            "x": _w((lambda *s: torch.randn(*s, dtype=torch.bfloat16) * 0.05)(B, S, D)),
            "w1": _w((lambda *s: torch.randn(*s, dtype=torch.bfloat16) * 0.4)(D, F) * (2.0 / D) ** 0.5),
            "w3": _w((lambda *s: torch.randn(*s, dtype=torch.bfloat16) * 0.4)(D, F) * (2.0 / D) ** 0.5),
            "w2": _w((lambda *s: torch.randn(*s, dtype=torch.bfloat16) * 0.4)(F, D) * (2.0 / F) ** 0.5),
        }
    _B_in = _B_setup()

    return {
        "A_x": _A_in["x"],
        "A_wq": _A_in["wq"],
        "A_wk": _A_in["wk"],
        "A_wv": _A_in["wv"],
        "A_wo": _A_in["wo"],
        "B_x": _B_in["x"],
        "B_w1": _B_in["w1"],
        "B_w3": _B_in["w3"],
        "B_w2": _B_in["w2"],
    }

def reference(A_x, A_wq, A_wk, A_wv, A_wo, B_x, B_w1, B_w3, B_w2):
    def _A_ref(x, wq, wk, wv, wo):
        B, S, D = x.shape
        H = 32
        Dh = D // H
        q = (lambda x, *d: x.permute(*d))((x @ wq).reshape(B, S, H, Dh), 0, 2, 1, 3)
        k = x @ wk
        v = x @ wv
        scores = torch.einsum("bhqd,bkd->bhqk", q, k) * (Dh ** -0.5)
        p = _softmax(scores, axis=-1)
        o = torch.einsum("bhqk,bkd->bhqd", p, v)
        return (lambda x, *d: x.permute(*d))(o, 0, 2, 1, 3).reshape(B, S, H * Dh) @ wo

    def _B_ref(x, w1, w3, w2):
        gate = torch.einsum("bsd,df->bsf", x, w1)
        up = torch.einsum("bsd,df->bsf", x, w3)
        h = _silu(gate) * up
        out = torch.einsum("bsf,fd->bsd", h, w2)
        return out

    x = A_x
    xn = _layernorm(x, axis=-1)
    return x + _A_ref(xn, A_wq, A_wk, A_wv, A_wo) + _B_ref(xn, B_w1, B_w3, B_w2)
```

```asm
; @launch grid=(256,1,1) block=(512,1,1) lds=161536
.amdgcn_target "amdgcn-amd-amdhsa--gfx950"
.text
.globl parallel_sum__grouped_kv_mqa__glu_gated_swiglu__prompt_kernel
.p2align 8
.type parallel_sum__grouped_kv_mqa__glu_gated_swiglu__prompt_kernel,@function
parallel_sum__grouped_kv_mqa__glu_gated_swiglu__prompt_kernel:
    s_cmp_ge_u32 s2, 256
    s_cbranch_scc1 L_end
    s_load_dwordx8 s[56:63], s[0:1], 0
    s_load_dwordx4 s[64:67], s[0:1], 48
    s_load_dwordx2 s[68:69], s[0:1], 64
    s_load_dwordx4 s[72:75], s[0:1], 80
    v_lshrrev_b32 v9, 6, v0
    v_and_b32 v0, 63, v0
    v_readfirstlane_b32 s3, v9
    s_getpc_b64 s[40:41]
L_pc:
    s_lshr_b32 s42, s2, 3
    s_lshl_b32 s42, s42, 3
    s_add_u32 s42, s42, s3
    s_and_b32 s42, s42, 63
    s_min_u32 s42, s42, ((L_end - L_pc) >> 10) - 1
    s_lshl_b32 s42, s42, 10
    v_lshl_add_u32 v132, v0, 4, s42
    global_load_dwordx4 v[136:139], v132, s[40:41]
    s_waitcnt lgkmcnt(0)
    s_mov_b32 s28, s56
    s_mov_b32 s29, s57
    s_mov_b32 s30, 2359296
    s_mov_b32 s31, 0x00020000
    s_lshl_b32 s50, s2, 3
    s_add_u32 s50, s50, s3
    s_mul_i32 s51, s50, 1152
    v_lshlrev_b32 v195, 4, v0
    v_cmp_gt_u32 s[52:53], 8, v0
    v_mov_b32 v205, 1073741824
    v_add_u32 v204, 1024, v195
    v_cndmask_b32 v204, v205, v204, s[52:53]
    buffer_load_dwordx4 v[196:199], v195, s[28:31], s51 offen
    buffer_load_dwordx4 v[200:203], v204, s[28:31], s51 offen
    s_mov_b32 s24, s74
    s_mov_b32 s25, s75
    s_mov_b32 s26, 268435456
    s_mov_b32 s27, 0x00020000
    s_mov_b32 s20, s72
    s_mov_b32 s21, s73
    s_mov_b32 s22, 256
    s_mov_b32 s23, 0x00020000
    s_or_b32 s55, s2, s3
    s_cmp_lg_u32 s55, 0
    s_cbranch_scc1 L_tok
    s_memrealtime s[98:99]
    v_mov_b32 v114, 0
    s_waitcnt lgkmcnt(0)
    s_or_b32 s98, s98, 1
    v_mov_b32 v112, s98
    v_mov_b32 v113, s99
    s_mov_b64 exec, 1
    buffer_store_dwordx2 v[112:113], v114, s[20:23], 0 offen sc1
    s_mov_b64 exec, -1
L_tok:
    s_lshr_b32 s5, s2, 3
    s_and_b32 s70, s2, 7
    s_and_b32 s4, s5, 3
    s_and_b32 s72, s70, 1
    s_lshl_b32 s72, s72, 2
    s_add_u32 s4, s4, s72
    s_lshr_b32 s5, s5, 2
    s_lshr_b32 s70, s70, 1
    s_lshl_b32 s70, s70, 3
    s_add_u32 s5, s5, s70
    s_lshl_b32 s100, s4, 5
    s_add_u32 s100, s100, s5
    s_lshl_b32 s6, s3, 10
    s_cmp_ge_u32 s3, 4
    s_cselect_b32 s76, 32, 0
    s_add_u32 s76, s76, s6
    s_add_u32 s7, s6, 8256
    s_lshl_b32 s71, s4, 3
    s_add_u32 s71, s71, s3
    s_mul_i32 s39, s71, 36864
    s_and_b32 s80, s5, 7
    s_mul_i32 s80, s80, 1
    s_and_b32 s81, s4, 3
    s_mul_i32 s81, s81, 2
    s_add_u32 s80, s80, s81
    s_cmp_ge_u32 s80, 9
    s_cselect_b32 s81, 9, 0
    s_sub_u32 s80, s80, s81
    s_cmp_ge_u32 s80, 9
    s_cselect_b32 s81, 9, 0
    s_sub_u32 s80, s80, s81
    s_add_u32 s81, s80, 1
    s_cmp_eq_u32 s81, 9
    s_cselect_b32 s81, 0, s81
    s_add_u32 s82, s81, 1
    s_cmp_eq_u32 s82, 9
    s_cselect_b32 s82, 0, s82
    s_add_u32 s83, s82, 1
    s_cmp_eq_u32 s83, 9
    s_cselect_b32 s83, 0, s83
    s_add_u32 s84, s83, 1
    s_cmp_eq_u32 s84, 9
    s_cselect_b32 s84, 0, s84
    s_add_u32 s85, s84, 1
    s_cmp_eq_u32 s85, 9
    s_cselect_b32 s85, 0, s85
    s_add_u32 s86, s85, 1
    s_cmp_eq_u32 s86, 9
    s_cselect_b32 s86, 0, s86
    s_add_u32 s87, s86, 1
    s_cmp_eq_u32 s87, 9
    s_cselect_b32 s87, 0, s87
    s_add_u32 s88, s87, 1
    s_cmp_eq_u32 s88, 9
    s_cselect_b32 s88, 0, s88
    v_lshrrev_b32 v20, 3, v0
    s_lshl_b32 s72, s3, 3
    v_add_u32 v20, s72, v20
    v_bfe_u32 v21, v0, 4, 1
    v_lshlrev_b32 v21, 1, v21
    v_and_b32 v22, 7, v0
    v_xor_b32 v21, v21, v22
    v_lshlrev_b32 v21, 4, v21
    v_lshrrev_b32 v22, 2, v0
    s_and_b32 s72, s3, 3
    s_lshl_b32 s72, s72, 4
    v_add_u32 v22, s72, v22
    v_and_b32 v23, 3, v0
    v_lshlrev_b32 v23, 4, v23
    s_cmp_ge_u32 s5, 29
    s_cbranch_scc1 L_su_q
    s_mov_b32 s8, s64
    s_mov_b32 s9, s65
    s_mov_b32 s10, 5308416
    s_mov_b32 s11, 0x00020000
    s_mov_b32 s12, s66
    s_mov_b32 s13, s67
    s_mov_b32 s14, 5308416
    s_mov_b32 s15, 0x00020000
    s_lshl_b32 s32, s5, 7
    s_mov_b32 s33, s32
    s_mov_b32 s37, 589824
    s_mov_b32 s38, 589824
    v_mul_u32_u24 v1, 9216, v20
    v_add_u32 v1, v1, v21
    v_mov_b32 v9, v1
    s_branch L_su_d
L_su_q:
    s_mov_b32 s12, s58
    s_mov_b32 s13, s59
    s_mov_b32 s14, 663552
    s_mov_b32 s15, 0x00020000
    s_mov_b32 s38, 73728
    s_cmp_eq_u32 s5, 31
    s_cbranch_scc1 L_su_kv
    s_mov_b32 s8, s58
    s_mov_b32 s9, s59
    s_mov_b32 s10, 663552
    s_mov_b32 s11, 0x00020000
    s_sub_u32 s32, s5, 29
    s_lshl_b32 s32, s32, 9
    s_add_u32 s33, s32, 128
    s_mov_b32 s37, 73728
    v_mul_u32_u24 v1, 1152, v20
    v_add_u32 v1, v1, v21
    v_mov_b32 v9, v1
    s_branch L_su_d
L_su_kv:
    s_cmp_ge_u32 s3, 4
    s_cselect_b32 s8, s62, s60
    s_cselect_b32 s9, s63, s61
    s_cselect_b32 s33, 64, 0
    s_mov_b32 s10, 20736
    s_mov_b32 s11, 0x00020000
    s_add_u32 s33, s33, 1024
    s_mov_b32 s32, 0
    s_mov_b32 s37, 2304
    s_mov_b32 s6, s76
    s_add_u32 s7, s76, 8224
    v_mul_u32_u24 v1, 36, v22
    v_add_u32 v1, v1, v23
    v_mul_u32_u24 v9, 1152, v22
    v_add_u32 v9, v9, v23
L_su_d:
    s_mul_i32 s78, s80, s37
    s_add_u32 m0, s6, 0
    s_add_u32 s79, s78, s32
    buffer_load_dwordx4 v1, s[8:11], s79 offen lds
    s_mul_i32 s78, s80, s38
    s_add_u32 m0, s7, 0
    s_add_u32 s79, s78, s33
    buffer_load_dwordx4 v9, s[12:15], s79 offen lds
    s_mul_i32 s78, s81, s37
    s_add_u32 m0, s6, 16448
    s_add_u32 s79, s78, s32
    buffer_load_dwordx4 v1, s[8:11], s79 offen lds
    s_mul_i32 s78, s81, s38
    s_add_u32 m0, s7, 16448
    s_add_u32 s79, s78, s33
    buffer_load_dwordx4 v9, s[12:15], s79 offen lds
    s_mul_i32 s78, s82, s37
    s_add_u32 m0, s6, 32896
    s_add_u32 s79, s78, s32
    buffer_load_dwordx4 v1, s[8:11], s79 offen lds
    s_mul_i32 s78, s82, s38
    s_add_u32 m0, s7, 32896
    s_add_u32 s79, s78, s33
    buffer_load_dwordx4 v9, s[12:15], s79 offen lds
    v_lshlrev_b32 v206, 7, v0
    s_lshl_b32 s54, s3, 4
    s_add_u32 s54, s54, 131584
    v_add_u32 v206, s54, v206
    s_lshl_b32 s54, s3, 10
    s_add_u32 s54, s54, 131584
    v_add_u32 v207, s54, v195
    v_lshrrev_b32 v228, 3, v0
    v_lshlrev_b32 v228, 9, v228
    v_and_b32 v229, 7, v0
    v_lshl_add_u32 v228, v229, 4, v228
    s_lshr_b32 s51, s2, 2
    s_mul_i32 s51, s51, 36864
    s_and_b32 s54, s2, 3
    s_lshl_b32 s54, s54, 7
    s_add_u32 s51, s51, s54
    s_lshl_b32 s54, s3, 12
    s_add_u32 s50, s51, s54
    s_waitcnt vmcnt(6)
    v_lshlrev_b32 v208, 16, v196
    v_and_b32 v209, 0xffff0000, v196
    v_lshlrev_b32 v210, 16, v197
    v_and_b32 v211, 0xffff0000, v197
    v_lshlrev_b32 v212, 16, v198
    v_and_b32 v213, 0xffff0000, v198
    v_lshlrev_b32 v214, 16, v199
    v_and_b32 v215, 0xffff0000, v199
    v_lshlrev_b32 v216, 16, v200
    v_and_b32 v217, 0xffff0000, v200
    v_lshlrev_b32 v218, 16, v201
    v_and_b32 v219, 0xffff0000, v201
    v_lshlrev_b32 v220, 16, v202
    v_and_b32 v221, 0xffff0000, v202
    v_lshlrev_b32 v222, 16, v203
    v_and_b32 v223, 0xffff0000, v203
    v_add_f32 v224, v208, v209
    v_add_f32 v225, v210, v211
    v_add_f32 v224, v224, v212
    v_add_f32 v225, v225, v213
    v_add_f32 v224, v224, v214
    v_add_f32 v225, v225, v215
    v_add_f32 v224, v224, v216
    v_add_f32 v225, v225, v217
    v_add_f32 v224, v224, v218
    v_add_f32 v225, v225, v219
    v_add_f32 v224, v224, v220
    v_add_f32 v225, v225, v221
    v_add_f32 v224, v224, v222
    v_add_f32 v225, v225, v223
    v_add_f32 v224, v224, v225
    s_nop 1
    v_add_f32 v224, v224, v224 row_shr:1 row_mask:0xf bank_mask:0xf bound_ctrl:0
    s_nop 1
    v_add_f32 v224, v224, v224 row_shr:2 row_mask:0xf bank_mask:0xf bound_ctrl:0
    s_nop 1
    v_add_f32 v224, v224, v224 row_shr:4 row_mask:0xf bank_mask:0xf bound_ctrl:0
    s_nop 1
    v_add_f32 v224, v224, v224 row_shr:8 row_mask:0xf bank_mask:0xf bound_ctrl:0
    s_nop 1
    v_add_f32 v224, v224, v224 row_bcast:15 row_mask:0xa bank_mask:0xf
    s_nop 1
    v_add_f32 v224, v224, v224 row_bcast:31 row_mask:0xc bank_mask:0xf
    s_nop 0
    v_readlane_b32 s54, v224, 63
    v_mov_b32 v226, 0x3ae38e39
    s_nop 0
    v_mul_f32 v226, s54, v226
    v_sub_f32 v232, v208, v226
    v_sub_f32 v233, v209, v226
    v_sub_f32 v234, v210, v226
    v_sub_f32 v235, v211, v226
    v_sub_f32 v236, v212, v226
    v_sub_f32 v237, v213, v226
    v_sub_f32 v238, v214, v226
    v_sub_f32 v239, v215, v226
    v_sub_f32 v240, v216, v226
    v_sub_f32 v241, v217, v226
    v_sub_f32 v242, v218, v226
    v_sub_f32 v243, v219, v226
    v_sub_f32 v244, v220, v226
    v_sub_f32 v245, v221, v226
    v_sub_f32 v246, v222, v226
    v_sub_f32 v247, v223, v226
    v_mul_f32 v224, v232, v232
    v_mul_f32 v225, v240, v240
    v_fmac_f32 v224, v233, v233
    v_fmac_f32 v225, v241, v241
    v_fmac_f32 v224, v234, v234
    v_fmac_f32 v225, v242, v242
    v_fmac_f32 v224, v235, v235
    v_fmac_f32 v225, v243, v243
    v_fmac_f32 v224, v236, v236
    v_fmac_f32 v225, v244, v244
    v_fmac_f32 v224, v237, v237
    v_fmac_f32 v225, v245, v245
    v_fmac_f32 v224, v238, v238
    v_fmac_f32 v225, v246, v246
    v_fmac_f32 v224, v239, v239
    v_fmac_f32 v225, v247, v247
    v_cndmask_b32 v225, 0, v225, s[52:53]
    v_add_f32 v224, v224, v225
    s_nop 1
    v_add_f32 v224, v224, v224 row_shr:1 row_mask:0xf bank_mask:0xf bound_ctrl:0
    s_nop 1
    v_add_f32 v224, v224, v224 row_shr:2 row_mask:0xf bank_mask:0xf bound_ctrl:0
    s_nop 1
    v_add_f32 v224, v224, v224 row_shr:4 row_mask:0xf bank_mask:0xf bound_ctrl:0
    s_nop 1
    v_add_f32 v224, v224, v224 row_shr:8 row_mask:0xf bank_mask:0xf bound_ctrl:0
    s_nop 1
    v_add_f32 v224, v224, v224 row_bcast:15 row_mask:0xa bank_mask:0xf
    s_nop 1
    v_add_f32 v224, v224, v224 row_bcast:31 row_mask:0xc bank_mask:0xf
    s_nop 0
    v_readlane_b32 s54, v224, 63
    v_mov_b32 v227, 0x3ae38e39
    s_nop 0
    v_mul_f32 v227, s54, v227
    v_cvt_pk_bf16_f32 v227, v227, v226
    v_and_b32 v226, 0xffff0000, v227
    v_lshlrev_b32 v227, 16, v227
    v_add_f32 v227, 0x3727c5ac, v227
    v_cvt_pk_bf16_f32 v227, v227, v227
    v_lshlrev_b32 v227, 16, v227
    v_sqrt_f32 v227, v227
    s_nop 0
    v_cvt_pk_bf16_f32 v227, v227, v227
    v_lshlrev_b32 v227, 16, v227
    v_rcp_f32 v227, v227
    v_sub_f32 v232, v208, v226
    v_sub_f32 v233, v209, v226
    v_sub_f32 v234, v210, v226
    v_sub_f32 v235, v211, v226
    v_sub_f32 v236, v212, v226
    v_sub_f32 v237, v213, v226
    v_sub_f32 v238, v214, v226
    v_sub_f32 v239, v215, v226
    v_sub_f32 v240, v216, v226
    v_sub_f32 v241, v217, v226
    v_sub_f32 v242, v218, v226
    v_sub_f32 v243, v219, v226
    v_sub_f32 v244, v220, v226
    v_sub_f32 v245, v221, v226
    v_sub_f32 v246, v222, v226
    v_sub_f32 v247, v223, v226
    v_mul_f32 v232, v232, v227
    v_mul_f32 v233, v233, v227
    v_mul_f32 v234, v234, v227
    v_mul_f32 v235, v235, v227
    v_mul_f32 v236, v236, v227
    v_mul_f32 v237, v237, v227
    v_mul_f32 v238, v238, v227
    v_mul_f32 v239, v239, v227
    v_mul_f32 v240, v240, v227
    v_mul_f32 v241, v241, v227
    v_mul_f32 v242, v242, v227
    v_mul_f32 v243, v243, v227
    v_mul_f32 v244, v244, v227
    v_mul_f32 v245, v245, v227
    v_mul_f32 v246, v246, v227
    v_mul_f32 v247, v247, v227
    v_cvt_pk_bf16_f32 v196, v232, v233
    v_cvt_pk_bf16_f32 v197, v234, v235
    v_cvt_pk_bf16_f32 v198, v236, v237
    v_cvt_pk_bf16_f32 v199, v238, v239
    v_cvt_pk_bf16_f32 v200, v240, v241
    v_cvt_pk_bf16_f32 v201, v242, v243
    v_cvt_pk_bf16_f32 v202, v244, v245
    v_cvt_pk_bf16_f32 v203, v246, v247
    ds_write_b128 v206, v[196:199]
    s_mov_b64 exec, 0xff
    ds_write_b128 v206, v[200:203] offset:8192
    s_mov_b64 exec, -1
    s_waitcnt lgkmcnt(0)
    s_barrier
    ds_read_b128 v[196:199], v207
    s_cmp_lg_u32 s3, 0
    s_cbranch_scc1 L_ln8
    ds_read_b128 v[200:203], v207 offset:8192
    s_add_u32 s51, s51, 32768
    s_waitcnt lgkmcnt(0)
    buffer_store_dwordx4 v[200:203], v228, s[24:27], s51 offen sc1
    buffer_store_dwordx4 v[196:199], v228, s[24:27], s50 offen sc1
    v_mov_b32 v212, 0
    s_mov_b32 s55, 0
L_tg:
    buffer_load_dwordx2 v[208:209], v212, s[20:23], 0 offen sc1
    s_add_u32 s55, s55, 1
    s_waitcnt vmcnt(0)
    v_cmp_eq_u32 vcc, 0, v208
    s_cbranch_vccz L_tg_d
    s_cmp_lt_u32 s55, 0x100000
    s_cbranch_scc1 L_tg
L_tg_d:
    v_mov_b32 v212, 140800
    ds_write_b64 v212, v[208:209]
    s_waitcnt lgkmcnt(0)
    s_branch L_ln8_e
L_ln8:
    s_waitcnt lgkmcnt(0)
    buffer_store_dwordx4 v[196:199], v228, s[24:27], s50 offen sc1
L_ln8_e:
    v_lshlrev_b32 v24, 4, v0
    s_mov_b32 s28, s68
    s_mov_b32 s29, s69
    s_mov_b32 s30, 5308416
    s_mov_b32 s31, 0x00020000
    s_waitcnt vmcnt(0)
    s_barrier
    v_mov_b32 v120, 140800
    ds_read_b64 v[118:119], v120
    s_waitcnt lgkmcnt(0)
    v_readfirstlane_b32 s98, v118
    v_readfirstlane_b32 s99, v119
    s_cmp_lg_u32 s3, 0
    s_cbranch_scc1 L_p0w
    v_mov_b32 v112, s98
    v_mov_b32 v113, s99
    v_mov_b32 v114, s98
    v_mov_b32 v115, s99
    s_lshl_b32 s55, s2, 7
    s_add_u32 s55, s55, 49283072
    s_mov_b64 exec, 0xff
    buffer_store_dwordx4 v[112:115], v24, s[24:27], s55 offen sc1
    s_mov_b64 exec, -1
L_p0w:
    s_mul_i32 s78, s83, s37
    s_add_u32 m0, s6, 49344
    s_add_u32 s79, s78, s32
    buffer_load_dwordx4 v1, s[8:11], s79 offen lds
    s_mul_i32 s78, s83, s38
    s_add_u32 m0, s7, 49344
    s_add_u32 s79, s78, s33
    buffer_load_dwordx4 v9, s[12:15], s79 offen lds
    s_mul_i32 s78, s84, s37
    s_add_u32 m0, s6, 65792
    s_add_u32 s79, s78, s32
    buffer_load_dwordx4 v1, s[8:11], s79 offen lds
    s_mul_i32 s78, s84, s38
    s_add_u32 m0, s7, 65792
    s_add_u32 s79, s78, s33
    buffer_load_dwordx4 v9, s[12:15], s79 offen lds
    s_mul_i32 s78, s85, s37
    s_add_u32 m0, s6, 82240
    s_add_u32 s79, s78, s32
    buffer_load_dwordx4 v1, s[8:11], s79 offen lds
    s_mul_i32 s78, s85, s38
    s_add_u32 m0, s7, 82240
    s_add_u32 s79, s78, s33
    buffer_load_dwordx4 v9, s[12:15], s79 offen lds
    s_mul_i32 s78, s86, s37
    s_add_u32 m0, s6, 98688
    s_add_u32 s79, s78, s32
    buffer_load_dwordx4 v1, s[8:11], s79 offen lds
    s_mul_i32 s78, s86, s38
    s_add_u32 m0, s7, 98688
    s_add_u32 s79, s78, s33
    buffer_load_dwordx4 v9, s[12:15], s79 offen lds
    s_mul_i32 s78, s87, s37
    s_add_u32 m0, s6, 115136
    s_add_u32 s79, s78, s32
    buffer_load_dwordx4 v1, s[8:11], s79 offen lds
    s_mul_i32 s78, s87, s38
    s_add_u32 m0, s7, 115136
    s_add_u32 s79, s78, s33
    buffer_load_dwordx4 v9, s[12:15], s79 offen lds
    v_bfe_u32 v25, v0, 4, 1
    v_lshrrev_b32 v26, 5, v0
    v_bfe_u32 v27, v0, 2, 2
    v_lshl_add_u32 v26, v26, 3, v27
    v_and_b32 v13, 3, v0
    v_lshlrev_b32 v13, 3, v13
    v_mul_u32_u24 v3, 8256, v25
    v_lshl_add_u32 v3, v26, 7, v3
    v_add_u32 v3, v3, v13
    v_bfe_u32 v14, v0, 3, 1
    v_lshlrev_b32 v14, 5, v14
    v_xor_b32 v15, 32, v14
    v_add_u32 v4, v3, v15
    v_add_u32 v3, v3, v14
    v_add_u32 v5, 65792, v3
    v_add_u32 v6, 65792, v4
    v_lshl_add_u32 v28, v26, 6, v13
    v_mul_u32_u24 v7, 4128, v25
    v_add_u32 v7, v7, v28
    v_add_u32 v8, 65792, v7
    v_and_b32 v32, 3, v0
    v_lshlrev_b32 v32, 7, v32
    s_lshl_b32 s77, s71, 9
    s_add_u32 s77, s77, 49283072
    v_add_u32 v32, s77, v32
    v_mov_b32 v0, v24
    s_mov_b32 s55, 0
L_poll_1:
    buffer_load_dwordx2 v[34:35], v32, s[24:27], 0 offen sc1
    s_add_u32 s55, s55, 1
    s_waitcnt vmcnt(0)
    v_cmp_ne_u64 vcc, s[98:99], v[34:35]
    s_cbranch_vccz L_poll_1_d
    s_cmp_lt_u32 s55, 0x100000
    s_cbranch_scc1 L_poll_1
L_poll_1_d:
    s_lshl_b32 s77, s80, 12
    s_add_u32 s77, s77, s39
    buffer_load_dwordx4 v[112:115], v0, s[24:27], s77 offen offset:0 sc1
    buffer_load_dwordx4 v[116:119], v0, s[24:27], s77 offen offset:1024 sc1
    buffer_load_dwordx4 v[120:123], v0, s[24:27], s77 offen offset:2048 sc1
    buffer_load_dwordx4 v[124:127], v0, s[24:27], s77 offen offset:3072 sc1
    s_lshl_b32 s77, s81, 12
    s_add_u32 s77, s77, s39
    buffer_load_dwordx4 v[128:131], v0, s[24:27], s77 offen offset:0 sc1
    buffer_load_dwordx4 v[132:135], v0, s[24:27], s77 offen offset:1024 sc1
    buffer_load_dwordx4 v[136:139], v0, s[24:27], s77 offen offset:2048 sc1
    buffer_load_dwordx4 v[140:143], v0, s[24:27], s77 offen offset:3072 sc1
    s_cmp_ge_u32 s5, 29
    s_cbranch_scc1 L_st_q
    s_cmp_ge_u32 s3, 4
    s_cselect_b32 s16, s66, s64
    s_cselect_b32 s17, s67, s65
    s_mov_b32 s18, 5308416
    s_mov_b32 s19, 0x00020000
    s_add_u32 s34, s32, 3712
    s_mov_b32 s35, s34
    s_min_u32 s74, s5, 27
    s_lshl_b32 s36, s74, 6
    s_add_u32 s36, s36, 7424
    s_mul_i32 s75, s71, 288*1024
    s_add_u32 s75, s75, 3145728
    s_lshl_b32 s40, s5, 12
    s_add_u32 s40, s40, s75
    s_add_u32 s41, s40, 118784
    s_lshl_b32 s42, s74, 11
    s_add_u32 s42, s42, 237568
    s_add_u32 s42, s42, s75
    s_cmp_eq_u32 s5, 28
    s_cselect_b32 s42, 1073741824, s42
    s_cselect_b32 s36, 1073741824, s36
    s_mov_b32 s46, 0xbfb8aa3b
    s_mov_b32 s47, 0xbfb8aa3b
    v_mul_u32_u24 v2, 9216, v22
    v_add_u32 v2, v2, v23
    s_and_b32 s4, s2, 7
    s_lshr_b32 s61, s2, 3
    s_mul_i32 s60, s61, 43
    s_lshr_b32 s60, s60, 7
    s_mul_i32 s59, s60, 3
    s_sub_u32 s59, s61, s59
    s_mul_i32 s5, s4, 10
    s_add_u32 s5, s5, s60
    s_lshr_b32 s57, s5, 4
    s_and_b32 s58, s5, 15
    s_and_b32 s62, s3, 3
    s_lshr_b32 s63, s3, 2
    s_cmp_eq_u32 s57, 4
    s_cselect_b32 s56, 28, 29
    s_cmp_ge_u32 s61, 30
    s_cselect_b32 s56, 0, s56
    s_and_b32 s20, s2, 0xe0
    s_add_u32 s20, s20, 29
    s_lshr_b32 s23, s58, 1
    s_lshl_b32 s23, s23, 5
    s_sub_u32 s23, s23, 32
    s_mov_b32 s96, 0
    s_cmp_eq_u32 s56, 0
    s_cselect_b32 s97, 0, 0x1fffffff
    s_lshr_b32 s4, s2, 2
    s_and_b32 s5, s2, 3
    s_lshl_b32 s52, s5, 3
    s_lshl_b32 s74, s62, 1
    s_add_u32 s52, s52, s74
    s_mul_i32 s4, s4, 36864
    s_add_u32 s51, s4, 26214400
    s_mul_i32 s5, s5, 9216
    s_add_u32 s50, s4, s5
    s_lshl_b32 s4, s3, 10
    s_add_u32 s50, s50, s4
    s_add_u32 s50, s50, 22020096
    s_mul_i32 s22, s62, 36
    s_lshl_b32 s4, s62, 8
    s_add_u32 s4, s4, 4096
    s_lshl_b32 s72, s62, 10
    s_cmp_eq_u32 s63, 0
    s_cselect_b32 s4, s4, s72
    s_add_u32 s73, s4, 131584
    s_add_u32 s101, s4, 25165824
    s_mul_i32 s66, s57, 12
    s_mul_i32 s68, s57, 17
    s_cmp_eq_u32 s57, 4
    s_cselect_b32 s66, 47, s66
    s_cselect_b32 s68, 69, s68
    s_add_u32 s68, s68, 58
    s_cmp_ge_u32 s57, 3
    s_cselect_b32 s67, 11, 12
    s_sub_u32 s69, s56, s67
    s_lshr_b32 s70, s60, 1
    s_add_u32 s70, s70, s60
    s_sub_u32 s70, s70, s67
    s_mul_i32 s64, s59, 384
    s_mul_i32 s65, s62, 9216
    s_add_u32 s64, s64, s65
    s_lshl_b32 s4, s58, 2
    s_add_u32 s4, s4, s62
    s_mul_i32 s65, s4, 294912
    s_add_u32 s65, s65, 3145728
    s_lshl_b32 s89, s62, 11
    s_add_u32 s89, s89, 49152
    s_cmp_eq_u32 s56, 0
    s_cselect_b32 s64, 1073741824, s64
    s_cselect_b32 s65, 1073741824, s65
    s_mul_i32 s75, s57, 2359296
    s_mul_i32 s4, s4, 18
    s_mul_i32 s5, s59, 6
    s_add_u32 s4, s4, s5
    s_mul_i32 s5, s63, 3
    s_add_u32 s4, s4, s5
    s_lshl_b32 s4, s4, 11
    s_add_u32 s75, s75, s4
    s_add_u32 s75, s75, 30408704
    s_lshl_b32 s58, s63, 10
    s_add_u32 s58, s58, 131584
    s_mul_i32 s59, s63, 1280
    s_add_u32 s59, s59, 133632
    s_lshl_b32 s71, s63, 12
    s_lshl_b32 s74, s63, 13
    s_cmp_eq_u32 s3, 0
    s_cselect_b32 s53, 6, -1
    s_cselect_b32 s54, 9, -1
    s_movk_i32 s4, 0x7f8
    s_mov_b32 s5, 0
    s_waitcnt vmcnt(4)
    s_barrier
    ds_read_b64_tr_b16 v[12:13], v3 offset:64
    ds_read_b64_tr_b16 v[14:15], v3 offset:576
    ds_read_b64_tr_b16 v[16:17], v3 offset:2112
    ds_read_b64_tr_b16 v[18:19], v3 offset:2624
    ds_read_b64_tr_b16 v[20:21], v3 offset:4160
    ds_read_b64_tr_b16 v[22:23], v3 offset:4672
    ds_read_b64_tr_b16 v[24:25], v3 offset:6208
    ds_read_b64_tr_b16 v[26:27], v3 offset:6720
    s_waitcnt lgkmcnt(6)
    v_mfma_f32_32x32x16_bf16 v[80:95], v[12:15], v[112:115], 0
    ds_read_b64_tr_b16 v[28:29], v4 offset:64
    ds_read_b64_tr_b16 v[30:31], v4 offset:576
    s_lshl_b32 s77, s82, 12
    s_add_u32 s77, s77, s39
    buffer_load_dwordx4 v[144:147], v0, s[24:27], s77 offen offset:0 sc1
    s_waitcnt lgkmcnt(6)
    v_mfma_f32_32x32x16_bf16 v[80:95], v[16:19], v[116:119], v[80:95]
    ds_read_b64_tr_b16 v[12:13], v4 offset:2112
    ds_read_b64_tr_b16 v[14:15], v4 offset:2624
    buffer_load_dwordx4 v[148:151], v0, s[24:27], s77 offen offset:1024 sc1
    s_waitcnt lgkmcnt(6)
    v_mfma_f32_32x32x16_bf16 v[80:95], v[20:23], v[120:123], v[80:95]
    ds_read_b64_tr_b16 v[16:17], v4 offset:4160
    ds_read_b64_tr_b16 v[18:19], v4 offset:4672
    buffer_load_dwordx4 v[152:155], v0, s[24:27], s77 offen offset:2048 sc1
    s_waitcnt lgkmcnt(6)
    v_mfma_f32_32x32x16_bf16 v[80:95], v[24:27], v[124:127], v[80:95]
    ds_read_b64_tr_b16 v[20:21], v4 offset:6208
    ds_read_b64_tr_b16 v[22:23], v4 offset:6720
    buffer_load_dwordx4 v[156:159], v0, s[24:27], s77 offen offset:3072 sc1
    s_waitcnt lgkmcnt(6)
    v_mfma_f32_32x32x16_bf16 v[96:111], v[28:31], v[112:115], 0
    ds_read_b64_tr_b16 v[24:25], v3 offset:0
    ds_read_b64_tr_b16 v[26:27], v3 offset:512
    s_waitcnt lgkmcnt(6)
    v_mfma_f32_32x32x16_bf16 v[96:111], v[12:15], v[116:119], v[96:111]
    ds_read_b64_tr_b16 v[28:29], v3 offset:2048
    ds_read_b64_tr_b16 v[30:31], v3 offset:2560
    s_waitcnt lgkmcnt(6)
    v_mfma_f32_32x32x16_bf16 v[96:111], v[16:19], v[120:123], v[96:111]
    ds_read_b64_tr_b16 v[12:13], v3 offset:4096
    ds_read_b64_tr_b16 v[14:15], v3 offset:4608
    s_waitcnt lgkmcnt(6)
    v_mfma_f32_32x32x16_bf16 v[96:111], v[20:23], v[124:127], v[96:111]
    ds_read_b64_tr_b16 v[16:17], v3 offset:6144
    ds_read_b64_tr_b16 v[18:19], v3 offset:6656
    s_waitcnt vmcnt(4)
    s_barrier
    s_waitcnt lgkmcnt(6)
    v_mfma_f32_32x32x16_bf16 v[48:63], v[24:27], v[112:115], 0
    ds_read_b64_tr_b16 v[20:21], v3 offset:16512
    ds_read_b64_tr_b16 v[22:23], v3 offset:17024
    s_lshl_b32 s77, s83, 12
    s_add_u32 s77, s77, s39
    buffer_load_dwordx4 v[160:163], v0, s[24:27], s77 offen offset:0 sc1
    s_waitcnt lgkmcnt(6)
    v_mfma_f32_32x32x16_bf16 v[48:63], v[28:31], v[116:119], v[48:63]
    ds_read_b64_tr_b16 v[24:25], v3 offset:18560
    ds_read_b64_tr_b16 v[26:27], v3 offset:19072
    buffer_load_dwordx4 v[164:167], v0, s[24:27], s77 offen offset:1024 sc1
    s_waitcnt lgkmcnt(6)
    v_mfma_f32_32x32x16_bf16 v[48:63], v[12:15], v[120:123], v[48:63]
    ds_read_b64_tr_b16 v[28:29], v3 offset:20608
    ds_read_b64_tr_b16 v[30:31], v3 offset:21120
    buffer_load_dwordx4 v[168:171], v0, s[24:27], s77 offen offset:2048 sc1
    s_waitcnt lgkmcnt(6)
    v_mfma_f32_32x32x16_bf16 v[48:63], v[16:19], v[124:127], v[48:63]
    ds_read_b64_tr_b16 v[12:13], v3 offset:22656
    ds_read_b64_tr_b16 v[14:15], v3 offset:23168
    buffer_load_dwordx4 v[172:175], v0, s[24:27], s77 offen offset:3072 sc1
    s_waitcnt lgkmcnt(6)
    v_mfma_f32_32x32x16_bf16 v[80:95], v[20:23], v[128:131], v[80:95]
    ds_read_b64_tr_b16 v[16:17], v4 offset:16512
    ds_read_b64_tr_b16 v[18:19], v4 offset:17024
    s_waitcnt lgkmcnt(6)
    v_mfma_f32_32x32x16_bf16 v[80:95], v[24:27], v[132:135], v[80:95]
    ds_read_b64_tr_b16 v[20:21], v4 offset:18560
    ds_read_b64_tr_b16 v[22:23], v4 offset:19072
    s_waitcnt lgkmcnt(6)
    v_mfma_f32_32x32x16_bf16 v[80:95], v[28:31], v[136:139], v[80:95]
    ds_read_b64_tr_b16 v[24:25], v4 offset:20608
    ds_read_b64_tr_b16 v[26:27], v4 offset:21120
    s_waitcnt lgkmcnt(6)
    v_mfma_f32_32x32x16_bf16 v[80:95], v[12:15], v[140:143], v[80:95]
    ds_read_b64_tr_b16 v[28:29], v4 offset:22656
    ds_read_b64_tr_b16 v[30:31], v4 offset:23168
    s_waitcnt lgkmcnt(6)
    v_mfma_f32_32x32x16_bf16 v[96:111], v[16:19], v[128:131], v[96:111]
    ds_read_b64_tr_b16 v[12:13], v3 offset:16448
    ds_read_b64_tr_b16 v[14:15], v3 offset:16960
    s_waitcnt lgkmcnt(6)
    v_mfma_f32_32x32x16_bf16 v[96:111], v[20:23], v[132:135], v[96:111]
    ds_read_b64_tr_b16 v[16:17], v3 offset:18496
    ds_read_b64_tr_b16 v[18:19], v3 offset:19008
    s_waitcnt lgkmcnt(6)
    v_mfma_f32_32x32x16_bf16 v[96:111], v[24:27], v[136:139], v[96:111]
    ds_read_b64_tr_b16 v[20:21], v3 offset:20544
    ds_read_b64_tr_b16 v[22:23], v3 offset:21056
    s_waitcnt lgkmcnt(6)
    v_mfma_f32_32x32x16_bf16 v[96:111], v[28:31], v[140:143], v[96:111]
    ds_read_b64_tr_b16 v[24:25], v3 offset:22592
    ds_read_b64_tr_b16 v[26:27], v3 offset:23104
    s_waitcnt lgkmcnt(6)
    v_mfma_f32_32x32x16_bf16 v[48:63], v[12:15], v[128:131], v[48:63]
    ds_read_b64_tr_b16 v[28:29], v4 offset:0
    ds_read_b64_tr_b16 v[30:31], v4 offset:512
    s_waitcnt lgkmcnt(6)
    v_mfma_f32_32x32x16_bf16 v[48:63], v[16:19], v[132:135], v[48:63]
    ds_read_b64_tr_b16 v[12:13], v4 offset:2048
    ds_read_b64_tr_b16 v[14:15], v4 offset:2560
    s_waitcnt lgkmcnt(6)
    v_mfma_f32_32x32x16_bf16 v[48:63], v[20:23], v[136:139], v[48:63]
    ds_read_b64_tr_b16 v[16:17], v4 offset:4096
    ds_read_b64_tr_b16 v[18:19], v4 offset:4608
    s_waitcnt lgkmcnt(6)
    v_mfma_f32_32x32x16_bf16 v[48:63], v[24:27], v[140:143], v[48:63]
    ds_read_b64_tr_b16 v[20:21], v4 offset:6144
    ds_read_b64_tr_b16 v[22:23], v4 offset:6656
    s_waitcnt vmcnt(4)
    s_barrier
    s_waitcnt lgkmcnt(6)
    v_mfma_f32_32x32x16_bf16 v[64:79], v[28:31], v[112:115], 0
    ds_read_b64_tr_b16 v[24:25], v3 offset:32960
    ds_read_b64_tr_b16 v[26:27], v3 offset:33472
    s_lshl_b32 s77, s84, 12
    s_add_u32 s77, s77, s39
    buffer_load_dwordx4 v[176:179], v0, s[24:27], s77 offen offset:0 sc1
    s_waitcnt lgkmcnt(6)
    v_mfma_f32_32x32x16_bf16 v[64:79], v[12:15], v[116:119], v[64:79]
    ds_read_b64_tr_b16 v[28:29], v3 offset:35008
    ds_read_b64_tr_b16 v[30:31], v3 offset:35520
    buffer_load_dwordx4 v[180:183], v0, s[24:27], s77 offen offset:1024 sc1
    s_waitcnt lgkmcnt(6)
    v_mfma_f32_32x32x16_bf16 v[64:79], v[16:19], v[120:123], v[64:79]
    ds_read_b64_tr_b16 v[12:13], v3 offset:37056
    ds_read_b64_tr_b16 v[14:15], v3 offset:37568
    buffer_load_dwordx4 v[184:187], v0, s[24:27], s77 offen offset:2048 sc1
    s_waitcnt lgkmcnt(6)
    v_mfma_f32_32x32x16_bf16 v[64:79], v[20:23], v[124:127], v[64:79]
    ds_read_b64_tr_b16 v[16:17], v3 offset:39104
    ds_read_b64_tr_b16 v[18:19], v3 offset:39616
    buffer_load_dwordx4 v[188:191], v0, s[24:27], s77 offen offset:3072 sc1
    s_waitcnt lgkmcnt(6)
    v_mfma_f32_32x32x16_bf16 v[80:95], v[24:27], v[144:147], v[80:95]
    ds_read_b64_tr_b16 v[20:21], v4 offset:32960
    ds_read_b64_tr_b16 v[22:23], v4 offset:33472
    s_waitcnt lgkmcnt(6)
    v_mfma_f32_32x32x16_bf16 v[80:95], v[28:31], v[148:151], v[80:95]
    ds_read_b64_tr_b16 v[24:25], v4 offset:35008
    ds_read_b64_tr_b16 v[26:27], v4 offset:35520
    s_waitcnt lgkmcnt(6)
    v_mfma_f32_32x32x16_bf16 v[80:95], v[12:15], v[152:155], v[80:95]
    ds_read_b64_tr_b16 v[28:29], v4 offset:37056
    ds_read_b64_tr_b16 v[30:31], v4 offset:37568
    s_waitcnt lgkmcnt(6)
    v_mfma_f32_32x32x16_bf16 v[80:95], v[16:19], v[156:159], v[80:95]
    ds_read_b64_tr_b16 v[12:13], v4 offset:39104
    ds_read_b64_tr_b16 v[14:15], v4 offset:39616
    s_waitcnt lgkmcnt(6)
    v_mfma_f32_32x32x16_bf16 v[96:111], v[20:23], v[144:147], v[96:111]
    ds_read_b64_tr_b16 v[16:17], v3 offset:32896
    ds_read_b64_tr_b16 v[18:19], v3 offset:33408
    s_waitcnt lgkmcnt(6)
    v_mfma_f32_32x32x16_bf16 v[96:111], v[24:27], v[148:151], v[96:111]
    ds_read_b64_tr_b16 v[20:21], v3 offset:34944
    ds_read_b64_tr_b16 v[22:23], v3 offset:35456
    s_waitcnt lgkmcnt(6)
    v_mfma_f32_32x32x16_bf16 v[96:111], v[28:31], v[152:155], v[96:111]
    ds_read_b64_tr_b16 v[24:25], v3 offset:36992
    ds_read_b64_tr_b16 v[26:27], v3 offset:37504
    s_waitcnt lgkmcnt(6)
    v_mfma_f32_32x32x16_bf16 v[96:111], v[12:15], v[156:159], v[96:111]
    ds_read_b64_tr_b16 v[28:29], v3 offset:39040
    ds_read_b64_tr_b16 v[30:31], v3 offset:39552
    s_waitcnt lgkmcnt(6)
    v_mfma_f32_32x32x16_bf16 v[48:63], v[16:19], v[144:147], v[48:63]
    ds_read_b64_tr_b16 v[12:13], v4 offset:16448
    ds_read_b64_tr_b16 v[14:15], v4 offset:16960
    s_waitcnt lgkmcnt(6)
    v_mfma_f32_32x32x16_bf16 v[48:63], v[20:23], v[148:151], v[48:63]
    ds_read_b64_tr_b16 v[16:17], v4 offset:18496
    ds_read_b64_tr_b16 v[18:19], v4 offset:19008
    s_waitcnt lgkmcnt(6)
    v_mfma_f32_32x32x16_bf16 v[48:63], v[24:27], v[152:155], v[48:63]
    ds_read_b64_tr_b16 v[20:21], v4 offset:20544
    ds_read_b64_tr_b16 v[22:23], v4 offset:21056
    s_waitcnt lgkmcnt(6)
    v_mfma_f32_32x32x16_bf16 v[48:63], v[28:31], v[156:159], v[48:63]
    ds_read_b64_tr_b16 v[24:25], v4 offset:22592
    ds_read_b64_tr_b16 v[26:27], v4 offset:23104
    s_waitcnt vmcnt(4)
    s_barrier
    s_waitcnt lgkmcnt(6)
    v_mfma_f32_32x32x16_bf16 v[64:79], v[12:15], v[128:131], v[64:79]
    ds_read_b64_tr_b16 v[28:29], v3 offset:49408
    ds_read_b64_tr_b16 v[30:31], v3 offset:49920
    s_lshl_b32 s77, s85, 12
    s_add_u32 s77, s77, s39
    buffer_load_dwordx4 v[192:195], v0, s[24:27], s77 offen offset:0 sc1
    s_waitcnt lgkmcnt(6)
    v_mfma_f32_32x32x16_bf16 v[64:79], v[16:19], v[132:135], v[64:79]
    ds_read_b64_tr_b16 v[12:13], v3 offset:51456
    ds_read_b64_tr_b16 v[14:15], v3 offset:51968
    buffer_load_dwordx4 v[196:199], v0, s[24:27], s77 offen offset:1024 sc1
    s_waitcnt lgkmcnt(6)
    v_mfma_f32_32x32x16_bf16 v[64:79], v[20:23], v[136:139], v[64:79]
    ds_read_b64_tr_b16 v[16:17], v3 offset:53504
    ds_read_b64_tr_b16 v[18:19], v3 offset:54016
    buffer_load_dwordx4 v[200:203], v0, s[24:27], s77 offen offset:2048 sc1
    s_waitcnt lgkmcnt(6)
    v_mfma_f32_32x32x16_bf16 v[64:79], v[24:27], v[140:143], v[64:79]
    ds_read_b64_tr_b16 v[20:21], v3 offset:55552
    ds_read_b64_tr_b16 v[22:23], v3 offset:56064
    buffer_load_dwordx4 v[204:207], v0, s[24:27], s77 offen offset:3072 sc1
    s_waitcnt lgkmcnt(6)
    v_mfma_f32_32x32x16_bf16 v[80:95], v[28:31], v[160:163], v[80:95]
    ds_read_b64_tr_b16 v[24:25], v4 offset:49408
    ds_read_b64_tr_b16 v[26:27], v4 offset:49920
    s_mul_i32 s78, s88, s37
    s_add_u32 m0, s6, 0
    s_add_u32 s79, s78, s32
    buffer_load_dwordx4 v1, s[8:11], s79 offen lds
    s_waitcnt lgkmcnt(6)
    v_mfma_f32_32x32x16_bf16 v[80:95], v[12:15], v[164:167], v[80:95]
    ds_read_b64_tr_b16 v[28:29], v4 offset:51456
    ds_read_b64_tr_b16 v[30:31], v4 offset:51968
    s_mul_i32 s78, s88, s38
    s_add_u32 m0, s7, 0
    s_add_u32 s79, s78, s33
    buffer_load_dwordx4 v9, s[12:15], s79 offen lds
    s_waitcnt lgkmcnt(6)
    v_mfma_f32_32x32x16_bf16 v[80:95], v[16:19], v[168:171], v[80:95]
    ds_read_b64_tr_b16 v[12:13], v4 offset:53504
    ds_read_b64_tr_b16 v[14:15], v4 offset:54016
    s_waitcnt lgkmcnt(6)
    v_mfma_f32_32x32x16_bf16 v[80:95], v[20:23], v[172:175], v[80:95]
    ds_read_b64_tr_b16 v[16:17], v4 offset:55552
    ds_read_b64_tr_b16 v[18:19], v4 offset:56064
    s_waitcnt lgkmcnt(6)
    v_mfma_f32_32x32x16_bf16 v[96:111], v[24:27], v[160:163], v[96:111]
    ds_read_b64_tr_b16 v[20:21], v3 offset:49344
    ds_read_b64_tr_b16 v[22:23], v3 offset:49856
    s_waitcnt lgkmcnt(6)
    v_mfma_f32_32x32x16_bf16 v[96:111], v[28:31], v[164:167], v[96:111]
    ds_read_b64_tr_b16 v[24:25], v3 offset:51392
    ds_read_b64_tr_b16 v[26:27], v3 offset:51904
    s_waitcnt lgkmcnt(6)
    v_mfma_f32_32x32x16_bf16 v[96:111], v[12:15], v[168:171], v[96:111]
    ds_read_b64_tr_b16 v[28:29], v3 offset:53440
    ds_read_b64_tr_b16 v[30:31], v3 offset:53952
    s_waitcnt lgkmcnt(6)
    v_mfma_f32_32x32x16_bf16 v[96:111], v[16:19], v[172:175], v[96:111]
    ds_read_b64_tr_b16 v[12:13], v3 offset:55488
    ds_read_b64_tr_b16 v[14:15], v3 offset:56000
    s_waitcnt lgkmcnt(6)
    v_mfma_f32_32x32x16_bf16 v[48:63], v[20:23], v[160:163], v[48:63]
    ds_read_b64_tr_b16 v[16:17], v4 offset:32896
    ds_read_b64_tr_b16 v[18:19], v4 offset:33408
    s_waitcnt lgkmcnt(6)
    v_mfma_f32_32x32x16_bf16 v[48:63], v[24:27], v[164:167], v[48:63]
    ds_read_b64_tr_b16 v[20:21], v4 offset:34944
    ds_read_b64_tr_b16 v[22:23], v4 offset:35456
    s_waitcnt lgkmcnt(6)
    v_mfma_f32_32x32x16_bf16 v[48:63], v[28:31], v[168:171], v[48:63]
    ds_read_b64_tr_b16 v[24:25], v4 offset:36992
    ds_read_b64_tr_b16 v[26:27], v4 offset:37504
    s_waitcnt lgkmcnt(6)
    v_mfma_f32_32x32x16_bf16 v[48:63], v[12:15], v[172:175], v[48:63]
    ds_read_b64_tr_b16 v[28:29], v4 offset:39040
    ds_read_b64_tr_b16 v[30:31], v4 offset:39552
    s_waitcnt vmcnt(6)
    s_barrier
    s_waitcnt lgkmcnt(6)
    v_mfma_f32_32x32x16_bf16 v[64:79], v[16:19], v[144:147], v[64:79]
    ds_read_b64_tr_b16 v[12:13], v5 offset:64
    ds_read_b64_tr_b16 v[14:15], v5 offset:576
    s_lshl_b32 s77, s86, 12
    s_add_u32 s77, s77, s39
    buffer_load_dwordx4 v[208:211], v0, s[24:27], s77 offen offset:0 sc1
    s_waitcnt lgkmcnt(6)
    v_mfma_f32_32x32x16_bf16 v[64:79], v[20:23], v[148:151], v[64:79]
    ds_read_b64_tr_b16 v[16:17], v5 offset:2112
    ds_read_b64_tr_b16 v[18:19], v5 offset:2624
    buffer_load_dwordx4 v[212:215], v0, s[24:27], s77 offen offset:1024 sc1
    s_waitcnt lgkmcnt(6)
    v_mfma_f32_32x32x16_bf16 v[64:79], v[24:27], v[152:155], v[64:79]
    ds_read_b64_tr_b16 v[20:21], v5 offset:4160
    ds_read_b64_tr_b16 v[22:23], v5 offset:4672
    buffer_load_dwordx4 v[216:219], v0, s[24:27], s77 offen offset:2048 sc1
    s_waitcnt lgkmcnt(6)
    v_mfma_f32_32x32x16_bf16 v[64:79], v[28:31], v[156:159], v[64:79]
    ds_read_b64_tr_b16 v[24:25], v5 offset:6208
    ds_read_b64_tr_b16 v[26:27], v5 offset:6720
    buffer_load_dwordx4 v[220:223], v0, s[24:27], s77 offen offset:3072 sc1
    s_waitcnt lgkmcnt(6)
    v_mfma_f32_32x32x16_bf16 v[80:95], v[12:15], v[176:179], v[80:95]
    ds_read_b64_tr_b16 v[28:29], v6 offset:64
    ds_read_b64_tr_b16 v[30:31], v6 offset:576
    s_mul_i32 s78, s80, s37
    s_add_u32 m0, s6, 16448
    s_add_u32 s79, s78, s34
    buffer_load_dwordx4 v1, s[8:11], s79 offen lds
    s_waitcnt lgkmcnt(6)
    v_mfma_f32_32x32x16_bf16 v[80:95], v[16:19], v[180:183], v[80:95]
    ds_read_b64_tr_b16 v[12:13], v6 offset:2112
    ds_read_b64_tr_b16 v[14:15], v6 offset:2624
    s_mul_i32 s78, s80, s38
    s_add_u32 m0, s7, 16448
    s_add_u32 s79, s78, s35
    buffer_load_dwordx4 v9, s[12:15], s79 offen lds
    s_waitcnt lgkmcnt(6)
    v_mfma_f32_32x32x16_bf16 v[80:95], v[20:23], v[184:187], v[80:95]
    ds_read_b64_tr_b16 v[16:17], v6 offset:4160
    ds_read_b64_tr_b16 v[18:19], v6 offset:4672
    s_waitcnt lgkmcnt(6)
    v_mfma_f32_32x32x16_bf16 v[80:95], v[24:27], v[188:191], v[80:95]
    ds_read_b64_tr_b16 v[20:21], v6 offset:6208
    ds_read_b64_tr_b16 v[22:23], v6 offset:6720
    s_waitcnt lgkmcnt(6)
    v_mfma_f32_32x32x16_bf16 v[96:111], v[28:31], v[176:179], v[96:111]
    ds_read_b64_tr_b16 v[24:25], v5 offset:0
    ds_read_b64_tr_b16 v[26:27], v5 offset:512
    s_waitcnt lgkmcnt(6)
    v_mfma_f32_32x32x16_bf16 v[96:111], v[12:15], v[180:183], v[96:111]
    ds_read_b64_tr_b16 v[28:29], v5 offset:2048
    ds_read_b64_tr_b16 v[30:31], v5 offset:2560
    s_waitcnt lgkmcnt(6)
    v_mfma_f32_32x32x16_bf16 v[96:111], v[16:19], v[184:187], v[96:111]
    ds_read_b64_tr_b16 v[12:13], v5 offset:4096
    ds_read_b64_tr_b16 v[14:15], v5 offset:4608
    s_waitcnt lgkmcnt(6)
    v_mfma_f32_32x32x16_bf16 v[96:111], v[20:23], v[188:191], v[96:111]
    ds_read_b64_tr_b16 v[16:17], v5 offset:6144
    ds_read_b64_tr_b16 v[18:19], v5 offset:6656
    s_waitcnt lgkmcnt(6)
    v_mfma_f32_32x32x16_bf16 v[48:63], v[24:27], v[176:179], v[48:63]
    ds_read_b64_tr_b16 v[20:21], v4 offset:49344
    ds_read_b64_tr_b16 v[22:23], v4 offset:49856
    s_waitcnt lgkmcnt(6)
    v_mfma_f32_32x32x16_bf16 v[48:63], v[28:31], v[180:183], v[48:63]
    ds_read_b64_tr_b16 v[24:25], v4 offset:51392
    ds_read_b64_tr_b16 v[26:27], v4 offset:51904
    s_waitcnt lgkmcnt(6)
    v_mfma_f32_32x32x16_bf16 v[48:63], v[12:15], v[184:187], v[48:63]
    ds_read_b64_tr_b16 v[28:29], v4 offset:53440
    ds_read_b64_tr_b16 v[30:31], v4 offset:53952
    s_waitcnt lgkmcnt(6)
    v_mfma_f32_32x32x16_bf16 v[48:63], v[16:19], v[188:191], v[48:63]
    ds_read_b64_tr_b16 v[12:13], v4 offset:55488
    ds_read_b64_tr_b16 v[14:15], v4 offset:56000
    s_waitcnt vmcnt(8)
    s_barrier
    s_waitcnt lgkmcnt(6)
    v_mfma_f32_32x32x16_bf16 v[64:79], v[20:23], v[160:163], v[64:79]
    ds_read_b64_tr_b16 v[16:17], v5 offset:16512
    ds_read_b64_tr_b16 v[18:19], v5 offset:17024
    s_lshl_b32 s77, s87, 12
    s_add_u32 s77, s77, s39
    buffer_load_dwordx4 v[224:227], v0, s[24:27], s77 offen offset:0 sc1
    s_waitcnt lgkmcnt(6)
    v_mfma_f32_32x32x16_bf16 v[64:79], v[24:27], v[164:167], v[64:79]
    ds_read_b64_tr_b16 v[20:21], v5 offset:18560
    ds_read_b64_tr_b16 v[22:23], v5 offset:19072
    buffer_load_dwordx4 v[228:231], v0, s[24:27], s77 offen offset:1024 sc1
    s_waitcnt lgkmcnt(6)
    v_mfma_f32_32x32x16_bf16 v[64:79], v[28:31], v[168:171], v[64:79]
    ds_read_b64_tr_b16 v[24:25], v5 offset:20608
    ds_read_b64_tr_b16 v[26:27], v5 offset:21120
    buffer_load_dwordx4 v[232:235], v0, s[24:27], s77 offen offset:2048 sc1
    s_waitcnt lgkmcnt(6)
    v_mfma_f32_32x32x16_bf16 v[64:79], v[12:15], v[172:175], v[64:79]
    ds_read_b64_tr_b16 v[28:29], v5 offset:22656
    ds_read_b64_tr_b16 v[30:31], v5 offset:23168
    buffer_load_dwordx4 v[236:239], v0, s[24:27], s77 offen offset:3072 sc1
    s_waitcnt lgkmcnt(6)
    v_mfma_f32_32x32x16_bf16 v[80:95], v[16:19], v[192:195], v[80:95]
    ds_read_b64_tr_b16 v[12:13], v6 offset:16512
    ds_read_b64_tr_b16 v[14:15], v6 offset:17024
    s_mul_i32 s78, s81, s37
    s_add_u32 m0, s6, 32896
    s_add_u32 s79, s78, s34
    buffer_load_dwordx4 v1, s[8:11], s79 offen lds
    s_waitcnt lgkmcnt(6)
    v_mfma_f32_32x32x16_bf16 v[80:95], v[20:23], v[196:199], v[80:95]
    ds_read_b64_tr_b16 v[16:17], v6 offset:18560
    ds_read_b64_tr_b16 v[18:19], v6 offset:19072
    s_mul_i32 s78, s81, s38
    s_add_u32 m0, s7, 32896
    s_add_u32 s79, s78, s35
    buffer_load_dwordx4 v9, s[12:15], s79 offen lds
    s_waitcnt lgkmcnt(6)
    v_mfma_f32_32x32x16_bf16 v[80:95], v[24:27], v[200:203], v[80:95]
    ds_read_b64_tr_b16 v[20:21], v6 offset:20608
    ds_read_b64_tr_b16 v[22:23], v6 offset:21120
    s_waitcnt lgkmcnt(6)
    v_mfma_f32_32x32x16_bf16 v[80:95], v[28:31], v[204:207], v[80:95]
    ds_read_b64_tr_b16 v[24:25], v6 offset:22656
    ds_read_b64_tr_b16 v[26:27], v6 offset:23168
    s_waitcnt lgkmcnt(6)
    v_mfma_f32_32x32x16_bf16 v[96:111], v[12:15], v[192:195], v[96:111]
    ds_read_b64_tr_b16 v[28:29], v5 offset:16448
    ds_read_b64_tr_b16 v[30:31], v5 offset:16960
    s_waitcnt lgkmcnt(6)
    v_mfma_f32_32x32x16_bf16 v[96:111], v[16:19], v[196:199], v[96:111]
    ds_read_b64_tr_b16 v[12:13], v5 offset:18496
    ds_read_b64_tr_b16 v[14:15], v5 offset:19008
    s_waitcnt lgkmcnt(6)
    v_mfma_f32_32x32x16_bf16 v[96:111], v[20:23], v[200:203], v[96:111]
    ds_read_b64_tr_b16 v[16:17], v5 offset:20544
    ds_read_b64_tr_b16 v[18:19], v5 offset:21056
    s_waitcnt lgkmcnt(6)
    v_mfma_f32_32x32x16_bf16 v[96:111], v[24:27], v[204:207], v[96:111]
    ds_read_b64_tr_b16 v[20:21], v5 offset:22592
    ds_read_b64_tr_b16 v[22:23], v5 offset:23104
    s_waitcnt lgkmcnt(6)
    v_mfma_f32_32x32x16_bf16 v[48:63], v[28:31], v[192:195], v[48:63]
    ds_read_b64_tr_b16 v[24:25], v6 offset:0
    ds_read_b64_tr_b16 v[26:27], v6 offset:512
    s_waitcnt lgkmcnt(6)
    v_mfma_f32_32x32x16_bf16 v[48:63], v[12:15], v[196:199], v[48:63]
    ds_read_b64_tr_b16 v[28:29], v6 offset:2048
    ds_read_b64_tr_b16 v[30:31], v6 offset:2560
    s_waitcnt lgkmcnt(6)
    v_mfma_f32_32x32x16_bf16 v[48:63], v[16:19], v[200:203], v[48:63]
    ds_read_b64_tr_b16 v[12:13], v6 offset:4096
    ds_read_b64_tr_b16 v[14:15], v6 offset:4608
    s_waitcnt lgkmcnt(6)
    v_mfma_f32_32x32x16_bf16 v[48:63], v[20:23], v[204:207], v[48:63]
    ds_read_b64_tr_b16 v[16:17], v6 offset:6144
    ds_read_b64_tr_b16 v[18:19], v6 offset:6656
    s_waitcnt vmcnt(6)
    s_barrier
    s_waitcnt lgkmcnt(6)
    v_mfma_f32_32x32x16_bf16 v[64:79], v[24:27], v[176:179], v[64:79]
    ds_read_b64_tr_b16 v[20:21], v5 offset:32960
    ds_read_b64_tr_b16 v[22:23], v5 offset:33472
    s_lshl_b32 s77, s88, 12
    s_add_u32 s77, s77, s39
    buffer_load_dwordx4 v[240:243], v0, s[24:27], s77 offen offset:0 sc1
    s_waitcnt lgkmcnt(6)
    v_mfma_f32_32x32x16_bf16 v[64:79], v[28:31], v[180:183], v[64:79]
    ds_read_b64_tr_b16 v[24:25], v5 offset:35008
    ds_read_b64_tr_b16 v[26:27], v5 offset:35520
    buffer_load_dwordx4 v[244:247], v0, s[24:27], s77 offen offset:1024 sc1
    s_waitcnt lgkmcnt(6)
    v_mfma_f32_32x32x16_bf16 v[64:79], v[12:15], v[184:187], v[64:79]
    ds_read_b64_tr_b16 v[28:29], v5 offset:37056
    ds_read_b64_tr_b16 v[30:31], v5 offset:37568
    buffer_load_dwordx4 v[248:251], v0, s[24:27], s77 offen offset:2048 sc1
    s_waitcnt lgkmcnt(6)
    v_mfma_f32_32x32x16_bf16 v[64:79], v[16:19], v[188:191], v[64:79]
    ds_read_b64_tr_b16 v[12:13], v5 offset:39104
    ds_read_b64_tr_b16 v[14:15], v5 offset:39616
    buffer_load_dwordx4 v[252:255], v0, s[24:27], s77 offen offset:3072 sc1
    s_waitcnt lgkmcnt(6)
    v_mfma_f32_32x32x16_bf16 v[80:95], v[20:23], v[208:211], v[80:95]
    ds_read_b64_tr_b16 v[16:17], v6 offset:32960
    ds_read_b64_tr_b16 v[18:19], v6 offset:33472
    s_mul_i32 s78, s82, s37
    s_add_u32 m0, s6, 49344
    s_add_u32 s79, s78, s34
    buffer_load_dwordx4 v1, s[8:11], s79 offen lds
    s_waitcnt lgkmcnt(6)
    v_mfma_f32_32x32x16_bf16 v[80:95], v[24:27], v[212:215], v[80:95]
    ds_read_b64_tr_b16 v[20:21], v6 offset:35008
    ds_read_b64_tr_b16 v[22:23], v6 offset:35520
    s_mul_i32 s78, s82, s38
    s_add_u32 m0, s7, 49344
    s_add_u32 s79, s78, s35
    buffer_load_dwordx4 v9, s[12:15], s79 offen lds
    s_waitcnt lgkmcnt(6)
    v_mfma_f32_32x32x16_bf16 v[80:95], v[28:31], v[216:219], v[80:95]
    ds_read_b64_tr_b16 v[24:25], v6 offset:37056
    ds_read_b64_tr_b16 v[26:27], v6 offset:37568
    s_waitcnt lgkmcnt(6)
    v_mfma_f32_32x32x16_bf16 v[80:95], v[12:15], v[220:223], v[80:95]
    ds_read_b64_tr_b16 v[28:29], v6 offset:39104
    ds_read_b64_tr_b16 v[30:31], v6 offset:39616
    s_waitcnt lgkmcnt(6)
    v_mfma_f32_32x32x16_bf16 v[96:111], v[16:19], v[208:211], v[96:111]
    ds_read_b64_tr_b16 v[12:13], v5 offset:32896
    ds_read_b64_tr_b16 v[14:15], v5 offset:33408
    s_waitcnt lgkmcnt(6)
    v_mfma_f32_32x32x16_bf16 v[96:111], v[20:23], v[212:215], v[96:111]
    ds_read_b64_tr_b16 v[16:17], v5 offset:34944
    ds_read_b64_tr_b16 v[18:19], v5 offset:35456
    s_waitcnt lgkmcnt(6)
    v_mfma_f32_32x32x16_bf16 v[96:111], v[24:27], v[216:219], v[96:111]
    ds_read_b64_tr_b16 v[20:21], v5 offset:36992
    ds_read_b64_tr_b16 v[22:23], v5 offset:37504
    s_waitcnt lgkmcnt(6)
    v_mfma_f32_32x32x16_bf16 v[96:111], v[28:31], v[220:223], v[96:111]
    ds_read_b64_tr_b16 v[24:25], v5 offset:39040
    ds_read_b64_tr_b16 v[26:27], v5 offset:39552
    s_waitcnt lgkmcnt(6)
    v_mfma_f32_32x32x16_bf16 v[48:63], v[12:15], v[208:211], v[48:63]
    ds_read_b64_tr_b16 v[28:29], v6 offset:16448
    ds_read_b64_tr_b16 v[30:31], v6 offset:16960
    s_waitcnt lgkmcnt(6)
    v_mfma_f32_32x32x16_bf16 v[48:63], v[16:19], v[212:215], v[48:63]
    ds_read_b64_tr_b16 v[12:13], v6 offset:18496
    ds_read_b64_tr_b16 v[14:15], v6 offset:19008
    s_waitcnt lgkmcnt(6)
    v_mfma_f32_32x32x16_bf16 v[48:63], v[20:23], v[216:219], v[48:63]
    ds_read_b64_tr_b16 v[16:17], v6 offset:20544
    ds_read_b64_tr_b16 v[18:19], v6 offset:21056
    s_waitcnt lgkmcnt(6)
    v_mfma_f32_32x32x16_bf16 v[48:63], v[24:27], v[220:223], v[48:63]
    ds_read_b64_tr_b16 v[20:21], v6 offset:22592
    ds_read_b64_tr_b16 v[22:23], v6 offset:23104
    s_waitcnt vmcnt(6)
    s_barrier
    s_waitcnt lgkmcnt(6)
    v_mfma_f32_32x32x16_bf16 v[64:79], v[28:31], v[192:195], v[64:79]
    ds_read_b64_tr_b16 v[24:25], v5 offset:49408
    ds_read_b64_tr_b16 v[26:27], v5 offset:49920
    s_mul_i32 s78, s83, s37
    s_add_u32 m0, s6, 65792
    s_add_u32 s79, s78, s34
    buffer_load_dwordx4 v1, s[8:11], s79 offen lds
    s_waitcnt lgkmcnt(6)
    v_mfma_f32_32x32x16_bf16 v[64:79], v[12:15], v[196:199], v[64:79]
    ds_read_b64_tr_b16 v[28:29], v5 offset:51456
    ds_read_b64_tr_b16 v[30:31], v5 offset:51968
    s_mul_i32 s78, s83, s38
    s_add_u32 m0, s7, 65792
    s_add_u32 s79, s78, s35
    buffer_load_dwordx4 v9, s[12:15], s79 offen lds
    s_waitcnt lgkmcnt(6)
    v_mfma_f32_32x32x16_bf16 v[64:79], v[16:19], v[200:203], v[64:79]
    ds_read_b64_tr_b16 v[12:13], v5 offset:53504
    ds_read_b64_tr_b16 v[14:15], v5 offset:54016
    s_waitcnt lgkmcnt(6)
    v_mfma_f32_32x32x16_bf16 v[64:79], v[20:23], v[204:207], v[64:79]
    ds_read_b64_tr_b16 v[16:17], v5 offset:55552
    ds_read_b64_tr_b16 v[18:19], v5 offset:56064
    s_waitcnt lgkmcnt(6)
    v_mfma_f32_32x32x16_bf16 v[80:95], v[24:27], v[224:227], v[80:95]
    ds_read_b64_tr_b16 v[20:21], v6 offset:49408
    ds_read_b64_tr_b16 v[22:23], v6 offset:49920
    s_waitcnt lgkmcnt(6)
    v_mfma_f32_32x32x16_bf16 v[80:95], v[28:31], v[228:231], v[80:95]
    ds_read_b64_tr_b16 v[24:25], v6 offset:51456
    ds_read_b64_tr_b16 v[26:27], v6 offset:51968
    s_waitcnt lgkmcnt(6)
    v_mfma_f32_32x32x16_bf16 v[80:95], v[12:15], v[232:235], v[80:95]
    ds_read_b64_tr_b16 v[28:29], v6 offset:53504
    ds_read_b64_tr_b16 v[30:31], v6 offset:54016
    s_waitcnt lgkmcnt(6)
    v_mfma_f32_32x32x16_bf16 v[80:95], v[16:19], v[236:239], v[80:95]
    ds_read_b64_tr_b16 v[12:13], v6 offset:55552
    ds_read_b64_tr_b16 v[14:15], v6 offset:56064
    s_waitcnt lgkmcnt(6)
    v_mfma_f32_32x32x16_bf16 v[96:111], v[20:23], v[224:227], v[96:111]
    ds_read_b64_tr_b16 v[16:17], v5 offset:49344
    ds_read_b64_tr_b16 v[18:19], v5 offset:49856
    s_waitcnt lgkmcnt(6)
    v_mfma_f32_32x32x16_bf16 v[96:111], v[24:27], v[228:231], v[96:111]
    ds_read_b64_tr_b16 v[20:21], v5 offset:51392
    ds_read_b64_tr_b16 v[22:23], v5 offset:51904
    s_waitcnt lgkmcnt(6)
    v_mfma_f32_32x32x16_bf16 v[96:111], v[28:31], v[232:235], v[96:111]
    ds_read_b64_tr_b16 v[24:25], v5 offset:53440
    ds_read_b64_tr_b16 v[26:27], v5 offset:53952
    s_waitcnt lgkmcnt(6)
    v_mfma_f32_32x32x16_bf16 v[96:111], v[12:15], v[236:239], v[96:111]
    ds_read_b64_tr_b16 v[28:29], v5 offset:55488
    ds_read_b64_tr_b16 v[30:31], v5 offset:56000
    s_waitcnt lgkmcnt(6)
    v_mfma_f32_32x32x16_bf16 v[48:63], v[16:19], v[224:227], v[48:63]
    ds_read_b64_tr_b16 v[12:13], v6 offset:32896
    ds_read_b64_tr_b16 v[14:15], v6 offset:33408
    s_waitcnt lgkmcnt(6)
    v_mfma_f32_32x32x16_bf16 v[48:63], v[20:23], v[228:231], v[48:63]
    ds_read_b64_tr_b16 v[16:17], v6 offset:34944
    ds_read_b64_tr_b16 v[18:19], v6 offset:35456
    s_waitcnt lgkmcnt(6)
    v_mfma_f32_32x32x16_bf16 v[48:63], v[24:27], v[232:235], v[48:63]
    ds_read_b64_tr_b16 v[20:21], v6 offset:36992
    ds_read_b64_tr_b16 v[22:23], v6 offset:37504
    s_waitcnt lgkmcnt(6)
    v_mfma_f32_32x32x16_bf16 v[48:63], v[28:31], v[236:239], v[48:63]
    ds_read_b64_tr_b16 v[24:25], v6 offset:39040
    ds_read_b64_tr_b16 v[26:27], v6 offset:39552
    s_waitcnt vmcnt(2)
    s_barrier
    s_waitcnt lgkmcnt(6)
    v_mfma_f32_32x32x16_bf16 v[64:79], v[12:15], v[208:211], v[64:79]
    ds_read_b64_tr_b16 v[28:29], v3 offset:64
    ds_read_b64_tr_b16 v[30:31], v3 offset:576
    s_mul_i32 s78, s84, s37
    s_add_u32 m0, s6, 82240
    s_add_u32 s79, s78, s34
    buffer_load_dwordx4 v1, s[8:11], s79 offen lds
    s_waitcnt lgkmcnt(6)
    v_mfma_f32_32x32x16_bf16 v[64:79], v[16:19], v[212:215], v[64:79]
    ds_read_b64_tr_b16 v[12:13], v3 offset:2112
    ds_read_b64_tr_b16 v[14:15], v3 offset:2624
    s_mul_i32 s78, s84, s38
    s_add_u32 m0, s7, 82240
    s_add_u32 s79, s78, s35
    buffer_load_dwordx4 v9, s[12:15], s79 offen lds
    s_waitcnt lgkmcnt(6)
    v_mfma_f32_32x32x16_bf16 v[64:79], v[20:23], v[216:219], v[64:79]
    ds_read_b64_tr_b16 v[16:17], v3 offset:4160
    ds_read_b64_tr_b16 v[18:19], v3 offset:4672
    s_waitcnt lgkmcnt(6)
    v_mfma_f32_32x32x16_bf16 v[64:79], v[24:27], v[220:223], v[64:79]
    ds_read_b64_tr_b16 v[20:21], v3 offset:6208
    ds_read_b64_tr_b16 v[22:23], v3 offset:6720
    s_waitcnt lgkmcnt(6)
    v_mfma_f32_32x32x16_bf16 v[80:95], v[28:31], v[240:243], v[80:95]
    ds_read_b64_tr_b16 v[24:25], v4 offset:64
    ds_read_b64_tr_b16 v[26:27], v4 offset:576
    s_waitcnt lgkmcnt(6)
    v_mfma_f32_32x32x16_bf16 v[80:95], v[12:15], v[244:247], v[80:95]
    ds_read_b64_tr_b16 v[28:29], v4 offset:2112
    ds_read_b64_tr_b16 v[30:31], v4 offset:2624
    s_waitcnt lgkmcnt(6)
    v_mfma_f32_32x32x16_bf16 v[80:95], v[16:19], v[248:251], v[80:95]
    ds_read_b64_tr_b16 v[12:13], v4 offset:4160
    ds_read_b64_tr_b16 v[14:15], v4 offset:4672
    s_waitcnt lgkmcnt(6)
    v_mfma_f32_32x32x16_bf16 v[80:95], v[20:23], v[252:255], v[80:95]
    ds_read_b64_tr_b16 v[16:17], v4 offset:6208
    ds_read_b64_tr_b16 v[18:19], v4 offset:6720
    s_waitcnt lgkmcnt(6)
    v_mfma_f32_32x32x16_bf16 v[96:111], v[24:27], v[240:243], v[96:111]
    ds_read_b64_tr_b16 v[20:21], v3 offset:0
    ds_read_b64_tr_b16 v[22:23], v3 offset:512
    s_waitcnt lgkmcnt(6)
    v_mfma_f32_32x32x16_bf16 v[96:111], v[28:31], v[244:247], v[96:111]
    ds_read_b64_tr_b16 v[24:25], v3 offset:2048
    ds_read_b64_tr_b16 v[26:27], v3 offset:2560
    s_waitcnt lgkmcnt(6)
    v_mfma_f32_32x32x16_bf16 v[96:111], v[12:15], v[248:251], v[96:111]
    ds_read_b64_tr_b16 v[28:29], v3 offset:4096
    ds_read_b64_tr_b16 v[30:31], v3 offset:4608
    v_mul_f32 v40, v80, v88
    v_mul_f32 v41, v81, v89
    v_mul_f32 v42, v82, v90
    v_mul_f32 v43, v83, v91
    s_waitcnt lgkmcnt(6)
    v_mfma_f32_32x32x16_bf16 v[96:111], v[16:19], v[252:255], v[96:111]
    ds_read_b64_tr_b16 v[12:13], v3 offset:6144
    ds_read_b64_tr_b16 v[14:15], v3 offset:6656
    v_mul_f32 v44, v84, v92
    v_mul_f32 v45, v85, v93
    v_mul_f32 v46, v86, v94
    v_mul_f32 v47, v87, v95
    s_waitcnt lgkmcnt(6)
    v_mfma_f32_32x32x16_bf16 v[48:63], v[20:23], v[240:243], v[48:63]
    ds_read_b64_tr_b16 v[16:17], v3 offset:16512
    ds_read_b64_tr_b16 v[18:19], v3 offset:17024
    v_mul_f32 v32, s46, v80
    v_mul_f32 v33, s46, v81
    v_mul_f32 v34, s46, v82
    v_mul_f32 v35, s46, v83
    s_waitcnt lgkmcnt(6)
    v_mfma_f32_32x32x16_bf16 v[48:63], v[24:27], v[244:247], v[48:63]
    ds_read_b64_tr_b16 v[20:21], v3 offset:18560
    ds_read_b64_tr_b16 v[22:23], v3 offset:19072
    v_mul_f32 v36, s46, v84
    v_mul_f32 v37, s46, v85
    v_mul_f32 v38, s46, v86
    v_mul_f32 v39, s46, v87
    s_waitcnt lgkmcnt(6)
    v_mfma_f32_32x32x16_bf16 v[48:63], v[28:31], v[248:251], v[48:63]
    ds_read_b64_tr_b16 v[24:25], v3 offset:20608
    ds_read_b64_tr_b16 v[26:27], v3 offset:21120
    v_exp_f32 v32, v32
    v_exp_f32 v33, v33
    v_exp_f32 v34, v34
    v_exp_f32 v35, v35
    s_waitcnt lgkmcnt(6)
    v_mfma_f32_32x32x16_bf16 v[48:63], v[12:15], v[252:255], v[48:63]
    ds_read_b64_tr_b16 v[28:29], v3 offset:22656
    ds_read_b64_tr_b16 v[30:31], v3 offset:23168
    v_exp_f32 v36, v36
    v_exp_f32 v37, v37
    v_exp_f32 v38, v38
    v_exp_f32 v39, v39
    s_waitcnt vmcnt(2)
    s_barrier
    s_waitcnt lgkmcnt(6)
    v_mfma_f32_32x32x16_bf16 v[80:95], v[16:19], v[112:115], 0
    ds_read_b64_tr_b16 v[12:13], v3 offset:32960
    ds_read_b64_tr_b16 v[14:15], v3 offset:33472
    s_mul_i32 s78, s85, s37
    s_add_u32 m0, s6, 98688
    s_add_u32 s79, s78, s34
    buffer_load_dwordx4 v1, s[8:11], s79 offen lds
    v_add_f32 v32, 1.0, v32
    v_add_f32 v33, 1.0, v33
    v_add_f32 v34, 1.0, v34
    v_add_f32 v35, 1.0, v35
    s_waitcnt lgkmcnt(6)
    v_mfma_f32_32x32x16_bf16 v[80:95], v[20:23], v[116:119], v[80:95]
    ds_read_b64_tr_b16 v[16:17], v3 offset:35008
    ds_read_b64_tr_b16 v[18:19], v3 offset:35520
    s_mul_i32 s78, s85, s38
    s_add_u32 m0, s7, 98688
    s_add_u32 s79, s78, s35
    buffer_load_dwordx4 v9, s[12:15], s79 offen lds
    v_add_f32 v36, 1.0, v36
    v_add_f32 v37, 1.0, v37
    v_add_f32 v38, 1.0, v38
    v_add_f32 v39, 1.0, v39
    s_waitcnt lgkmcnt(6)
    v_mfma_f32_32x32x16_bf16 v[80:95], v[24:27], v[120:123], v[80:95]
    ds_read_b64_tr_b16 v[20:21], v3 offset:37056
    ds_read_b64_tr_b16 v[22:23], v3 offset:37568
    v_rcp_f32 v32, v32
    v_rcp_f32 v33, v33
    v_rcp_f32 v34, v34
    v_rcp_f32 v35, v35
    s_waitcnt lgkmcnt(6)
    v_mfma_f32_32x32x16_bf16 v[80:95], v[28:31], v[124:127], v[80:95]
    ds_read_b64_tr_b16 v[24:25], v3 offset:39104
    ds_read_b64_tr_b16 v[26:27], v3 offset:39616
    v_rcp_f32 v36, v36
    v_rcp_f32 v37, v37
    v_rcp_f32 v38, v38
    v_rcp_f32 v39, v39
    s_waitcnt lgkmcnt(6)
    v_mfma_f32_32x32x16_bf16 v[80:95], v[12:15], v[128:131], v[80:95]
    ds_read_b64_tr_b16 v[28:29], v3 offset:49408
    ds_read_b64_tr_b16 v[30:31], v3 offset:49920
    v_mul_f32 v40, v40, v32
    v_mul_f32 v41, v41, v33
    v_mul_f32 v42, v42, v34
    v_mul_f32 v43, v43, v35
    s_waitcnt lgkmcnt(6)
    v_mfma_f32_32x32x16_bf16 v[80:95], v[16:19], v[132:135], v[80:95]
    ds_read_b64_tr_b16 v[12:13], v3 offset:51456
    ds_read_b64_tr_b16 v[14:15], v3 offset:51968
    v_mul_f32 v44, v44, v36
    v_mul_f32 v45, v45, v37
    v_mul_f32 v46, v46, v38
    v_mul_f32 v47, v47, v39
    s_waitcnt lgkmcnt(6)
    v_mfma_f32_32x32x16_bf16 v[80:95], v[20:23], v[136:139], v[80:95]
    ds_read_b64_tr_b16 v[16:17], v3 offset:53504
    ds_read_b64_tr_b16 v[18:19], v3 offset:54016
    v_cvt_pk_bf16_f32 v32, v40, v41
    v_cvt_pk_bf16_f32 v33, v42, v43
    v_cvt_pk_bf16_f32 v34, v44, v45
    v_cvt_pk_bf16_f32 v35, v46, v47
    s_waitcnt lgkmcnt(6)
    v_mfma_f32_32x32x16_bf16 v[80:95], v[24:27], v[140:143], v[80:95]
    ds_read_b64_tr_b16 v[20:21], v3 offset:55552
    ds_read_b64_tr_b16 v[22:23], v3 offset:56064
    buffer_store_dwordx4 v[32:35], v0, s[24:27], s40 offen offset:2048 sc1
    v_mul_f32 v40, v96, v104
    v_mul_f32 v41, v97, v105
    v_mul_f32 v42, v98, v106
    s_waitcnt lgkmcnt(6)
    v_mfma_f32_32x32x16_bf16 v[80:95], v[28:31], v[144:147], v[80:95]
    ds_read_b64_tr_b16 v[24:25], v6 offset:49344
    ds_read_b64_tr_b16 v[26:27], v6 offset:49856
    v_mul_f32 v43, v99, v107
    v_mul_f32 v44, v100, v108
    v_mul_f32 v45, v101, v109
    v_mul_f32 v46, v102, v110
    s_waitcnt lgkmcnt(6)
    v_mfma_f32_32x32x16_bf16 v[80:95], v[12:15], v[148:151], v[80:95]
    ds_read_b64_tr_b16 v[28:29], v6 offset:51392
    ds_read_b64_tr_b16 v[30:31], v6 offset:51904
    v_mul_f32 v47, v103, v111
    v_mul_f32 v32, s46, v96
    v_mul_f32 v33, s46, v97
    v_mul_f32 v34, s46, v98
    s_waitcnt lgkmcnt(6)
    v_mfma_f32_32x32x16_bf16 v[80:95], v[16:19], v[152:155], v[80:95]
    ds_read_b64_tr_b16 v[12:13], v6 offset:53440
    ds_read_b64_tr_b16 v[14:15], v6 offset:53952
    v_mul_f32 v35, s46, v99
    v_mul_f32 v36, s46, v100
    v_mul_f32 v37, s46, v101
    v_mul_f32 v38, s46, v102
    s_waitcnt lgkmcnt(6)
    v_mfma_f32_32x32x16_bf16 v[80:95], v[20:23], v[156:159], v[80:95]
    ds_read_b64_tr_b16 v[16:17], v6 offset:55488
    ds_read_b64_tr_b16 v[18:19], v6 offset:56000
    v_mul_f32 v39, s46, v103
    v_exp_f32 v32, v32
    v_exp_f32 v33, v33
    v_exp_f32 v34, v34
    s_waitcnt lgkmcnt(6)
    v_mfma_f32_32x32x16_bf16 v[64:79], v[24:27], v[224:227], v[64:79]
    ds_read_b64_tr_b16 v[20:21], v4 offset:16512
    ds_read_b64_tr_b16 v[22:23], v4 offset:17024
    v_exp_f32 v35, v35
    v_exp_f32 v36, v36
    v_exp_f32 v37, v37
    v_exp_f32 v38, v38
    s_waitcnt lgkmcnt(6)
    v_mfma_f32_32x32x16_bf16 v[64:79], v[28:31], v[228:231], v[64:79]
    ds_read_b64_tr_b16 v[24:25], v4 offset:18560
    ds_read_b64_tr_b16 v[26:27], v4 offset:19072
    v_exp_f32 v39, v39
    v_add_f32 v32, 1.0, v32
    v_add_f32 v33, 1.0, v33
    v_add_f32 v34, 1.0, v34
    s_waitcnt lgkmcnt(6)
    v_mfma_f32_32x32x16_bf16 v[64:79], v[12:15], v[232:235], v[64:79]
    ds_read_b64_tr_b16 v[28:29], v4 offset:20608
    ds_read_b64_tr_b16 v[30:31], v4 offset:21120
    v_add_f32 v35, 1.0, v35
    v_add_f32 v36, 1.0, v36
    v_add_f32 v37, 1.0, v37
    v_add_f32 v38, 1.0, v38
    s_waitcnt lgkmcnt(6)
    v_mfma_f32_32x32x16_bf16 v[64:79], v[16:19], v[236:239], v[64:79]
    ds_read_b64_tr_b16 v[12:13], v4 offset:22656
    ds_read_b64_tr_b16 v[14:15], v4 offset:23168
    v_add_f32 v39, 1.0, v39
    v_rcp_f32 v32, v32
    v_rcp_f32 v33, v33
    v_rcp_f32 v34, v34
    s_waitcnt vmcnt(3)
    s_barrier
    s_waitcnt lgkmcnt(6)
    v_mfma_f32_32x32x16_bf16 v[96:111], v[20:23], v[112:115], 0
    ds_read_b64_tr_b16 v[16:17], v4 offset:32960
    ds_read_b64_tr_b16 v[18:19], v4 offset:33472
    s_mul_i32 s78, s86, s37
    s_add_u32 m0, s6, 115136
    s_add_u32 s79, s78, s34
    buffer_load_dwordx4 v1, s[8:11], s79 offen lds
    v_rcp_f32 v35, v35
    v_rcp_f32 v36, v36
    v_rcp_f32 v37, v37
    v_rcp_f32 v38, v38
    s_waitcnt lgkmcnt(6)
    v_mfma_f32_32x32x16_bf16 v[96:111], v[24:27], v[116:119], v[96:111]
    ds_read_b64_tr_b16 v[20:21], v4 offset:35008
    ds_read_b64_tr_b16 v[22:23], v4 offset:35520
    s_mul_i32 s78, s86, s38
    s_add_u32 m0, s7, 115136
    s_add_u32 s79, s78, s35
    buffer_load_dwordx4 v9, s[12:15], s79 offen lds
    v_rcp_f32 v39, v39
    v_mul_f32 v40, v40, v32
    v_mul_f32 v41, v41, v33
    v_mul_f32 v42, v42, v34
    s_waitcnt lgkmcnt(6)
    v_mfma_f32_32x32x16_bf16 v[96:111], v[28:31], v[120:123], v[96:111]
    ds_read_b64_tr_b16 v[24:25], v4 offset:37056
    ds_read_b64_tr_b16 v[26:27], v4 offset:37568
    v_mul_f32 v43, v43, v35
    v_mul_f32 v44, v44, v36
    v_mul_f32 v45, v45, v37
    v_mul_f32 v46, v46, v38
    s_waitcnt lgkmcnt(6)
    v_mfma_f32_32x32x16_bf16 v[96:111], v[12:15], v[124:127], v[96:111]
    ds_read_b64_tr_b16 v[28:29], v4 offset:39104
    ds_read_b64_tr_b16 v[30:31], v4 offset:39616
    v_mul_f32 v47, v47, v39
    v_cvt_pk_bf16_f32 v32, v40, v41
    v_cvt_pk_bf16_f32 v33, v42, v43
    v_cvt_pk_bf16_f32 v34, v44, v45
    s_waitcnt lgkmcnt(6)
    v_mfma_f32_32x32x16_bf16 v[96:111], v[16:19], v[128:131], v[96:111]
    ds_read_b64_tr_b16 v[12:13], v5 offset:64
    ds_read_b64_tr_b16 v[14:15], v5 offset:576
    v_cvt_pk_bf16_f32 v35, v46, v47
    buffer_store_dwordx4 v[32:35], v0, s[24:27], s40 offen offset:3072 sc1
    v_mul_f32 v40, v48, v56
    v_mul_f32 v41, v49, v57
    s_waitcnt lgkmcnt(6)
    v_mfma_f32_32x32x16_bf16 v[96:111], v[20:23], v[132:135], v[96:111]
    ds_read_b64_tr_b16 v[16:17], v5 offset:2112
    ds_read_b64_tr_b16 v[18:19], v5 offset:2624
    v_mul_f32 v42, v50, v58
    v_mul_f32 v43, v51, v59
    v_mul_f32 v44, v52, v60
    v_mul_f32 v45, v53, v61
    s_waitcnt lgkmcnt(6)
    v_mfma_f32_32x32x16_bf16 v[96:111], v[24:27], v[136:139], v[96:111]
    ds_read_b64_tr_b16 v[20:21], v5 offset:4160
    ds_read_b64_tr_b16 v[22:23], v5 offset:4672
    v_mul_f32 v46, v54, v62
    v_mul_f32 v47, v55, v63
    v_mul_f32 v32, s46, v48
    v_mul_f32 v33, s46, v49
    s_waitcnt lgkmcnt(6)
    v_mfma_f32_32x32x16_bf16 v[96:111], v[28:31], v[140:143], v[96:111]
    ds_read_b64_tr_b16 v[24:25], v5 offset:6208
    ds_read_b64_tr_b16 v[26:27], v5 offset:6720
    v_mul_f32 v34, s46, v50
    v_mul_f32 v35, s46, v51
    v_mul_f32 v36, s46, v52
    v_mul_f32 v37, s46, v53
    s_waitcnt lgkmcnt(6)
    v_mfma_f32_32x32x16_bf16 v[80:95], v[12:15], v[160:163], v[80:95]
    ds_read_b64_tr_b16 v[28:29], v3 offset:16448
    ds_read_b64_tr_b16 v[30:31], v3 offset:16960
    v_mul_f32 v38, s46, v54
    v_mul_f32 v39, s46, v55
    v_exp_f32 v32, v32
    v_exp_f32 v33, v33
    s_waitcnt lgkmcnt(6)
    v_mfma_f32_32x32x16_bf16 v[80:95], v[16:19], v[164:167], v[80:95]
    ds_read_b64_tr_b16 v[12:13], v3 offset:18496
    ds_read_b64_tr_b16 v[14:15], v3 offset:19008
    v_exp_f32 v34, v34
    v_exp_f32 v35, v35
    v_exp_f32 v36, v36
    v_exp_f32 v37, v37
    s_waitcnt lgkmcnt(6)
    v_mfma_f32_32x32x16_bf16 v[80:95], v[20:23], v[168:171], v[80:95]
    ds_read_b64_tr_b16 v[16:17], v3 offset:20544
    ds_read_b64_tr_b16 v[18:19], v3 offset:21056
    v_exp_f32 v38, v38
    v_exp_f32 v39, v39
    v_add_f32 v32, 1.0, v32
    v_add_f32 v33, 1.0, v33
    s_waitcnt lgkmcnt(6)
    v_mfma_f32_32x32x16_bf16 v[80:95], v[24:27], v[172:175], v[80:95]
    ds_read_b64_tr_b16 v[20:21], v3 offset:22592
    ds_read_b64_tr_b16 v[22:23], v3 offset:23104
    v_add_f32 v34, 1.0, v34
    v_add_f32 v35, 1.0, v35
    v_add_f32 v36, 1.0, v36
    v_add_f32 v37, 1.0, v37
    s_waitcnt lgkmcnt(6)
    v_mfma_f32_32x32x16_bf16 v[48:63], v[28:31], v[112:115], 0
    ds_read_b64_tr_b16 v[24:25], v4 offset:49408
    ds_read_b64_tr_b16 v[26:27], v4 offset:49920
    v_add_f32 v38, 1.0, v38
    v_add_f32 v39, 1.0, v39
    v_rcp_f32 v32, v32
    v_rcp_f32 v33, v33
    s_waitcnt lgkmcnt(6)
    v_mfma_f32_32x32x16_bf16 v[48:63], v[12:15], v[116:119], v[48:63]
    ds_read_b64_tr_b16 v[28:29], v4 offset:51456
    ds_read_b64_tr_b16 v[30:31], v4 offset:51968
    v_rcp_f32 v34, v34
    v_rcp_f32 v35, v35
    v_rcp_f32 v36, v36
    v_rcp_f32 v37, v37
    s_waitcnt lgkmcnt(6)
    v_mfma_f32_32x32x16_bf16 v[48:63], v[16:19], v[120:123], v[48:63]
    ds_read_b64_tr_b16 v[12:13], v4 offset:53504
    ds_read_b64_tr_b16 v[14:15], v4 offset:54016
    v_rcp_f32 v38, v38
    v_rcp_f32 v39, v39
    v_mul_f32 v40, v40, v32
    v_mul_f32 v41, v41, v33
    s_waitcnt lgkmcnt(6)
    v_mfma_f32_32x32x16_bf16 v[48:63], v[20:23], v[124:127], v[48:63]
    ds_read_b64_tr_b16 v[16:17], v4 offset:55552
    ds_read_b64_tr_b16 v[18:19], v4 offset:56064
    v_mul_f32 v42, v42, v34
    v_mul_f32 v43, v43, v35
    v_mul_f32 v44, v44, v36
    v_mul_f32 v45, v45, v37
    s_waitcnt vmcnt(4)
    s_barrier
    s_waitcnt lgkmcnt(6)
    v_mfma_f32_32x32x16_bf16 v[96:111], v[24:27], v[144:147], v[96:111]
    ds_read_b64_tr_b16 v[20:21], v3 offset:32896
    ds_read_b64_tr_b16 v[22:23], v3 offset:33408
    v_mul_f32 v46, v46, v38
    v_mul_f32 v47, v47, v39
    v_cvt_pk_bf16_f32 v32, v40, v41
    v_cvt_pk_bf16_f32 v33, v42, v43
    s_waitcnt lgkmcnt(6)
    v_mfma_f32_32x32x16_bf16 v[96:111], v[28:31], v[148:151], v[96:111]
    ds_read_b64_tr_b16 v[24:25], v3 offset:34944
    ds_read_b64_tr_b16 v[26:27], v3 offset:35456
    v_cvt_pk_bf16_f32 v34, v44, v45
    v_cvt_pk_bf16_f32 v35, v46, v47
    buffer_store_dwordx4 v[32:35], v0, s[24:27], s40 offen offset:0 sc1
    s_waitcnt lgkmcnt(6)
    v_mfma_f32_32x32x16_bf16 v[96:111], v[12:15], v[152:155], v[96:111]
    ds_read_b64_tr_b16 v[28:29], v3 offset:36992
    ds_read_b64_tr_b16 v[30:31], v3 offset:37504
    s_waitcnt lgkmcnt(6)
    v_mfma_f32_32x32x16_bf16 v[96:111], v[16:19], v[156:159], v[96:111]
    ds_read_b64_tr_b16 v[12:13], v3 offset:39040
    ds_read_b64_tr_b16 v[14:15], v3 offset:39552
    s_waitcnt lgkmcnt(6)
    v_mfma_f32_32x32x16_bf16 v[48:63], v[20:23], v[128:131], v[48:63]
    ds_read_b64_tr_b16 v[16:17], v4 offset:0
    ds_read_b64_tr_b16 v[18:19], v4 offset:512
    s_waitcnt lgkmcnt(6)
    v_mfma_f32_32x32x16_bf16 v[48:63], v[24:27], v[132:135], v[48:63]
    ds_read_b64_tr_b16 v[20:21], v4 offset:2048
    ds_read_b64_tr_b16 v[22:23], v4 offset:2560
    s_waitcnt lgkmcnt(6)
    v_mfma_f32_32x32x16_bf16 v[48:63], v[28:31], v[136:139], v[48:63]
    ds_read_b64_tr_b16 v[24:25], v4 offset:4096
    ds_read_b64_tr_b16 v[26:27], v4 offset:4608
    s_waitcnt lgkmcnt(6)
    v_mfma_f32_32x32x16_bf16 v[48:63], v[12:15], v[140:143], v[48:63]
    ds_read_b64_tr_b16 v[28:29], v4 offset:6144
    ds_read_b64_tr_b16 v[30:31], v4 offset:6656
    s_waitcnt lgkmcnt(6)
    v_mfma_f32_32x32x16_bf16 v[64:79], v[16:19], v[240:243], v[64:79]
    ds_read_b64_tr_b16 v[12:13], v5 offset:16512
    ds_read_b64_tr_b16 v[14:15], v5 offset:17024
    s_waitcnt lgkmcnt(6)
    v_mfma_f32_32x32x16_bf16 v[64:79], v[20:23], v[244:247], v[64:79]
    ds_read_b64_tr_b16 v[16:17], v5 offset:18560
    ds_read_b64_tr_b16 v[18:19], v5 offset:19072
    s_waitcnt lgkmcnt(6)
    v_mfma_f32_32x32x16_bf16 v[64:79], v[24:27], v[248:251], v[64:79]
    ds_read_b64_tr_b16 v[20:21], v5 offset:20608
    ds_read_b64_tr_b16 v[22:23], v5 offset:21120
    s_waitcnt lgkmcnt(6)
    v_mfma_f32_32x32x16_bf16 v[64:79], v[28:31], v[252:255], v[64:79]
    ds_read_b64_tr_b16 v[24:25], v5 offset:22656
    ds_read_b64_tr_b16 v[26:27], v5 offset:23168
    s_waitcnt lgkmcnt(6)
    v_mfma_f32_32x32x16_bf16 v[80:95], v[12:15], v[176:179], v[80:95]
    ds_read_b64_tr_b16 v[28:29], v6 offset:64
    ds_read_b64_tr_b16 v[30:31], v6 offset:576
    s_waitcnt lgkmcnt(6)
    v_mfma_f32_32x32x16_bf16 v[80:95], v[16:19], v[180:183], v[80:95]
    ds_read_b64_tr_b16 v[12:13], v6 offset:2112
    ds_read_b64_tr_b16 v[14:15], v6 offset:2624
    s_waitcnt lgkmcnt(6)
    v_mfma_f32_32x32x16_bf16 v[80:95], v[20:23], v[184:187], v[80:95]
    ds_read_b64_tr_b16 v[16:17], v6 offset:4160
    ds_read_b64_tr_b16 v[18:19], v6 offset:4672
    v_mul_f32 v40, v64, v72
    v_mul_f32 v41, v65, v73
    v_mul_f32 v42, v66, v74
    v_mul_f32 v43, v67, v75
    s_waitcnt lgkmcnt(6)
    v_mfma_f32_32x32x16_bf16 v[80:95], v[24:27], v[188:191], v[80:95]
    ds_read_b64_tr_b16 v[20:21], v6 offset:6208
    ds_read_b64_tr_b16 v[22:23], v6 offset:6720
    v_mul_f32 v44, v68, v76
    v_mul_f32 v45, v69, v77
    v_mul_f32 v46, v70, v78
    v_mul_f32 v47, v71, v79
    s_waitcnt vmcnt(2)
    s_barrier
    s_waitcnt lgkmcnt(6)
    v_mfma_f32_32x32x16_bf16 v[96:111], v[28:31], v[160:163], v[96:111]
    ds_read_b64_tr_b16 v[24:25], v3 offset:49344
    ds_read_b64_tr_b16 v[26:27], v3 offset:49856
    s_mul_i32 s78, s87, s37
    s_add_u32 m0, s6, 0
    s_add_u32 s79, s78, s34
    buffer_load_dwordx4 v1, s[8:11], s79 offen lds
    v_mul_f32 v32, s46, v64
    v_mul_f32 v33, s46, v65
    v_mul_f32 v34, s46, v66
    v_mul_f32 v35, s46, v67
    s_waitcnt lgkmcnt(6)
    v_mfma_f32_32x32x16_bf16 v[96:111], v[12:15], v[164:167], v[96:111]
    ds_read_b64_tr_b16 v[28:29], v3 offset:51392
    ds_read_b64_tr_b16 v[30:31], v3 offset:51904
    s_mul_i32 s78, s87, s38
    s_add_u32 m0, s7, 0
    s_add_u32 s79, s78, s35
    buffer_load_dwordx4 v9, s[12:15], s79 offen lds
    v_mul_f32 v36, s46, v68
    v_mul_f32 v37, s46, v69
    v_mul_f32 v38, s46, v70
    v_mul_f32 v39, s46, v71
    s_waitcnt lgkmcnt(6)
    v_mfma_f32_32x32x16_bf16 v[96:111], v[16:19], v[168:171], v[96:111]
    ds_read_b64_tr_b16 v[12:13], v3 offset:53440
    ds_read_b64_tr_b16 v[14:15], v3 offset:53952
    v_exp_f32 v32, v32
    v_exp_f32 v33, v33
    v_exp_f32 v34, v34
    v_exp_f32 v35, v35
    s_waitcnt lgkmcnt(6)
    v_mfma_f32_32x32x16_bf16 v[96:111], v[20:23], v[172:175], v[96:111]
    ds_read_b64_tr_b16 v[16:17], v3 offset:55488
    ds_read_b64_tr_b16 v[18:19], v3 offset:56000
    v_exp_f32 v36, v36
    v_exp_f32 v37, v37
    v_exp_f32 v38, v38
    v_exp_f32 v39, v39
    s_waitcnt lgkmcnt(6)
    v_mfma_f32_32x32x16_bf16 v[48:63], v[24:27], v[144:147], v[48:63]
    ds_read_b64_tr_b16 v[20:21], v4 offset:16448
    ds_read_b64_tr_b16 v[22:23], v4 offset:16960
    v_add_f32 v32, 1.0, v32
    v_add_f32 v33, 1.0, v33
    v_add_f32 v34, 1.0, v34
    v_add_f32 v35, 1.0, v35
    s_waitcnt lgkmcnt(6)
    v_mfma_f32_32x32x16_bf16 v[48:63], v[28:31], v[148:151], v[48:63]
    ds_read_b64_tr_b16 v[24:25], v4 offset:18496
    ds_read_b64_tr_b16 v[26:27], v4 offset:19008
    v_add_f32 v36, 1.0, v36
    v_add_f32 v37, 1.0, v37
    v_add_f32 v38, 1.0, v38
    v_add_f32 v39, 1.0, v39
    s_waitcnt lgkmcnt(6)
    v_mfma_f32_32x32x16_bf16 v[48:63], v[12:15], v[152:155], v[48:63]
    ds_read_b64_tr_b16 v[28:29], v4 offset:20544
    ds_read_b64_tr_b16 v[30:31], v4 offset:21056
    v_rcp_f32 v32, v32
    v_rcp_f32 v33, v33
    v_rcp_f32 v34, v34
    v_rcp_f32 v35, v35
    s_waitcnt lgkmcnt(6)
    v_mfma_f32_32x32x16_bf16 v[48:63], v[16:19], v[156:159], v[48:63]
    ds_read_b64_tr_b16 v[12:13], v4 offset:22592
    ds_read_b64_tr_b16 v[14:15], v4 offset:23104
    v_rcp_f32 v36, v36
    v_rcp_f32 v37, v37
    v_rcp_f32 v38, v38
    v_rcp_f32 v39, v39
    s_waitcnt lgkmcnt(6)
    v_mfma_f32_32x32x16_bf16 v[64:79], v[20:23], v[112:115], 0
    ds_read_b64_tr_b16 v[16:17], v5 offset:32960
    ds_read_b64_tr_b16 v[18:19], v5 offset:33472
    v_mul_f32 v40, v40, v32
    v_mul_f32 v41, v41, v33
    v_mul_f32 v42, v42, v34
    v_mul_f32 v43, v43, v35
    s_waitcnt lgkmcnt(6)
    v_mfma_f32_32x32x16_bf16 v[64:79], v[24:27], v[116:119], v[64:79]
    ds_read_b64_tr_b16 v[20:21], v5 offset:35008
    ds_read_b64_tr_b16 v[22:23], v5 offset:35520
    v_mul_f32 v44, v44, v36
    v_mul_f32 v45, v45, v37
    v_mul_f32 v46, v46, v38
    v_mul_f32 v47, v47, v39
    s_waitcnt lgkmcnt(6)
    v_mfma_f32_32x32x16_bf16 v[64:79], v[28:31], v[120:123], v[64:79]
    ds_read_b64_tr_b16 v[24:25], v5 offset:37056
    ds_read_b64_tr_b16 v[26:27], v5 offset:37568
    v_cvt_pk_bf16_f32 v32, v40, v41
    v_cvt_pk_bf16_f32 v33, v42, v43
    v_cvt_pk_bf16_f32 v34, v44, v45
    v_cvt_pk_bf16_f32 v35, v46, v47
    s_waitcnt lgkmcnt(6)
    v_mfma_f32_32x32x16_bf16 v[64:79], v[12:15], v[124:127], v[64:79]
    ds_read_b64_tr_b16 v[28:29], v5 offset:39104
    ds_read_b64_tr_b16 v[30:31], v5 offset:39616
    buffer_store_dwordx4 v[32:35], v0, s[24:27], s40 offen offset:1024 sc1
    s_waitcnt lgkmcnt(6)
    v_mfma_f32_32x32x16_bf16 v[80:95], v[16:19], v[192:195], v[80:95]
    ds_read_b64_tr_b16 v[12:13], v6 offset:16512
    ds_read_b64_tr_b16 v[14:15], v6 offset:17024
    s_waitcnt lgkmcnt(6)
    v_mfma_f32_32x32x16_bf16 v[80:95], v[20:23], v[196:199], v[80:95]
    ds_read_b64_tr_b16 v[16:17], v6 offset:18560
    ds_read_b64_tr_b16 v[18:19], v6 offset:19072
    s_waitcnt lgkmcnt(6)
    v_mfma_f32_32x32x16_bf16 v[80:95], v[24:27], v[200:203], v[80:95]
    ds_read_b64_tr_b16 v[20:21], v6 offset:20608
    ds_read_b64_tr_b16 v[22:23], v6 offset:21120
    s_waitcnt lgkmcnt(6)
    v_mfma_f32_32x32x16_bf16 v[80:95], v[28:31], v[204:207], v[80:95]
    ds_read_b64_tr_b16 v[24:25], v6 offset:22656
    ds_read_b64_tr_b16 v[26:27], v6 offset:23168
    s_barrier
    s_waitcnt lgkmcnt(6)
    v_mfma_f32_32x32x16_bf16 v[96:111], v[12:15], v[176:179], v[96:111]
    ds_read_b64_tr_b16 v[28:29], v5 offset:0
    ds_read_b64_tr_b16 v[30:31], v5 offset:512
    s_mul_i32 s78, s88, s37
    s_add_u32 m0, s6, 16448
    s_add_u32 s79, s78, s34
    buffer_load_dwordx4 v1, s[8:11], s79 offen lds
    s_waitcnt lgkmcnt(6)
    v_mfma_f32_32x32x16_bf16 v[96:111], v[16:19], v[180:183], v[96:111]
    ds_read_b64_tr_b16 v[12:13], v5 offset:2048
    ds_read_b64_tr_b16 v[14:15], v5 offset:2560
    s_mul_i32 s78, s88, s38
    s_add_u32 m0, s7, 16448
    s_add_u32 s79, s78, s35
    buffer_load_dwordx4 v9, s[12:15], s79 offen lds
    s_waitcnt lgkmcnt(6)
    v_mfma_f32_32x32x16_bf16 v[96:111], v[20:23], v[184:187], v[96:111]
    ds_read_b64_tr_b16 v[16:17], v5 offset:4096
    ds_read_b64_tr_b16 v[18:19], v5 offset:4608
    s_waitcnt lgkmcnt(6)
    v_mfma_f32_32x32x16_bf16 v[96:111], v[24:27], v[188:191], v[96:111]
    ds_read_b64_tr_b16 v[20:21], v5 offset:6144
    ds_read_b64_tr_b16 v[22:23], v5 offset:6656
    s_waitcnt lgkmcnt(6)
    v_mfma_f32_32x32x16_bf16 v[48:63], v[28:31], v[160:163], v[48:63]
    ds_read_b64_tr_b16 v[24:25], v4 offset:32896
    ds_read_b64_tr_b16 v[26:27], v4 offset:33408
    s_waitcnt lgkmcnt(6)
    v_mfma_f32_32x32x16_bf16 v[48:63], v[12:15], v[164:167], v[48:63]
    ds_read_b64_tr_b16 v[28:29], v4 offset:34944
    ds_read_b64_tr_b16 v[30:31], v4 offset:35456
    s_waitcnt lgkmcnt(6)
    v_mfma_f32_32x32x16_bf16 v[48:63], v[16:19], v[168:171], v[48:63]
    ds_read_b64_tr_b16 v[12:13], v4 offset:36992
    ds_read_b64_tr_b16 v[14:15], v4 offset:37504
    s_waitcnt lgkmcnt(6)
    v_mfma_f32_32x32x16_bf16 v[48:63], v[20:23], v[172:175], v[48:63]
    ds_read_b64_tr_b16 v[16:17], v4 offset:39040
    ds_read_b64_tr_b16 v[18:19], v4 offset:39552
    s_waitcnt lgkmcnt(6)
    v_mfma_f32_32x32x16_bf16 v[64:79], v[24:27], v[128:131], v[64:79]
    ds_read_b64_tr_b16 v[20:21], v5 offset:49408
    ds_read_b64_tr_b16 v[22:23], v5 offset:49920
    s_waitcnt lgkmcnt(6)
    v_mfma_f32_32x32x16_bf16 v[64:79], v[28:31], v[132:135], v[64:79]
    ds_read_b64_tr_b16 v[24:25], v5 offset:51456
    ds_read_b64_tr_b16 v[26:27], v5 offset:51968
    s_waitcnt lgkmcnt(6)
    v_mfma_f32_32x32x16_bf16 v[64:79], v[12:15], v[136:139], v[64:79]
    ds_read_b64_tr_b16 v[28:29], v5 offset:53504
    ds_read_b64_tr_b16 v[30:31], v5 offset:54016
    s_waitcnt lgkmcnt(6)
    v_mfma_f32_32x32x16_bf16 v[64:79], v[16:19], v[140:143], v[64:79]
    ds_read_b64_tr_b16 v[12:13], v5 offset:55552
    ds_read_b64_tr_b16 v[14:15], v5 offset:56064
    s_waitcnt lgkmcnt(6)
    v_mfma_f32_32x32x16_bf16 v[80:95], v[20:23], v[208:211], v[80:95]
    ds_read_b64_tr_b16 v[16:17], v6 offset:32960
    ds_read_b64_tr_b16 v[18:19], v6 offset:33472
    s_waitcnt lgkmcnt(6)
    v_mfma_f32_32x32x16_bf16 v[80:95], v[24:27], v[212:215], v[80:95]
    ds_read_b64_tr_b16 v[20:21], v6 offset:35008
    ds_read_b64_tr_b16 v[22:23], v6 offset:35520
    s_waitcnt lgkmcnt(6)
    v_mfma_f32_32x32x16_bf16 v[80:95], v[28:31], v[216:219], v[80:95]
    ds_read_b64_tr_b16 v[24:25], v6 offset:37056
    ds_read_b64_tr_b16 v[26:27], v6 offset:37568
    s_waitcnt lgkmcnt(6)
    v_mfma_f32_32x32x16_bf16 v[80:95], v[12:15], v[220:223], v[80:95]
    ds_read_b64_tr_b16 v[28:29], v6 offset:39104
    ds_read_b64_tr_b16 v[30:31], v6 offset:39616
    s_waitcnt vmcnt(2)
    s_barrier
    s_cmp_lg_u32 s3, 0
    s_cbranch_scc1 L_f1a_2
    v_mov_b32 v32, s98
    v_mov_b32 v33, s99
    v_mov_b32 v34, s98
    v_mov_b32 v35, s99
    s_lshl_b32 s55, s100, 7
    s_add_u32 s55, s55, 49315840
    s_mov_b64 exec, 0xff
    buffer_store_dwordx4 v[32:35], v0, s[24:27], s55 offen sc1
    s_mov_b64 exec, -1
L_f1a_2:
    s_waitcnt lgkmcnt(6)
    v_mfma_f32_32x32x16_bf16 v[96:111], v[16:19], v[192:195], v[96:111]
    ds_read_b64_tr_b16 v[12:13], v5 offset:16448
    ds_read_b64_tr_b16 v[14:15], v5 offset:16960
    s_mul_i32 s78, s80, s37
    s_add_u32 m0, s76, 32896
    s_add_u32 s79, s78, s36
    buffer_load_dwordx4 v2, s[16:19], s79 offen lds
    s_waitcnt lgkmcnt(6)
    v_mfma_f32_32x32x16_bf16 v[96:111], v[20:23], v[196:199], v[96:111]
    ds_read_b64_tr_b16 v[16:17], v5 offset:18496
    ds_read_b64_tr_b16 v[18:19], v5 offset:19008
    s_mul_i32 s78, s81, s37
    s_add_u32 m0, s76, 41120
    s_add_u32 s79, s78, s36
    buffer_load_dwordx4 v2, s[16:19], s79 offen lds
    s_waitcnt lgkmcnt(6)
    v_mfma_f32_32x32x16_bf16 v[96:111], v[24:27], v[200:203], v[96:111]
    ds_read_b64_tr_b16 v[20:21], v5 offset:20544
    ds_read_b64_tr_b16 v[22:23], v5 offset:21056
    s_waitcnt lgkmcnt(6)
    v_mfma_f32_32x32x16_bf16 v[96:111], v[28:31], v[204:207], v[96:111]
    ds_read_b64_tr_b16 v[24:25], v5 offset:22592
    ds_read_b64_tr_b16 v[26:27], v5 offset:23104
    s_waitcnt lgkmcnt(6)
    v_mfma_f32_32x32x16_bf16 v[48:63], v[12:15], v[176:179], v[48:63]
    ds_read_b64_tr_b16 v[28:29], v4 offset:49344
    ds_read_b64_tr_b16 v[30:31], v4 offset:49856
    s_waitcnt lgkmcnt(6)
    v_mfma_f32_32x32x16_bf16 v[48:63], v[16:19], v[180:183], v[48:63]
    ds_read_b64_tr_b16 v[12:13], v4 offset:51392
    ds_read_b64_tr_b16 v[14:15], v4 offset:51904
    s_waitcnt lgkmcnt(6)
    v_mfma_f32_32x32x16_bf16 v[48:63], v[20:23], v[184:187], v[48:63]
    ds_read_b64_tr_b16 v[16:17], v4 offset:53440
    ds_read_b64_tr_b16 v[18:19], v4 offset:53952
    s_waitcnt lgkmcnt(6)
    v_mfma_f32_32x32x16_bf16 v[48:63], v[24:27], v[188:191], v[48:63]
    ds_read_b64_tr_b16 v[20:21], v4 offset:55488
    ds_read_b64_tr_b16 v[22:23], v4 offset:56000
    s_waitcnt lgkmcnt(6)
    v_mfma_f32_32x32x16_bf16 v[64:79], v[28:31], v[144:147], v[64:79]
    ds_read_b64_tr_b16 v[24:25], v3 offset:64
    ds_read_b64_tr_b16 v[26:27], v3 offset:576
    s_waitcnt lgkmcnt(6)
    v_mfma_f32_32x32x16_bf16 v[64:79], v[12:15], v[148:151], v[64:79]
    ds_read_b64_tr_b16 v[28:29], v3 offset:2112
    ds_read_b64_tr_b16 v[30:31], v3 offset:2624
    s_waitcnt lgkmcnt(6)
    v_mfma_f32_32x32x16_bf16 v[64:79], v[16:19], v[152:155], v[64:79]
    ds_read_b64_tr_b16 v[12:13], v3 offset:4160
    ds_read_b64_tr_b16 v[14:15], v3 offset:4672
    s_waitcnt lgkmcnt(6)
    v_mfma_f32_32x32x16_bf16 v[64:79], v[20:23], v[156:159], v[64:79]
    ds_read_b64_tr_b16 v[16:17], v3 offset:6208
    ds_read_b64_tr_b16 v[18:19], v3 offset:6720
    s_waitcnt lgkmcnt(6)
    v_mfma_f32_32x32x16_bf16 v[80:95], v[24:27], v[224:227], v[80:95]
    ds_read_b64_tr_b16 v[20:21], v6 offset:49408
    ds_read_b64_tr_b16 v[22:23], v6 offset:49920
    s_waitcnt lgkmcnt(6)
    v_mfma_f32_32x32x16_bf16 v[80:95], v[28:31], v[228:231], v[80:95]
    ds_read_b64_tr_b16 v[24:25], v6 offset:51456
    ds_read_b64_tr_b16 v[26:27], v6 offset:51968
    s_waitcnt lgkmcnt(6)
    v_mfma_f32_32x32x16_bf16 v[80:95], v[12:15], v[232:235], v[80:95]
    ds_read_b64_tr_b16 v[28:29], v6 offset:53504
    ds_read_b64_tr_b16 v[30:31], v6 offset:54016
    s_waitcnt lgkmcnt(6)
    v_mfma_f32_32x32x16_bf16 v[80:95], v[16:19], v[236:239], v[80:95]
    ds_read_b64_tr_b16 v[12:13], v6 offset:55552
    ds_read_b64_tr_b16 v[14:15], v6 offset:56064
    s_waitcnt vmcnt(2)
    s_barrier
    s_waitcnt lgkmcnt(6)
    v_mfma_f32_32x32x16_bf16 v[96:111], v[20:23], v[208:211], v[96:111]
    ds_read_b64_tr_b16 v[16:17], v5 offset:32896
    ds_read_b64_tr_b16 v[18:19], v5 offset:33408
    s_mul_i32 s78, s82, s37
    s_add_u32 m0, s76, 49344
    s_add_u32 s79, s78, s36
    buffer_load_dwordx4 v2, s[16:19], s79 offen lds
    s_waitcnt lgkmcnt(6)
    v_mfma_f32_32x32x16_bf16 v[96:111], v[24:27], v[212:215], v[96:111]
    ds_read_b64_tr_b16 v[20:21], v5 offset:34944
    ds_read_b64_tr_b16 v[22:23], v5 offset:35456
    s_mul_i32 s78, s83, s37
    s_add_u32 m0, s76, 57568
    s_add_u32 s79, s78, s36
    buffer_load_dwordx4 v2, s[16:19], s79 offen lds
    s_waitcnt lgkmcnt(6)
    v_mfma_f32_32x32x16_bf16 v[96:111], v[28:31], v[216:219], v[96:111]
    ds_read_b64_tr_b16 v[24:25], v5 offset:36992
    ds_read_b64_tr_b16 v[26:27], v5 offset:37504
    s_waitcnt lgkmcnt(6)
    v_mfma_f32_32x32x16_bf16 v[96:111], v[12:15], v[220:223], v[96:111]
    ds_read_b64_tr_b16 v[28:29], v5 offset:39040
    ds_read_b64_tr_b16 v[30:31], v5 offset:39552
    s_waitcnt lgkmcnt(6)
    v_mfma_f32_32x32x16_bf16 v[48:63], v[16:19], v[192:195], v[48:63]
    ds_read_b64_tr_b16 v[12:13], v6 offset:0
    ds_read_b64_tr_b16 v[14:15], v6 offset:512
    s_waitcnt lgkmcnt(6)
    v_mfma_f32_32x32x16_bf16 v[48:63], v[20:23], v[196:199], v[48:63]
    ds_read_b64_tr_b16 v[16:17], v6 offset:2048
    ds_read_b64_tr_b16 v[18:19], v6 offset:2560
    s_waitcnt lgkmcnt(6)
    v_mfma_f32_32x32x16_bf16 v[48:63], v[24:27], v[200:203], v[48:63]
    ds_read_b64_tr_b16 v[20:21], v6 offset:4096
    ds_read_b64_tr_b16 v[22:23], v6 offset:4608
    s_waitcnt lgkmcnt(6)
    v_mfma_f32_32x32x16_bf16 v[48:63], v[28:31], v[204:207], v[48:63]
    ds_read_b64_tr_b16 v[24:25], v6 offset:6144
    ds_read_b64_tr_b16 v[26:27], v6 offset:6656
    s_waitcnt lgkmcnt(6)
    v_mfma_f32_32x32x16_bf16 v[64:79], v[12:15], v[160:163], v[64:79]
    ds_read_b64_tr_b16 v[28:29], v3 offset:16512
    ds_read_b64_tr_b16 v[30:31], v3 offset:17024
    s_waitcnt lgkmcnt(6)
    v_mfma_f32_32x32x16_bf16 v[64:79], v[16:19], v[164:167], v[64:79]
    ds_read_b64_tr_b16 v[12:13], v3 offset:18560
    ds_read_b64_tr_b16 v[14:15], v3 offset:19072
    s_waitcnt lgkmcnt(6)
    v_mfma_f32_32x32x16_bf16 v[64:79], v[20:23], v[168:171], v[64:79]
    ds_read_b64_tr_b16 v[16:17], v3 offset:20608
    ds_read_b64_tr_b16 v[18:19], v3 offset:21120
    s_waitcnt lgkmcnt(6)
    v_mfma_f32_32x32x16_bf16 v[64:79], v[24:27], v[172:175], v[64:79]
    ds_read_b64_tr_b16 v[20:21], v3 offset:22656
    ds_read_b64_tr_b16 v[22:23], v3 offset:23168
    s_waitcnt lgkmcnt(6)
    v_mfma_f32_32x32x16_bf16 v[80:95], v[28:31], v[240:243], v[80:95]
    ds_read_b64_tr_b16 v[24:25], v4 offset:64
    ds_read_b64_tr_b16 v[26:27], v4 offset:576
    s_waitcnt lgkmcnt(6)
    v_mfma_f32_32x32x16_bf16 v[80:95], v[12:15], v[244:247], v[80:95]
    ds_read_b64_tr_b16 v[28:29], v4 offset:2112
    ds_read_b64_tr_b16 v[30:31], v4 offset:2624
    s_waitcnt lgkmcnt(6)
    v_mfma_f32_32x32x16_bf16 v[80:95], v[16:19], v[248:251], v[80:95]
    ds_read_b64_tr_b16 v[12:13], v4 offset:4160
    ds_read_b64_tr_b16 v[14:15], v4 offset:4672
    s_waitcnt lgkmcnt(6)
    v_mfma_f32_32x32x16_bf16 v[80:95], v[20:23], v[252:255], v[80:95]
    ds_read_b64_tr_b16 v[16:17], v4 offset:6208
    ds_read_b64_tr_b16 v[18:19], v4 offset:6720
    s_waitcnt vmcnt(2)
    s_barrier
    s_waitcnt lgkmcnt(6)
    v_mfma_f32_32x32x16_bf16 v[96:111], v[24:27], v[224:227], v[96:111]
    ds_read_b64_tr_b16 v[20:21], v5 offset:49344
    ds_read_b64_tr_b16 v[22:23], v5 offset:49856
    s_mul_i32 s78, s84, s37
    s_add_u32 m0, s76, 65792
    s_add_u32 s79, s78, s36
    buffer_load_dwordx4 v2, s[16:19], s79 offen lds
    s_waitcnt lgkmcnt(6)
    v_mfma_f32_32x32x16_bf16 v[96:111], v[28:31], v[228:231], v[96:111]
    ds_read_b64_tr_b16 v[24:25], v5 offset:51392
    ds_read_b64_tr_b16 v[26:27], v5 offset:51904
    s_mul_i32 s78, s85, s37
    s_add_u32 m0, s76, 74016
    s_add_u32 s79, s78, s36
    buffer_load_dwordx4 v2, s[16:19], s79 offen lds
    s_waitcnt lgkmcnt(6)
    v_mfma_f32_32x32x16_bf16 v[96:111], v[12:15], v[232:235], v[96:111]
    ds_read_b64_tr_b16 v[28:29], v5 offset:53440
    ds_read_b64_tr_b16 v[30:31], v5 offset:53952
    v_mul_f32 v40, v80, v88
    v_mul_f32 v41, v81, v89
    v_mul_f32 v42, v82, v90
    v_mul_f32 v43, v83, v91
    s_waitcnt lgkmcnt(6)
    v_mfma_f32_32x32x16_bf16 v[96:111], v[16:19], v[236:239], v[96:111]
    ds_read_b64_tr_b16 v[12:13], v5 offset:55488
    ds_read_b64_tr_b16 v[14:15], v5 offset:56000
    v_mul_f32 v44, v84, v92
    v_mul_f32 v45, v85, v93
    v_mul_f32 v46, v86, v94
    v_mul_f32 v47, v87, v95
    s_waitcnt lgkmcnt(6)
    v_mfma_f32_32x32x16_bf16 v[48:63], v[20:23], v[208:211], v[48:63]
    ds_read_b64_tr_b16 v[16:17], v6 offset:16448
    ds_read_b64_tr_b16 v[18:19], v6 offset:16960
    v_mul_f32 v32, s46, v80
    v_mul_f32 v33, s46, v81
    v_mul_f32 v34, s46, v82
    v_mul_f32 v35, s46, v83
    s_waitcnt lgkmcnt(6)
    v_mfma_f32_32x32x16_bf16 v[48:63], v[24:27], v[212:215], v[48:63]
    ds_read_b64_tr_b16 v[20:21], v6 offset:18496
    ds_read_b64_tr_b16 v[22:23], v6 offset:19008
    v_mul_f32 v36, s46, v84
    v_mul_f32 v37, s46, v85
    v_mul_f32 v38, s46, v86
    v_mul_f32 v39, s46, v87
    s_waitcnt lgkmcnt(6)
    v_mfma_f32_32x32x16_bf16 v[48:63], v[28:31], v[216:219], v[48:63]
    ds_read_b64_tr_b16 v[24:25], v6 offset:20544
    ds_read_b64_tr_b16 v[26:27], v6 offset:21056
    v_exp_f32 v32, v32
    v_exp_f32 v33, v33
    v_exp_f32 v34, v34
    v_exp_f32 v35, v35
    s_waitcnt lgkmcnt(6)
    v_mfma_f32_32x32x16_bf16 v[48:63], v[12:15], v[220:223], v[48:63]
    ds_read_b64_tr_b16 v[28:29], v6 offset:22592
    ds_read_b64_tr_b16 v[30:31], v6 offset:23104
    v_exp_f32 v36, v36
    v_exp_f32 v37, v37
    v_exp_f32 v38, v38
    v_exp_f32 v39, v39
    s_waitcnt lgkmcnt(6)
    v_mfma_f32_32x32x16_bf16 v[64:79], v[16:19], v[176:179], v[64:79]
    ds_read_b64_tr_b16 v[12:13], v4 offset:16512
    ds_read_b64_tr_b16 v[14:15], v4 offset:17024
    v_add_f32 v32, 1.0, v32
    v_add_f32 v33, 1.0, v33
    v_add_f32 v34, 1.0, v34
    v_add_f32 v35, 1.0, v35
    s_waitcnt lgkmcnt(6)
    v_mfma_f32_32x32x16_bf16 v[64:79], v[20:23], v[180:183], v[64:79]
    ds_read_b64_tr_b16 v[16:17], v4 offset:18560
    ds_read_b64_tr_b16 v[18:19], v4 offset:19072
    v_add_f32 v36, 1.0, v36
    v_add_f32 v37, 1.0, v37
    v_add_f32 v38, 1.0, v38
    v_add_f32 v39, 1.0, v39
    s_waitcnt lgkmcnt(6)
    v_mfma_f32_32x32x16_bf16 v[64:79], v[24:27], v[184:187], v[64:79]
    ds_read_b64_tr_b16 v[20:21], v4 offset:20608
    ds_read_b64_tr_b16 v[22:23], v4 offset:21120
    v_rcp_f32 v32, v32
    v_rcp_f32 v33, v33
    v_rcp_f32 v34, v34
    v_rcp_f32 v35, v35
    s_waitcnt lgkmcnt(6)
    v_mfma_f32_32x32x16_bf16 v[64:79], v[28:31], v[188:191], v[64:79]
    ds_read_b64_tr_b16 v[24:25], v4 offset:22656
    ds_read_b64_tr_b16 v[26:27], v4 offset:23168
    v_rcp_f32 v36, v36
    v_rcp_f32 v37, v37
    v_rcp_f32 v38, v38
    v_rcp_f32 v39, v39
    s_waitcnt lgkmcnt(6)
    v_mfma_f32_32x32x16_bf16 v[96:111], v[12:15], v[240:243], v[96:111]
    ds_read_b64_tr_b16 v[28:29], v3 offset:0
    ds_read_b64_tr_b16 v[30:31], v3 offset:512
    v_mul_f32 v40, v40, v32
    v_mul_f32 v41, v41, v33
    v_mul_f32 v42, v42, v34
    v_mul_f32 v43, v43, v35
    s_waitcnt lgkmcnt(6)
    v_mfma_f32_32x32x16_bf16 v[96:111], v[16:19], v[244:247], v[96:111]
    ds_read_b64_tr_b16 v[12:13], v3 offset:2048
    ds_read_b64_tr_b16 v[14:15], v3 offset:2560
    v_mul_f32 v44, v44, v36
    v_mul_f32 v45, v45, v37
    v_mul_f32 v46, v46, v38
    v_mul_f32 v47, v47, v39
    s_waitcnt lgkmcnt(6)
    v_mfma_f32_32x32x16_bf16 v[96:111], v[20:23], v[248:251], v[96:111]
    ds_read_b64_tr_b16 v[16:17], v3 offset:4096
    ds_read_b64_tr_b16 v[18:19], v3 offset:4608
    v_cvt_pk_bf16_f32 v32, v40, v41
    v_cvt_pk_bf16_f32 v33, v42, v43
    v_cvt_pk_bf16_f32 v34, v44, v45
    v_cvt_pk_bf16_f32 v35, v46, v47
    s_waitcnt lgkmcnt(6)
    v_mfma_f32_32x32x16_bf16 v[96:111], v[24:27], v[252:255], v[96:111]
    ds_read_b64_tr_b16 v[20:21], v3 offset:6144
    ds_read_b64_tr_b16 v[22:23], v3 offset:6656
    buffer_store_dwordx4 v[32:35], v0, s[24:27], s41 offen offset:2048 sc1
    s_waitcnt vmcnt(3)
    s_barrier
    s_waitcnt lgkmcnt(6)
    v_mfma_f32_32x32x16_bf16 v[48:63], v[28:31], v[224:227], v[48:63]
    ds_read_b64_tr_b16 v[24:25], v6 offset:32896
    ds_read_b64_tr_b16 v[26:27], v6 offset:33408
    s_mul_i32 s78, s86, s37
    s_add_u32 m0, s76, 82240
    s_add_u32 s79, s78, s36
    buffer_load_dwordx4 v2, s[16:19], s79 offen lds
    s_waitcnt lgkmcnt(6)
    v_mfma_f32_32x32x16_bf16 v[48:63], v[12:15], v[228:231], v[48:63]
    ds_read_b64_tr_b16 v[28:29], v6 offset:34944
    ds_read_b64_tr_b16 v[30:31], v6 offset:35456
    s_mul_i32 s78, s87, s37
    s_add_u32 m0, s76, 90464
    s_add_u32 s79, s78, s36
    buffer_load_dwordx4 v2, s[16:19], s79 offen lds
    s_waitcnt lgkmcnt(6)
    v_mfma_f32_32x32x16_bf16 v[48:63], v[16:19], v[232:235], v[48:63]
    ds_read_b64_tr_b16 v[12:13], v6 offset:36992
    ds_read_b64_tr_b16 v[14:15], v6 offset:37504
    v_mul_f32 v40, v96, v104
    v_mul_f32 v41, v97, v105
    v_mul_f32 v42, v98, v106
    v_mul_f32 v43, v99, v107
    s_waitcnt lgkmcnt(6)
    v_mfma_f32_32x32x16_bf16 v[48:63], v[20:23], v[236:239], v[48:63]
    ds_read_b64_tr_b16 v[16:17], v6 offset:39040
    ds_read_b64_tr_b16 v[18:19], v6 offset:39552
    v_mul_f32 v44, v100, v108
    v_mul_f32 v45, v101, v109
    v_mul_f32 v46, v102, v110
    v_mul_f32 v47, v103, v111
    s_waitcnt lgkmcnt(6)
    v_mfma_f32_32x32x16_bf16 v[64:79], v[24:27], v[192:195], v[64:79]
    ds_read_b64_tr_b16 v[20:21], v3 offset:16448
    ds_read_b64_tr_b16 v[22:23], v3 offset:16960
    v_mul_f32 v32, s46, v96
    v_mul_f32 v33, s46, v97
    v_mul_f32 v34, s46, v98
    v_mul_f32 v35, s46, v99
    s_waitcnt lgkmcnt(6)
    v_mfma_f32_32x32x16_bf16 v[64:79], v[28:31], v[196:199], v[64:79]
    ds_read_b64_tr_b16 v[24:25], v3 offset:18496
    ds_read_b64_tr_b16 v[26:27], v3 offset:19008
    v_mul_f32 v36, s46, v100
    v_mul_f32 v37, s46, v101
    v_mul_f32 v38, s46, v102
    v_mul_f32 v39, s46, v103
    s_waitcnt lgkmcnt(6)
    v_mfma_f32_32x32x16_bf16 v[64:79], v[12:15], v[200:203], v[64:79]
    ds_read_b64_tr_b16 v[28:29], v3 offset:20544
    ds_read_b64_tr_b16 v[30:31], v3 offset:21056
    v_exp_f32 v32, v32
    v_exp_f32 v33, v33
    v_exp_f32 v34, v34
    v_exp_f32 v35, v35
    s_waitcnt lgkmcnt(6)
    v_mfma_f32_32x32x16_bf16 v[64:79], v[16:19], v[204:207], v[64:79]
    ds_read_b64_tr_b16 v[12:13], v3 offset:22592
    ds_read_b64_tr_b16 v[14:15], v3 offset:23104
    v_exp_f32 v36, v36
    v_exp_f32 v37, v37
    v_exp_f32 v38, v38
    v_exp_f32 v39, v39
    s_waitcnt lgkmcnt(6)
    v_mfma_f32_32x32x16_bf16 v[48:63], v[20:23], v[240:243], v[48:63]
    ds_read_b64_tr_b16 v[16:17], v6 offset:49344
    ds_read_b64_tr_b16 v[18:19], v6 offset:49856
    v_add_f32 v32, 1.0, v32
    v_add_f32 v33, 1.0, v33
    v_add_f32 v34, 1.0, v34
    v_add_f32 v35, 1.0, v35
    s_waitcnt lgkmcnt(6)
    v_mfma_f32_32x32x16_bf16 v[48:63], v[24:27], v[244:247], v[48:63]
    ds_read_b64_tr_b16 v[20:21], v6 offset:51392
    ds_read_b64_tr_b16 v[22:23], v6 offset:51904
    v_add_f32 v36, 1.0, v36
    v_add_f32 v37, 1.0, v37
    v_add_f32 v38, 1.0, v38
    v_add_f32 v39, 1.0, v39
    s_waitcnt lgkmcnt(6)
    v_mfma_f32_32x32x16_bf16 v[48:63], v[28:31], v[248:251], v[48:63]
    ds_read_b64_tr_b16 v[24:25], v6 offset:53440
    ds_read_b64_tr_b16 v[26:27], v6 offset:53952
    v_rcp_f32 v32, v32
    v_rcp_f32 v33, v33
    v_rcp_f32 v34, v34
    v_rcp_f32 v35, v35
    s_waitcnt lgkmcnt(6)
    v_mfma_f32_32x32x16_bf16 v[48:63], v[12:15], v[252:255], v[48:63]
    ds_read_b64_tr_b16 v[28:29], v6 offset:55488
    ds_read_b64_tr_b16 v[30:31], v6 offset:56000
    v_rcp_f32 v36, v36
    v_rcp_f32 v37, v37
    v_rcp_f32 v38, v38
    v_rcp_f32 v39, v39
    s_waitcnt lgkmcnt(6)
    v_mfma_f32_32x32x16_bf16 v[64:79], v[16:19], v[208:211], v[64:79]
    ds_read_b64_tr_b16 v[12:13], v4 offset:0
    ds_read_b64_tr_b16 v[14:15], v4 offset:512
    v_mul_f32 v40, v40, v32
    v_mul_f32 v41, v41, v33
    v_mul_f32 v42, v42, v34
    v_mul_f32 v43, v43, v35
    s_waitcnt lgkmcnt(6)
    v_mfma_f32_32x32x16_bf16 v[64:79], v[20:23], v[212:215], v[64:79]
    ds_read_b64_tr_b16 v[16:17], v4 offset:2048
    ds_read_b64_tr_b16 v[18:19], v4 offset:2560
    v_mul_f32 v44, v44, v36
    v_mul_f32 v45, v45, v37
    v_mul_f32 v46, v46, v38
    v_mul_f32 v47, v47, v39
    s_waitcnt lgkmcnt(6)
    v_mfma_f32_32x32x16_bf16 v[64:79], v[24:27], v[216:219], v[64:79]
    ds_read_b64_tr_b16 v[20:21], v4 offset:4096
    ds_read_b64_tr_b16 v[22:23], v4 offset:4608
    v_cvt_pk_bf16_f32 v32, v40, v41
    v_cvt_pk_bf16_f32 v33, v42, v43
    v_cvt_pk_bf16_f32 v34, v44, v45
    v_cvt_pk_bf16_f32 v35, v46, v47
    s_waitcnt lgkmcnt(6)
    v_mfma_f32_32x32x16_bf16 v[64:79], v[28:31], v[220:223], v[64:79]
    ds_read_b64_tr_b16 v[24:25], v4 offset:6144
    ds_read_b64_tr_b16 v[26:27], v4 offset:6656
    buffer_store_dwordx4 v[32:35], v0, s[24:27], s41 offen offset:3072 sc1
    v_mul_f32 v40, v48, v56
    v_mul_f32 v41, v49, v57
    v_mul_f32 v42, v50, v58
    s_waitcnt vmcnt(4)
    s_barrier
    s_waitcnt lgkmcnt(6)
    v_mfma_f32_32x32x16_bf16 v[64:79], v[12:15], v[224:227], v[64:79]
    ds_read_b64_tr_b16 v[28:29], v4 offset:16448
    ds_read_b64_tr_b16 v[30:31], v4 offset:16960
    s_mul_i32 s78, s88, s37
    s_add_u32 m0, s76, 98688
    s_add_u32 s79, s78, s36
    buffer_load_dwordx4 v2, s[16:19], s79 offen lds
    v_mul_f32 v43, v51, v59
    v_mul_f32 v44, v52, v60
    v_mul_f32 v45, v53, v61
    v_mul_f32 v46, v54, v62
    v_lshrrev_b32 v95, 4, v0
    s_waitcnt lgkmcnt(6)
    v_mfma_f32_32x32x16_bf16 v[64:79], v[16:19], v[228:231], v[64:79]
    ds_read_b64_tr_b16 v[12:13], v4 offset:18496
    ds_read_b64_tr_b16 v[14:15], v4 offset:19008
    v_mul_f32 v47, v55, v63
    v_mul_f32 v32, s46, v48
    v_mul_f32 v33, s46, v49
    v_mul_f32 v34, s46, v50
    v_min_u32 v110, 2, v95
    s_waitcnt lgkmcnt(6)
    v_mfma_f32_32x32x16_bf16 v[64:79], v[20:23], v[232:235], v[64:79]
    ds_read_b64_tr_b16 v[16:17], v4 offset:20544
    ds_read_b64_tr_b16 v[18:19], v4 offset:21056
    v_mul_f32 v35, s46, v51
    v_mul_f32 v36, s46, v52
    v_mul_f32 v37, s46, v53
    v_mul_f32 v38, s46, v54
    v_add_u32 v110, s20, v110
    s_waitcnt lgkmcnt(6)
    v_mfma_f32_32x32x16_bf16 v[64:79], v[24:27], v[236:239], v[64:79]
    ds_read_b64_tr_b16 v[20:21], v4 offset:22592
    ds_read_b64_tr_b16 v[22:23], v4 offset:23104
    v_mul_f32 v39, s46, v55
    v_exp_f32 v32, v32
    v_exp_f32 v33, v33
    v_exp_f32 v34, v34
    v_lshl_add_u32 v109, v95, 5, -1
    s_waitcnt lgkmcnt(6)
    v_mfma_f32_32x32x16_bf16 v[64:79], v[28:31], v[240:243], v[64:79]
    ds_read_b64_tr_b16 v[24:25], v7 offset:32896
    ds_read_b64_tr_b16 v[26:27], v7 offset:33152
    v_exp_f32 v35, v35
    v_exp_f32 v36, v36
    v_exp_f32 v37, v37
    v_exp_f32 v38, v38
    v_subrev_u32 v109, 64, v109
    s_waitcnt lgkmcnt(6)
    v_mfma_f32_32x32x16_bf16 v[64:79], v[12:15], v[244:247], v[64:79]
    ds_read_b64_tr_b16 v[28:29], v7 offset:33920
    ds_read_b64_tr_b16 v[30:31], v7 offset:34176
    v_exp_f32 v39, v39
    v_add_f32 v32, 1.0, v32
    v_add_f32 v33, 1.0, v33
    v_add_f32 v34, 1.0, v34
    v_add_u32 v108, s23, v95
    s_waitcnt lgkmcnt(6)
    v_mfma_f32_32x32x16_bf16 v[64:79], v[16:19], v[248:251], v[64:79]
    ds_read_b64_tr_b16 v[12:13], v7 offset:34944
    ds_read_b64_tr_b16 v[14:15], v7 offset:35200
    v_add_f32 v35, 1.0, v35
    v_add_f32 v36, 1.0, v36
    v_add_f32 v37, 1.0, v37
    v_add_f32 v38, 1.0, v38
    v_cndmask_b32 v110, v110, v109, s[4:5]
    s_waitcnt lgkmcnt(6)
    v_mfma_f32_32x32x16_bf16 v[64:79], v[20:23], v[252:255], v[64:79]
    ds_read_b64_tr_b16 v[16:17], v7 offset:35968
    ds_read_b64_tr_b16 v[18:19], v7 offset:36224
    v_add_f32 v39, 1.0, v39
    v_rcp_f32 v32, v32
    v_rcp_f32 v33, v33
    v_rcp_f32 v34, v34
    v_cndmask_b32 v110, v110, v108, s[96:97]
    s_waitcnt lgkmcnt(6)
    v_mfma_f32_32x32x16_bf16 v[48:63], v[24:27], v[112:115], 0
    ds_read_b64_tr_b16 v[20:21], v7 offset:41120
    ds_read_b64_tr_b16 v[22:23], v7 offset:41376
    v_rcp_f32 v35, v35
    v_rcp_f32 v36, v36
    v_rcp_f32 v37, v37
    v_rcp_f32 v38, v38
    v_lshlrev_b32 v110, 7, v110
    s_waitcnt lgkmcnt(6)
    v_mfma_f32_32x32x16_bf16 v[48:63], v[28:31], v[116:119], v[48:63]
    ds_read_b64_tr_b16 v[24:25], v7 offset:42144
    ds_read_b64_tr_b16 v[26:27], v7 offset:42400
    v_rcp_f32 v39, v39
    v_mul_f32 v40, v40, v32
    v_mul_f32 v41, v41, v33
    v_mul_f32 v42, v42, v34
    v_add_u32 v86, 49348608, v110
    s_waitcnt lgkmcnt(6)
    v_mfma_f32_32x32x16_bf16 v[48:63], v[12:15], v[120:123], v[48:63]
    ds_read_b64_tr_b16 v[28:29], v7 offset:43168
    ds_read_b64_tr_b16 v[30:31], v7 offset:43424
    v_mul_f32 v43, v43, v35
    v_mul_f32 v44, v44, v36
    v_mul_f32 v45, v45, v37
    v_mul_f32 v46, v46, v38
    v_add_u32 v94, 49315840, v110
    s_waitcnt lgkmcnt(6)
    v_mfma_f32_32x32x16_bf16 v[48:63], v[16:19], v[124:127], v[48:63]
    ds_read_b64_tr_b16 v[12:13], v7 offset:44192
    ds_read_b64_tr_b16 v[14:15], v7 offset:44448
    v_mul_f32 v47, v47, v39
    v_cvt_pk_bf16_f32 v32, v40, v41
    v_cvt_pk_bf16_f32 v33, v42, v43
    v_cvt_pk_bf16_f32 v34, v44, v45
    v_lshlrev_b32 v91, 7, v95
    s_waitcnt lgkmcnt(6)
    v_mfma_f32_32x32x16_bf16 v[48:63], v[20:23], v[128:131], v[48:63]
    ds_read_b64_tr_b16 v[16:17], v7 offset:49344
    ds_read_b64_tr_b16 v[18:19], v7 offset:49600
    v_cvt_pk_bf16_f32 v35, v46, v47
    buffer_store_dwordx4 v[32:35], v0, s[24:27], s41 offen offset:0 sc1
    v_mul_f32 v40, v64, v72
    v_mul_f32 v41, v65, v73
    v_add_u32 v91, 25427968, v91
    s_waitcnt lgkmcnt(6)
    v_mfma_f32_32x32x16_bf16 v[48:63], v[24:27], v[132:135], v[48:63]
    ds_read_b64_tr_b16 v[20:21], v7 offset:50368
    ds_read_b64_tr_b16 v[22:23], v7 offset:50624
    v_mul_f32 v42, v66, v74
    v_mul_f32 v43, v67, v75
    v_mul_f32 v44, v68, v76
    v_mul_f32 v45, v69, v77
    v_add_u32 v88, s61, v95
    s_waitcnt lgkmcnt(6)
    v_mfma_f32_32x32x16_bf16 v[48:63], v[28:31], v[136:139], v[48:63]
    ds_read_b64_tr_b16 v[24:25], v7 offset:51392
    ds_read_b64_tr_b16 v[26:27], v7 offset:51648
    v_mul_f32 v46, v70, v78
    v_mul_f32 v47, v71, v79
    v_mul_f32 v32, s46, v64
    v_mul_f32 v33, s46, v65
    v_and_b32 v88, 31, v88
    s_waitcnt lgkmcnt(6)
    v_mfma_f32_32x32x16_bf16 v[48:63], v[12:15], v[140:143], v[48:63]
    ds_read_b64_tr_b16 v[28:29], v7 offset:52416
    ds_read_b64_tr_b16 v[30:31], v7 offset:52672
    v_mul_f32 v34, s46, v66
    v_mul_f32 v35, s46, v67
    v_mul_f32 v36, s46, v68
    v_mul_f32 v37, s46, v69
    v_mul_u32_u24 v88, 5120, v88
    s_waitcnt vmcnt(3)
    s_barrier
    s_waitcnt lgkmcnt(6)
    v_mfma_f32_32x32x16_bf16 v[48:63], v[16:19], v[144:147], v[48:63]
    ds_read_b64_tr_b16 v[12:13], v7 offset:57568
    ds_read_b64_tr_b16 v[14:15], v7 offset:57824
    v_mul_f32 v38, s46, v70
    v_mul_f32 v39, s46, v71
    v_exp_f32 v32, v32
    v_exp_f32 v33, v33
    v_add_u32 v88, s101, v88
    s_waitcnt lgkmcnt(6)
    v_mfma_f32_32x32x16_bf16 v[48:63], v[20:23], v[148:151], v[48:63]
    ds_read_b64_tr_b16 v[16:17], v7 offset:58592
    ds_read_b64_tr_b16 v[18:19], v7 offset:58848
    v_exp_f32 v34, v34
    v_exp_f32 v35, v35
    v_exp_f32 v36, v36
    v_exp_f32 v37, v37
    v_lshlrev_b32 v90, 2, v95
    s_waitcnt lgkmcnt(6)
    v_mfma_f32_32x32x16_bf16 v[48:63], v[24:27], v[152:155], v[48:63]
    ds_read_b64_tr_b16 v[20:21], v7 offset:59616
    ds_read_b64_tr_b16 v[22:23], v7 offset:59872
    v_exp_f32 v38, v38
    v_exp_f32 v39, v39
    v_add_f32 v32, 1.0, v32
    v_add_f32 v33, 1.0, v33
    v_and_b32 v81, 0x1f0, v0
    s_waitcnt lgkmcnt(6)
    v_mfma_f32_32x32x16_bf16 v[48:63], v[28:31], v[156:159], v[48:63]
    ds_read_b64_tr_b16 v[24:25], v7 offset:60640
    ds_read_b64_tr_b16 v[26:27], v7 offset:60896
    v_add_f32 v34, 1.0, v34
    v_add_f32 v35, 1.0, v35
    v_add_f32 v36, 1.0, v36
    v_add_f32 v37, 1.0, v37
    v_lshrrev_b32 v111, 5, v95
    s_waitcnt lgkmcnt(6)
    v_mfma_f32_32x32x16_bf16 v[48:63], v[12:15], v[160:163], v[48:63]
    ds_read_b64_tr_b16 v[28:29], v8 offset:0
    ds_read_b64_tr_b16 v[30:31], v8 offset:256
    v_add_f32 v38, 1.0, v38
    v_add_f32 v39, 1.0, v39
    v_rcp_f32 v32, v32
    v_rcp_f32 v33, v33
    v_lshl_add_u32 v111, v111, 2, s22
    s_waitcnt lgkmcnt(6)
    v_mfma_f32_32x32x16_bf16 v[48:63], v[16:19], v[164:167], v[48:63]
    ds_read_b64_tr_b16 v[12:13], v8 offset:1024
    ds_read_b64_tr_b16 v[14:15], v8 offset:1280
    v_rcp_f32 v34, v34
    v_rcp_f32 v35, v35
    v_rcp_f32 v36, v36
    v_rcp_f32 v37, v37
    v_add_u32 v110, 152064, v81
    s_waitcnt lgkmcnt(6)
    v_mfma_f32_32x32x16_bf16 v[48:63], v[20:23], v[168:171], v[48:63]
    ds_read_b64_tr_b16 v[16:17], v8 offset:2048
    ds_read_b64_tr_b16 v[18:19], v8 offset:2304
    v_rcp_f32 v38, v38
    v_rcp_f32 v39, v39
    v_mul_f32 v40, v40, v32
    v_mul_f32 v41, v41, v33
    v_add_u32 v108, 0, v111
    s_waitcnt lgkmcnt(6)
    v_mfma_f32_32x32x16_bf16 v[48:63], v[24:27], v[172:175], v[48:63]
    ds_read_b64_tr_b16 v[20:21], v8 offset:3072
    ds_read_b64_tr_b16 v[22:23], v8 offset:3328
    v_mul_f32 v42, v42, v34
    v_mul_f32 v43, v43, v35
    v_mul_f32 v44, v44, v36
    v_mul_f32 v45, v45, v37
    v_lshrrev_b32 v96, 3, v108
    s_waitcnt lgkmcnt(6)
    v_mfma_f32_32x32x16_bf16 v[48:63], v[28:31], v[176:179], v[48:63]
    ds_read_b64_tr_b16 v[24:25], v8 offset:8224
    ds_read_b64_tr_b16 v[26:27], v8 offset:8480
    v_mul_f32 v46, v46, v38
    v_mul_f32 v47, v47, v39
    v_cvt_pk_bf16_f32 v32, v40, v41
    v_cvt_pk_bf16_f32 v33, v42, v43
    v_lshl_add_u32 v96, v96, 9, v110
    s_waitcnt lgkmcnt(6)
    v_mfma_f32_32x32x16_bf16 v[48:63], v[12:15], v[180:183], v[48:63]
    ds_read_b64_tr_b16 v[28:29], v8 offset:9248
    ds_read_b64_tr_b16 v[30:31], v8 offset:9504
    v_cvt_pk_bf16_f32 v34, v44, v45
    v_cvt_pk_bf16_f32 v35, v46, v47
    buffer_store_dwordx4 v[32:35], v0, s[24:27], s41 offen offset:1024 sc1
    v_and_b32 v109, 6, v108
    v_lshl_add_u32 v96, v109, 1, v96
    s_waitcnt lgkmcnt(6)
    v_mfma_f32_32x32x16_bf16 v[48:63], v[16:19], v[184:187], v[48:63]
    ds_read_b64_tr_b16 v[12:13], v8 offset:10272
    ds_read_b64_tr_b16 v[14:15], v8 offset:10528
    v_add_u32 v108, 2, v111
    v_lshrrev_b32 v97, 3, v108
    v_lshl_add_u32 v97, v97, 9, v110
    v_and_b32 v109, 6, v108
    v_lshl_add_u32 v97, v109, 1, v97
    s_waitcnt lgkmcnt(6)
    v_mfma_f32_32x32x16_bf16 v[48:63], v[20:23], v[188:191], v[48:63]
    ds_read_b64_tr_b16 v[16:17], v8 offset:11296
    ds_read_b64_tr_b16 v[18:19], v8 offset:11552
    v_add_u32 v98, 512, v96
    v_add_u32 v99, 512, v97
    v_add_u32 v100, 512, v98
    v_mov_b32 v101, 0
    v_add_u32 v108, 18, v111
    s_waitcnt lgkmcnt(6)
    v_mfma_f32_32x32x16_bf16 v[48:63], v[24:27], v[192:195], v[48:63]
    ds_read_b64_tr_b16 v[20:21], v7 offset:32928
    ds_read_b64_tr_b16 v[22:23], v7 offset:33184
    v_lshrrev_b32 v102, 3, v108
    v_lshl_add_u32 v102, v102, 9, v110
    v_and_b32 v109, 6, v108
    v_lshl_add_u32 v102, v109, 1, v102
    v_add_u32 v108, 20, v111
    s_waitcnt lgkmcnt(6)
    v_mfma_f32_32x32x16_bf16 v[48:63], v[28:31], v[196:199], v[48:63]
    ds_read_b64_tr_b16 v[24:25], v7 offset:33952
    ds_read_b64_tr_b16 v[26:27], v7 offset:34208
    v_lshrrev_b32 v103, 3, v108
    v_lshl_add_u32 v103, v103, 9, v110
    v_and_b32 v109, 6, v108
    v_lshl_add_u32 v103, v109, 1, v103
    v_add_u32 v104, 512, v102
    s_waitcnt lgkmcnt(6)
    v_mfma_f32_32x32x16_bf16 v[48:63], v[12:15], v[200:203], v[48:63]
    ds_read_b64_tr_b16 v[28:29], v7 offset:34976
    ds_read_b64_tr_b16 v[30:31], v7 offset:35232
    v_add_u32 v105, 512, v103
    v_add_u32 v106, 512, v104
    v_mov_b32 v107, 0
    v_subrev_u32 v108, 2, v95
    v_add_u32 v109, s60, v108
    s_waitcnt lgkmcnt(6)
    v_mfma_f32_32x32x16_bf16 v[48:63], v[16:19], v[204:207], v[48:63]
    ds_read_b64_tr_b16 v[12:13], v7 offset:36000
    ds_read_b64_tr_b16 v[14:15], v7 offset:36256
    v_subrev_u32 v110, s67, v109
    v_min_u32 v109, v109, v110
    v_add_u32 v109, s66, v109
    v_add_u32 v110, s70, v108
    v_subrev_u32 v111, s69, v110
    s_waitcnt vmcnt(2)
    s_barrier
    s_cmp_lg_u32 s3, 0
    s_cbranch_scc1 L_pi_3
    buffer_load_dwordx2 v[92:93], v94, s[24:27], 0 offen sc1
L_pi_3:
    buffer_load_dword v11, v0, s[24:27], 0 offen
    s_waitcnt lgkmcnt(6)
    v_mfma_f32_32x32x16_bf16 v[64:79], v[20:23], v[112:115], 0
    ds_read_b64_tr_b16 v[16:17], v8 offset:16448
    ds_read_b64_tr_b16 v[18:19], v8 offset:16704
    v_min_u32 v110, v110, v111
    v_add_u32 v110, s68, v110
    v_cmp_gt_u32 s[4:5], s67, v108
    v_cmp_gt_u32 s[96:97], s56, v108
    v_mov_b32 v111, s66
    s_waitcnt lgkmcnt(6)
    v_mfma_f32_32x32x16_bf16 v[64:79], v[24:27], v[116:119], v[64:79]
    ds_read_b64_tr_b16 v[20:21], v8 offset:17472
    ds_read_b64_tr_b16 v[22:23], v8 offset:17728
    v_cndmask_b32 v109, v110, v109, s[4:5]
    v_cndmask_b32 v87, v111, v109, s[96:97]
    v_add_u32 v83, s89, v0
    v_lshrrev_b32 v89, 3, v95
    v_mul_u32_u24 v89, 1152, v89
    s_waitcnt lgkmcnt(6)
    v_mfma_f32_32x32x16_bf16 v[64:79], v[28:31], v[120:123], v[64:79]
    ds_read_b64_tr_b16 v[24:25], v8 offset:18496
    ds_read_b64_tr_b16 v[26:27], v8 offset:18752
    v_bfe_u32 v108, v95, 4, 1
    v_lshlrev_b32 v110, 2, v108
    v_and_b32 v109, 7, v95
    v_xor_b32 v110, v110, v109
    v_lshl_add_u32 v89, v110, 4, v89
    s_waitcnt lgkmcnt(6)
    v_mfma_f32_32x32x16_bf16 v[64:79], v[12:15], v[124:127], v[64:79]
    ds_read_b64_tr_b16 v[28:29], v8 offset:19520
    ds_read_b64_tr_b16 v[30:31], v8 offset:19776
    v_add_u32 v80, s58, v0
    v_and_b32 v110, 31, v95
    v_min_u32 v110, 19, v110
    v_lshrrev_b32 v109, 5, v95
    v_mad_u32_u24 v110, v109, 20, v110
    s_waitcnt lgkmcnt(6)
    v_mfma_f32_32x32x16_bf16 v[48:63], v[16:19], v[208:211], v[48:63]
    ds_read_b64_tr_b16 v[12:13], v7 offset:41152
    ds_read_b64_tr_b16 v[14:15], v7 offset:41408
    v_lshl_add_u32 v82, v110, 4, s59
    v_bfe_u32 v110, v95, 2, 2
    v_lshl_add_u32 v110, v109, 2, v110
    v_lshlrev_b32 v110, 7, v110
    v_lshl_add_u32 v110, v108, 5, v110
    s_waitcnt lgkmcnt(6)
    v_mfma_f32_32x32x16_bf16 v[48:63], v[20:23], v[212:215], v[48:63]
    ds_read_b64_tr_b16 v[16:17], v7 offset:42176
    ds_read_b64_tr_b16 v[18:19], v7 offset:42432
    v_and_b32 v109, 3, v95
    v_lshl_add_u32 v108, v109, 3, v110
    v_bfe_u32 v109, v95, 3, 1
    v_xor_b32 v109, s63, v109
    v_lshlrev_b32 v109, 6, v109
    s_waitcnt lgkmcnt(6)
    v_mfma_f32_32x32x16_bf16 v[48:63], v[24:27], v[216:219], v[48:63]
    ds_read_b64_tr_b16 v[20:21], v7 offset:43200
    ds_read_b64_tr_b16 v[22:23], v7 offset:43456
    v_xor_b32 v110, 64, v109
    v_add3_u32 v84, v108, v109, s71
    v_add3_u32 v85, v108, v110, s74
    v_lshrrev_b32 v81, 1, v81
    s_waitcnt lgkmcnt(6)
    v_mfma_f32_32x32x16_bf16 v[48:63], v[28:31], v[220:223], v[48:63]
    ds_read_b64_tr_b16 v[24:25], v7 offset:44224
    ds_read_b64_tr_b16 v[26:27], v7 offset:44480
    s_waitcnt lgkmcnt(6)
    v_mfma_f32_32x32x16_bf16 v[64:79], v[12:15], v[128:131], v[64:79]
    ds_read_b64_tr_b16 v[28:29], v8 offset:24672
    ds_read_b64_tr_b16 v[30:31], v8 offset:24928
    s_waitcnt lgkmcnt(6)
    v_mfma_f32_32x32x16_bf16 v[64:79], v[16:19], v[132:135], v[64:79]
    ds_read_b64_tr_b16 v[12:13], v8 offset:25696
    ds_read_b64_tr_b16 v[14:15], v8 offset:25952
    s_waitcnt lgkmcnt(6)
    v_mfma_f32_32x32x16_bf16 v[64:79], v[20:23], v[136:139], v[64:79]
    ds_read_b64_tr_b16 v[16:17], v8 offset:26720
    ds_read_b64_tr_b16 v[18:19], v8 offset:26976
    s_waitcnt lgkmcnt(6)
    v_mfma_f32_32x32x16_bf16 v[64:79], v[24:27], v[140:143], v[64:79]
    ds_read_b64_tr_b16 v[20:21], v8 offset:27744
    ds_read_b64_tr_b16 v[22:23], v8 offset:28000
    s_waitcnt lgkmcnt(6)
    v_mfma_f32_32x32x16_bf16 v[48:63], v[28:31], v[224:227], v[48:63]
    ds_read_b64_tr_b16 v[24:25], v7 offset:49376
    ds_read_b64_tr_b16 v[26:27], v7 offset:49632
    s_waitcnt lgkmcnt(6)
    v_mfma_f32_32x32x16_bf16 v[48:63], v[12:15], v[228:231], v[48:63]
    ds_read_b64_tr_b16 v[28:29], v7 offset:50400
    ds_read_b64_tr_b16 v[30:31], v7 offset:50656
    s_waitcnt lgkmcnt(6)
    v_mfma_f32_32x32x16_bf16 v[48:63], v[16:19], v[232:235], v[48:63]
    ds_read_b64_tr_b16 v[12:13], v7 offset:51424
    ds_read_b64_tr_b16 v[14:15], v7 offset:51680
    s_waitcnt lgkmcnt(6)
    v_mfma_f32_32x32x16_bf16 v[48:63], v[20:23], v[236:239], v[48:63]
    ds_read_b64_tr_b16 v[16:17], v7 offset:52448
    ds_read_b64_tr_b16 v[18:19], v7 offset:52704
    s_waitcnt vmcnt(0)
    s_cmp_lg_u32 s3, 0
    s_cbranch_scc1 L_pc_4
    v_cmp_ne_u64 vcc, s[98:99], v[92:93]
    s_cbranch_vccz L_pc_4
    s_mov_b32 s55, 0
L_poll_5:
    buffer_load_dwordx2 v[92:93], v94, s[24:27], 0 offen sc1
    s_add_u32 s55, s55, 1
    s_waitcnt vmcnt(0)
    v_cmp_ne_u64 vcc, s[98:99], v[92:93]
    s_cbranch_vccz L_poll_5_d
    s_cmp_lt_u32 s55, 0x100000
    s_cbranch_scc1 L_poll_5
L_poll_5_d:
L_pc_4:
    s_barrier
    s_waitcnt lgkmcnt(6)
    v_mfma_f32_32x32x16_bf16 v[64:79], v[24:27], v[144:147], v[64:79]
    ds_read_b64_tr_b16 v[20:21], v8 offset:32896
    ds_read_b64_tr_b16 v[22:23], v8 offset:33152
    s_lshl_b32 s21, s3, 10
    s_add_u32 m0, s21, 152064
    s_cmp_gt_u32 s3, 1
    buffer_load_dwordx4 v0, s[24:27], s50 offen sc1 lds
    s_cbranch_scc1 L_q_7
    s_cmp_eq_u32 s3, 1
    s_cbranch_scc1 L_q_6
    s_mov_b32 m0, 160256
    s_add_u32 s21, s50, 8192
    buffer_load_dwordx4 v0, s[24:27], s21 offen sc1 lds
    s_branch L_q_7
L_q_6:
    s_mov_b32 m0, 161280
    s_nop 0
    buffer_load_dword v91, s[24:27], 0 offen sc1 lds
L_q_7:
    s_waitcnt lgkmcnt(6)
    v_mfma_f32_32x32x16_bf16 v[64:79], v[28:31], v[148:151], v[64:79]
    ds_read_b64_tr_b16 v[24:25], v8 offset:33920
    ds_read_b64_tr_b16 v[26:27], v8 offset:34176
    v_readlane_b32 s21, v88, 0
    s_add_u32 m0, s73, 0
    s_cmp_eq_u32 s63, 0
    s_nop 2
    s_cbranch_scc1 L_kv_8
    buffer_load_dwordx4 v0, s[24:27], s21 offen sc1 lds
    s_branch L_kv_9
L_kv_8:
    buffer_load_dword v90, s[24:27], s21 offen sc1 lds
L_kv_9:
    s_waitcnt lgkmcnt(6)
    v_mfma_f32_32x32x16_bf16 v[64:79], v[12:15], v[152:155], v[64:79]
    ds_read_b64_tr_b16 v[28:29], v8 offset:34944
    ds_read_b64_tr_b16 v[30:31], v8 offset:35200
    v_readlane_b32 s21, v88, 1
    s_add_u32 m0, s73, 5120
    s_cmp_eq_u32 s63, 0
    s_nop 2
    s_cbranch_scc1 L_kv_10
    buffer_load_dwordx4 v0, s[24:27], s21 offen sc1 lds
    s_branch L_kv_11
L_kv_10:
    buffer_load_dword v90, s[24:27], s21 offen sc1 lds
L_kv_11:
    s_waitcnt lgkmcnt(6)
    v_mfma_f32_32x32x16_bf16 v[64:79], v[16:19], v[156:159], v[64:79]
    ds_read_b64_tr_b16 v[12:13], v8 offset:35968
    ds_read_b64_tr_b16 v[14:15], v8 offset:36224
    v_readlane_b32 s21, v88, 2
    s_add_u32 m0, s73, 10240
    s_cmp_eq_u32 s63, 0
    s_nop 2
    s_cbranch_scc1 L_kv_12
    buffer_load_dwordx4 v0, s[24:27], s21 offen sc1 lds
    s_branch L_kv_13
L_kv_12:
    buffer_load_dword v90, s[24:27], s21 offen sc1 lds
L_kv_13:
    s_waitcnt lgkmcnt(6)
    v_mfma_f32_32x32x16_bf16 v[48:63], v[20:23], v[240:243], v[48:63]
    ds_read_b64_tr_b16 v[16:17], v7 offset:57600
    ds_read_b64_tr_b16 v[18:19], v7 offset:57856
    v_readlane_b32 s21, v88, 3
    s_add_u32 m0, s73, 15360
    s_cmp_eq_u32 s63, 0
    s_nop 2
    s_cbranch_scc1 L_kv_14
    buffer_load_dwordx4 v0, s[24:27], s21 offen sc1 lds
    s_branch L_kv_15
L_kv_14:
    buffer_load_dword v90, s[24:27], s21 offen sc1 lds
L_kv_15:
    s_waitcnt lgkmcnt(6)
    v_mfma_f32_32x32x16_bf16 v[48:63], v[24:27], v[244:247], v[48:63]
    ds_read_b64_tr_b16 v[20:21], v7 offset:58624
    ds_read_b64_tr_b16 v[22:23], v7 offset:58880
    s_waitcnt lgkmcnt(6)
    v_mfma_f32_32x32x16_bf16 v[48:63], v[28:31], v[248:251], v[48:63]
    ds_read_b64_tr_b16 v[24:25], v7 offset:59648
    ds_read_b64_tr_b16 v[26:27], v7 offset:59904
    s_waitcnt lgkmcnt(6)
    v_mfma_f32_32x32x16_bf16 v[48:63], v[12:15], v[252:255], v[48:63]
    ds_read_b64_tr_b16 v[28:29], v7 offset:60672
    ds_read_b64_tr_b16 v[30:31], v7 offset:60928
    s_waitcnt lgkmcnt(6)
    v_mfma_f32_32x32x16_bf16 v[64:79], v[16:19], v[160:163], v[64:79]
    ds_read_b64_tr_b16 v[12:13], v8 offset:32
    ds_read_b64_tr_b16 v[14:15], v8 offset:288
    s_waitcnt lgkmcnt(6)
    v_mfma_f32_32x32x16_bf16 v[64:79], v[20:23], v[164:167], v[64:79]
    ds_read_b64_tr_b16 v[16:17], v8 offset:1056
    ds_read_b64_tr_b16 v[18:19], v8 offset:1312
    s_waitcnt lgkmcnt(6)
    v_mfma_f32_32x32x16_bf16 v[64:79], v[24:27], v[168:171], v[64:79]
    ds_read_b64_tr_b16 v[20:21], v8 offset:2080
    ds_read_b64_tr_b16 v[22:23], v8 offset:2336
    v_mul_f32 v40, v48, v56
    v_mul_f32 v41, v49, v57
    v_mul_f32 v42, v50, v58
    v_mul_f32 v43, v51, v59
    s_waitcnt lgkmcnt(6)
    v_mfma_f32_32x32x16_bf16 v[64:79], v[28:31], v[172:175], v[64:79]
    ds_read_b64_tr_b16 v[24:25], v8 offset:3104
    ds_read_b64_tr_b16 v[26:27], v8 offset:3360
    v_mul_f32 v44, v52, v60
    v_mul_f32 v45, v53, v61
    v_mul_f32 v46, v54, v62
    v_mul_f32 v47, v55, v63
    s_waitcnt lgkmcnt(6)
    v_mfma_f32_32x32x16_bf16 v[64:79], v[12:15], v[176:179], v[64:79]
    ds_read_b64_tr_b16 v[28:29], v8 offset:8256
    ds_read_b64_tr_b16 v[30:31], v8 offset:8512
    v_mul_f32 v32, s46, v48
    v_mul_f32 v33, s46, v49
    v_mul_f32 v34, s46, v50
    v_mul_f32 v35, s46, v51
    s_waitcnt lgkmcnt(6)
    v_mfma_f32_32x32x16_bf16 v[64:79], v[16:19], v[180:183], v[64:79]
    ds_read_b64_tr_b16 v[12:13], v8 offset:9280
    ds_read_b64_tr_b16 v[14:15], v8 offset:9536
    v_mul_f32 v36, s46, v52
    v_mul_f32 v37, s46, v53
    v_mul_f32 v38, s46, v54
    v_mul_f32 v39, s46, v55
    s_waitcnt lgkmcnt(6)
    v_mfma_f32_32x32x16_bf16 v[64:79], v[20:23], v[184:187], v[64:79]
    ds_read_b64_tr_b16 v[16:17], v8 offset:10304
    ds_read_b64_tr_b16 v[18:19], v8 offset:10560
    v_exp_f32 v32, v32
    v_exp_f32 v33, v33
    v_exp_f32 v34, v34
    v_exp_f32 v35, v35
    s_waitcnt lgkmcnt(6)
    v_mfma_f32_32x32x16_bf16 v[64:79], v[24:27], v[188:191], v[64:79]
    ds_read_b64_tr_b16 v[20:21], v8 offset:11328
    ds_read_b64_tr_b16 v[22:23], v8 offset:11584
    v_exp_f32 v36, v36
    v_exp_f32 v37, v37
    v_exp_f32 v38, v38
    v_exp_f32 v39, v39
    s_waitcnt vmcnt(0)
    s_barrier
    s_waitcnt lgkmcnt(6)
    v_mfma_f32_32x32x16_bf16 v[64:79], v[28:31], v[192:195], v[64:79]
    ds_read_b64_tr_b16 v[24:25], v8 offset:16480
    ds_read_b64_tr_b16 v[26:27], v8 offset:16736
    v_add_f32 v32, 1.0, v32
    v_add_f32 v33, 1.0, v33
    v_add_f32 v34, 1.0, v34
    v_add_f32 v35, 1.0, v35
    v_add_u32 v91, 161280, v90
    ds_read_b32 v91, v91
    ds_read_b32 v96, v96
    ds_read_b32 v97, v97
    ds_read_b32 v98, v98
    ds_read_b32 v99, v99
    ds_read_b32 v100, v100
    ds_read_b32 v102, v102
    ds_read_b32 v103, v103
    ds_read_b32 v104, v104
    ds_read_b32 v105, v105
    ds_read_b32 v106, v106
    s_waitcnt lgkmcnt(15)
    v_mfma_f32_32x32x16_bf16 v[64:79], v[12:15], v[196:199], v[64:79]
    ds_read_b64_tr_b16 v[28:29], v8 offset:17504
    ds_read_b64_tr_b16 v[30:31], v8 offset:17760
    v_add_f32 v36, 1.0, v36
    v_add_f32 v37, 1.0, v37
    v_add_f32 v38, 1.0, v38
    v_add_f32 v39, 1.0, v39
    v_cmp_gt_u32 s[4:5], 32, v95
    v_mfma_f32_32x32x16_bf16 v[64:79], v[16:19], v[200:203], v[64:79]
    ds_read_b64_tr_b16 v[12:13], v8 offset:18528
    ds_read_b64_tr_b16 v[14:15], v8 offset:18784
    v_rcp_f32 v32, v32
    v_rcp_f32 v33, v33
    v_rcp_f32 v34, v34
    v_rcp_f32 v35, v35
    s_nop 0
    s_waitcnt lgkmcnt(15)
    v_mfma_f32_32x32x16_bf16 v[64:79], v[20:23], v[204:207], v[64:79]
    ds_read_b64_tr_b16 v[16:17], v8 offset:19552
    ds_read_b64_tr_b16 v[18:19], v8 offset:19808
    v_rcp_f32 v36, v36
    v_rcp_f32 v37, v37
    v_rcp_f32 v38, v38
    v_rcp_f32 v39, v39
    s_nop 0
    v_mfma_f32_32x32x16_bf16 v[64:79], v[24:27], v[208:211], v[64:79]
    ds_read_b64_tr_b16 v[20:21], v8 offset:24704
    ds_read_b64_tr_b16 v[22:23], v8 offset:24960
    v_mul_f32 v40, v40, v32
    v_mul_f32 v41, v41, v33
    v_mul_f32 v42, v42, v34
    v_mul_f32 v43, v43, v35
    s_nop 0
    s_waitcnt lgkmcnt(6)
    v_mfma_f32_32x32x16_bf16 v[64:79], v[28:31], v[212:215], v[64:79]
    ds_read_b64_tr_b16 v[24:25], v8 offset:25728
    ds_read_b64_tr_b16 v[26:27], v8 offset:25984
    v_mul_f32 v44, v44, v36
    v_mul_f32 v45, v45, v37
    v_mul_f32 v46, v46, v38
    v_mul_f32 v47, v47, v39
    s_nop 0
    s_waitcnt lgkmcnt(6)
    v_mfma_f32_32x32x16_bf16 v[64:79], v[12:15], v[216:219], v[64:79]
    ds_read_b64_tr_b16 v[28:29], v8 offset:26752
    ds_read_b64_tr_b16 v[30:31], v8 offset:27008
    v_cvt_pk_bf16_f32 v32, v40, v41
    v_cvt_pk_bf16_f32 v33, v42, v43
    v_cvt_pk_bf16_f32 v34, v44, v45
    v_cvt_pk_bf16_f32 v35, v46, v47
    s_nop 0
    s_waitcnt lgkmcnt(6)
    v_mfma_f32_32x32x16_bf16 v[64:79], v[16:19], v[220:223], v[64:79]
    ds_read_b64_tr_b16 v[12:13], v8 offset:27776
    ds_read_b64_tr_b16 v[14:15], v8 offset:28032
    buffer_store_dwordx4 v[32:35], v0, s[24:27], s42 offen offset:0 sc1
    s_nop 0
    v_cndmask_b32 v100, 0, v100, s[4:5]
    v_cndmask_b32 v106, 0, v106, s[4:5]
    s_waitcnt lgkmcnt(6)
    v_mfma_f32_32x32x16_bf16 v[64:79], v[20:23], v[224:227], v[64:79]
    ds_read_b64_tr_b16 v[16:17], v8 offset:32928
    ds_read_b64_tr_b16 v[18:19], v8 offset:33184
    s_nop 1
    v_max_f32 v91, v91, v91 row_shr:1 row_mask:0xf bank_mask:0xf bound_ctrl:0
    s_nop 1
    v_max_f32 v91, v91, v91 row_shr:2 row_mask:0xf bank_mask:0xf bound_ctrl:0
    s_nop 1
    s_waitcnt lgkmcnt(6)
    v_mfma_f32_32x32x16_bf16 v[64:79], v[24:27], v[228:231], v[64:79]
    ds_read_b64_tr_b16 v[20:21], v8 offset:33952
    ds_read_b64_tr_b16 v[22:23], v8 offset:34208
    v_max_f32 v91, v91, v91 row_shr:4 row_mask:0xf bank_mask:0xf bound_ctrl:0
    s_nop 1
    v_max_f32 v91, v91, v91 row_shr:8 row_mask:0xf bank_mask:0xf bound_ctrl:0
    s_nop 1
    v_max_f32 v91, v91, v91 row_bcast:15 row_mask:0xa bank_mask:0xf
    s_waitcnt lgkmcnt(6)
    v_mfma_f32_32x32x16_bf16 v[64:79], v[28:31], v[232:235], v[64:79]
    ds_read_b64_tr_b16 v[24:25], v8 offset:34976
    ds_read_b64_tr_b16 v[26:27], v8 offset:35232
    s_nop 1
    v_max_f32 v91, v91, v91 row_bcast:31 row_mask:0xc bank_mask:0xf
    s_nop 0
    v_readlane_b32 s66, v91, 63
    v_lshlrev_b32 v108, 16, v96
    s_waitcnt lgkmcnt(6)
    v_mfma_f32_32x32x16_bf16 v[64:79], v[12:15], v[236:239], v[64:79]
    ds_read_b64_tr_b16 v[28:29], v8 offset:36000
    ds_read_b64_tr_b16 v[30:31], v8 offset:36256
    v_and_b32 v109, 0xffff0000, v96
    v_mul_f32 v110, v108, v108
    v_fmac_f32 v110, v109, v109
    v_lshlrev_b32 v108, 16, v97
    v_and_b32 v109, 0xffff0000, v97
    s_waitcnt lgkmcnt(6)
    v_mfma_f32_32x32x16_bf16 v[64:79], v[16:19], v[240:243], v[64:79]
    v_fmac_f32 v110, v108, v108
    v_fmac_f32 v110, v109, v109
    v_lshlrev_b32 v108, 16, v98
    v_and_b32 v109, 0xffff0000, v98
    v_fmac_f32 v110, v108, v108
    s_waitcnt lgkmcnt(4)
    v_mfma_f32_32x32x16_bf16 v[64:79], v[20:23], v[244:247], v[64:79]
    v_fmac_f32 v110, v109, v109
    v_lshlrev_b32 v108, 16, v99
    v_and_b32 v109, 0xffff0000, v99
    v_fmac_f32 v110, v108, v108
    v_fmac_f32 v110, v109, v109
    s_waitcnt lgkmcnt(2)
    v_mfma_f32_32x32x16_bf16 v[64:79], v[24:27], v[248:251], v[64:79]
    v_lshlrev_b32 v108, 16, v100
    v_and_b32 v109, 0xffff0000, v100
    v_fmac_f32 v110, v108, v108
    v_fmac_f32 v110, v109, v109
    v_mov_b32 v108, v110
    s_waitcnt lgkmcnt(0)
    v_mfma_f32_32x32x16_bf16 v[64:79], v[28:31], v[252:255], v[64:79]
    s_nop 1
    v_permlane32_swap_b32 v110, v108
    v_add_f32 v110, v110, v108
    v_lshlrev_b32 v108, 16, v102
    v_and_b32 v109, 0xffff0000, v102
    s_barrier
    s_nop 11
    s_cmp_lg_u32 s63, 0
    s_cbranch_scc1 L_eg_16
    v_readlane_b32 s22, v87, 2
    s_nop 3
    s_lshl_b32 s70, s22, 11
    s_add_u32 m0, s89, 16384
    s_add_u32 s70, s70, s65
    buffer_load_dwordx4 v0, s[24:27], s70 offen sc1 lds
L_eg_16:
    v_mul_f32 v40, v64, v72
    v_mul_f32 v41, v65, v73
    v_mul_f32 v42, v66, v74
    v_mul_f32 v43, v67, v75
    v_mul_f32 v44, v68, v76
    v_mul_f32 v111, v108, v108
    s_cmp_lg_u32 s63, 0
    s_cbranch_scc1 L_eg_17
    buffer_load_dwordx4 v0, s[24:27], s70 offen offset:1024 sc1 lds
L_eg_17:
    v_mul_f32 v45, v69, v77
    v_mul_f32 v46, v70, v78
    v_mul_f32 v47, v71, v79
    v_mul_f32 v32, s46, v64
    v_mul_f32 v33, s46, v65
    v_fmac_f32 v111, v109, v109
    s_cmp_lg_u32 s63, 0
    s_cbranch_scc1 L_eg_18
    s_mul_i32 s71, s22, 36864
    s_add_u32 m0, s72, 24576
    s_add_u32 s71, s71, s64
    buffer_load_dwordx4 v89, s[28:31], s71 offen lds
L_eg_18:
    v_mul_f32 v34, s46, v66
    v_mul_f32 v35, s46, v67
    v_mul_f32 v36, s46, v68
    v_mul_f32 v37, s46, v69
    v_mul_f32 v38, s46, v70
    v_lshlrev_b32 v108, 16, v103
    s_cmp_lg_u32 s63, 0
    s_cbranch_scc1 L_eg_19
    s_add_u32 m0, s72, 28544
    s_nop 0
    buffer_load_dwordx4 v89, s[28:31], s71 offen offset:128 lds
L_eg_19:
    v_mul_f32 v39, s46, v71
    v_exp_f32 v32, v32
    v_exp_f32 v33, v33
    v_exp_f32 v34, v34
    v_exp_f32 v35, v35
    v_and_b32 v109, 0xffff0000, v103
    s_cmp_lg_u32 s63, 0
    s_cbranch_scc1 L_eg_20
    s_add_u32 m0, s72, 32512
    s_nop 0
    buffer_load_dwordx4 v89, s[28:31], s71 offen offset:256 lds
L_eg_20:
    v_exp_f32 v36, v36
    v_exp_f32 v37, v37
    v_exp_f32 v38, v38
    v_exp_f32 v39, v39
    v_add_f32 v32, 1.0, v32
    v_fmac_f32 v111, v108, v108
    s_cmp_lg_u32 s63, 0
    s_cbranch_scc1 L_eg_21
    v_readlane_b32 s22, v87, 3
    s_nop 3
    s_lshl_b32 s70, s22, 11
    s_add_u32 m0, s89, 24576
    s_add_u32 s70, s70, s65
    buffer_load_dwordx4 v0, s[24:27], s70 offen sc1 lds
L_eg_21:
    v_add_f32 v33, 1.0, v33
    v_add_f32 v34, 1.0, v34
    v_add_f32 v35, 1.0, v35
    v_add_f32 v36, 1.0, v36
    v_add_f32 v37, 1.0, v37
    v_fmac_f32 v111, v109, v109
    s_cmp_lg_u32 s63, 0
    s_cbranch_scc1 L_eg_22
    buffer_load_dwordx4 v0, s[24:27], s70 offen offset:1024 sc1 lds
L_eg_22:
    v_add_f32 v38, 1.0, v38
    v_add_f32 v39, 1.0, v39
    v_rcp_f32 v32, v32
    v_rcp_f32 v33, v33
    v_rcp_f32 v34, v34
    v_lshlrev_b32 v108, 16, v104
    s_cmp_lg_u32 s63, 0
    s_cbranch_scc1 L_eg_23
    s_mul_i32 s71, s22, 36864
    s_add_u32 m0, s72, 36864
    s_add_u32 s71, s71, s64
    buffer_load_dwordx4 v89, s[28:31], s71 offen lds
L_eg_23:
    v_rcp_f32 v35, v35
    v_rcp_f32 v36, v36
    v_rcp_f32 v37, v37
    v_rcp_f32 v38, v38
    v_rcp_f32 v39, v39
    v_and_b32 v109, 0xffff0000, v104
    s_cmp_lg_u32 s63, 0
    s_cbranch_scc1 L_eg_24
    s_add_u32 m0, s72, 40832
    s_nop 0
    buffer_load_dwordx4 v89, s[28:31], s71 offen offset:128 lds
L_eg_24:
    v_mul_f32 v40, v40, v32
    v_mul_f32 v41, v41, v33
    v_mul_f32 v42, v42, v34
    v_mul_f32 v43, v43, v35
    v_mul_f32 v44, v44, v36
    v_fmac_f32 v111, v108, v108
    s_cmp_lg_u32 s63, 0
    s_cbranch_scc1 L_eg_25
    s_add_u32 m0, s72, 44800
    s_nop 0
    buffer_load_dwordx4 v89, s[28:31], s71 offen offset:256 lds
L_eg_25:
    v_mul_f32 v45, v45, v37
    v_mul_f32 v46, v46, v38
    v_mul_f32 v47, v47, v39
    v_cvt_pk_bf16_f32 v32, v40, v41
    v_cvt_pk_bf16_f32 v33, v42, v43
    v_fmac_f32 v111, v109, v109
    v_cvt_pk_bf16_f32 v34, v44, v45
    v_cvt_pk_bf16_f32 v35, v46, v47
    buffer_store_dwordx4 v[32:35], v0, s[24:27], s42 offen offset:1024 sc1
    v_lshlrev_b32 v108, 16, v105
    v_and_b32 v109, 0xffff0000, v105
    v_fmac_f32 v111, v108, v108
    v_fmac_f32 v111, v109, v109
    v_lshlrev_b32 v108, 16, v106
    v_and_b32 v109, 0xffff0000, v106
    v_fmac_f32 v111, v108, v108
    v_fmac_f32 v111, v109, v109
    v_mov_b32 v108, v111
    s_nop 1
    v_permlane32_swap_b32 v111, v108
    v_add_f32 v111, v111, v108
    v_max_f32 v110, v110, v111
    v_mul_f32 v110, s66, v110
    v_mov_b32 v108, 0x45610000
    v_cmp_nle_f32 s[4:5], v110, v108
    s_branch L_p1_done
L_st_q:
    v_bfe_u32 v13, v0, 4, 1
    v_bfe_u32 v14, v0, 5, 1
    v_sub_u32 v13, v13, v14
    v_lshlrev_b32 v13, 3, v13
    v_add_u32 v3, v3, v13
    v_add_u32 v4, v4, v13
    v_add_u32 v5, v5, v13
    v_add_u32 v6, v6, v13
    v_add_u32 v7, v7, v13
    v_add_u32 v8, v8, v13
    s_mul_i32 s75, s71, 36*1024
    s_add_u32 s75, s75, 22020096
    s_cmp_eq_u32 s5, 31
    s_cbranch_scc1 L_st_kv
    s_add_u32 s34, s32, 256
    s_add_u32 s35, s32, 384
    s_lshl_b32 s74, s32, 5
    s_add_u32 s40, s75, s74
    s_add_u32 s43, s40, 4096
    s_add_u32 s41, s40, 8192
    s_add_u32 s44, s40, 12288
    s_waitcnt vmcnt(4)
    s_barrier
    ds_read_b64_tr_b16 v[12:13], v3 offset:64
    ds_read_b64_tr_b16 v[14:15], v3 offset:576
    ds_read_b64_tr_b16 v[16:17], v3 offset:2112
    ds_read_b64_tr_b16 v[18:19], v3 offset:2624
    ds_read_b64_tr_b16 v[20:21], v3 offset:4160
    ds_read_b64_tr_b16 v[22:23], v3 offset:4672
    ds_read_b64_tr_b16 v[24:25], v3 offset:6208
    ds_read_b64_tr_b16 v[26:27], v3 offset:6720
    s_waitcnt lgkmcnt(6)
    v_mfma_f32_32x32x16_bf16 v[80:95], v[12:15], v[112:115], 0
    ds_read_b64_tr_b16 v[28:29], v4 offset:64
    ds_read_b64_tr_b16 v[30:31], v4 offset:576
    s_lshl_b32 s77, s82, 12
    s_add_u32 s77, s77, s39
    buffer_load_dwordx4 v[144:147], v0, s[24:27], s77 offen offset:0 sc1
    s_waitcnt lgkmcnt(6)
    v_mfma_f32_32x32x16_bf16 v[80:95], v[16:19], v[116:119], v[80:95]
    ds_read_b64_tr_b16 v[12:13], v4 offset:2112
    ds_read_b64_tr_b16 v[14:15], v4 offset:2624
    buffer_load_dwordx4 v[148:151], v0, s[24:27], s77 offen offset:1024 sc1
    s_waitcnt lgkmcnt(6)
    v_mfma_f32_32x32x16_bf16 v[80:95], v[20:23], v[120:123], v[80:95]
    ds_read_b64_tr_b16 v[16:17], v4 offset:4160
    ds_read_b64_tr_b16 v[18:19], v4 offset:4672
    buffer_load_dwordx4 v[152:155], v0, s[24:27], s77 offen offset:2048 sc1
    s_waitcnt lgkmcnt(6)
    v_mfma_f32_32x32x16_bf16 v[80:95], v[24:27], v[124:127], v[80:95]
    ds_read_b64_tr_b16 v[20:21], v4 offset:6208
    ds_read_b64_tr_b16 v[22:23], v4 offset:6720
    buffer_load_dwordx4 v[156:159], v0, s[24:27], s77 offen offset:3072 sc1
    s_waitcnt lgkmcnt(6)
    v_mfma_f32_32x32x16_bf16 v[96:111], v[28:31], v[112:115], 0
    ds_read_b64_tr_b16 v[24:25], v3 offset:0
    ds_read_b64_tr_b16 v[26:27], v3 offset:512
    s_waitcnt lgkmcnt(6)
    v_mfma_f32_32x32x16_bf16 v[96:111], v[12:15], v[116:119], v[96:111]
    ds_read_b64_tr_b16 v[28:29], v3 offset:2048
    ds_read_b64_tr_b16 v[30:31], v3 offset:2560
    s_waitcnt lgkmcnt(6)
    v_mfma_f32_32x32x16_bf16 v[96:111], v[16:19], v[120:123], v[96:111]
    ds_read_b64_tr_b16 v[12:13], v3 offset:4096
    ds_read_b64_tr_b16 v[14:15], v3 offset:4608
    s_waitcnt lgkmcnt(6)
    v_mfma_f32_32x32x16_bf16 v[96:111], v[20:23], v[124:127], v[96:111]
    ds_read_b64_tr_b16 v[16:17], v3 offset:6144
    ds_read_b64_tr_b16 v[18:19], v3 offset:6656
    s_waitcnt vmcnt(4)
    s_barrier
    s_waitcnt lgkmcnt(6)
    v_mfma_f32_32x32x16_bf16 v[48:63], v[24:27], v[112:115], 0
    ds_read_b64_tr_b16 v[20:21], v3 offset:16512
    ds_read_b64_tr_b16 v[22:23], v3 offset:17024
    s_lshl_b32 s77, s83, 12
    s_add_u32 s77, s77, s39
    buffer_load_dwordx4 v[160:163], v0, s[24:27], s77 offen offset:0 sc1
    s_waitcnt lgkmcnt(6)
    v_mfma_f32_32x32x16_bf16 v[48:63], v[28:31], v[116:119], v[48:63]
    ds_read_b64_tr_b16 v[24:25], v3 offset:18560
    ds_read_b64_tr_b16 v[26:27], v3 offset:19072
    buffer_load_dwordx4 v[164:167], v0, s[24:27], s77 offen offset:1024 sc1
    s_waitcnt lgkmcnt(6)
    v_mfma_f32_32x32x16_bf16 v[48:63], v[12:15], v[120:123], v[48:63]
    ds_read_b64_tr_b16 v[28:29], v3 offset:20608
    ds_read_b64_tr_b16 v[30:31], v3 offset:21120
    buffer_load_dwordx4 v[168:171], v0, s[24:27], s77 offen offset:2048 sc1
    s_waitcnt lgkmcnt(6)
    v_mfma_f32_32x32x16_bf16 v[48:63], v[16:19], v[124:127], v[48:63]
    ds_read_b64_tr_b16 v[12:13], v3 offset:22656
    ds_read_b64_tr_b16 v[14:15], v3 offset:23168
    buffer_load_dwordx4 v[172:175], v0, s[24:27], s77 offen offset:3072 sc1
    s_waitcnt lgkmcnt(6)
    v_mfma_f32_32x32x16_bf16 v[80:95], v[20:23], v[128:131], v[80:95]
    ds_read_b64_tr_b16 v[16:17], v4 offset:16512
    ds_read_b64_tr_b16 v[18:19], v4 offset:17024
    s_waitcnt lgkmcnt(6)
    v_mfma_f32_32x32x16_bf16 v[80:95], v[24:27], v[132:135], v[80:95]
    ds_read_b64_tr_b16 v[20:21], v4 offset:18560
    ds_read_b64_tr_b16 v[22:23], v4 offset:19072
    s_waitcnt lgkmcnt(6)
    v_mfma_f32_32x32x16_bf16 v[80:95], v[28:31], v[136:139], v[80:95]
    ds_read_b64_tr_b16 v[24:25], v4 offset:20608
    ds_read_b64_tr_b16 v[26:27], v4 offset:21120
    s_waitcnt lgkmcnt(6)
    v_mfma_f32_32x32x16_bf16 v[80:95], v[12:15], v[140:143], v[80:95]
    ds_read_b64_tr_b16 v[28:29], v4 offset:22656
    ds_read_b64_tr_b16 v[30:31], v4 offset:23168
    s_waitcnt lgkmcnt(6)
    v_mfma_f32_32x32x16_bf16 v[96:111], v[16:19], v[128:131], v[96:111]
    ds_read_b64_tr_b16 v[12:13], v3 offset:16448
    ds_read_b64_tr_b16 v[14:15], v3 offset:16960
    s_waitcnt lgkmcnt(6)
    v_mfma_f32_32x32x16_bf16 v[96:111], v[20:23], v[132:135], v[96:111]
    ds_read_b64_tr_b16 v[16:17], v3 offset:18496
    ds_read_b64_tr_b16 v[18:19], v3 offset:19008
    s_waitcnt lgkmcnt(6)
    v_mfma_f32_32x32x16_bf16 v[96:111], v[24:27], v[136:139], v[96:111]
    ds_read_b64_tr_b16 v[20:21], v3 offset:20544
    ds_read_b64_tr_b16 v[22:23], v3 offset:21056
    s_waitcnt lgkmcnt(6)
    v_mfma_f32_32x32x16_bf16 v[96:111], v[28:31], v[140:143], v[96:111]
    ds_read_b64_tr_b16 v[24:25], v3 offset:22592
    ds_read_b64_tr_b16 v[26:27], v3 offset:23104
    s_waitcnt lgkmcnt(6)
    v_mfma_f32_32x32x16_bf16 v[48:63], v[12:15], v[128:131], v[48:63]
    ds_read_b64_tr_b16 v[28:29], v4 offset:0
    ds_read_b64_tr_b16 v[30:31], v4 offset:512
    s_waitcnt lgkmcnt(6)
    v_mfma_f32_32x32x16_bf16 v[48:63], v[16:19], v[132:135], v[48:63]
    ds_read_b64_tr_b16 v[12:13], v4 offset:2048
    ds_read_b64_tr_b16 v[14:15], v4 offset:2560
    s_waitcnt lgkmcnt(6)
    v_mfma_f32_32x32x16_bf16 v[48:63], v[20:23], v[136:139], v[48:63]
    ds_read_b64_tr_b16 v[16:17], v4 offset:4096
    ds_read_b64_tr_b16 v[18:19], v4 offset:4608
    s_waitcnt lgkmcnt(6)
    v_mfma_f32_32x32x16_bf16 v[48:63], v[24:27], v[140:143], v[48:63]
    ds_read_b64_tr_b16 v[20:21], v4 offset:6144
    ds_read_b64_tr_b16 v[22:23], v4 offset:6656
    s_waitcnt vmcnt(4)
    s_barrier
    s_waitcnt lgkmcnt(6)
    v_mfma_f32_32x32x16_bf16 v[64:79], v[28:31], v[112:115], 0
    ds_read_b64_tr_b16 v[24:25], v3 offset:32960
    ds_read_b64_tr_b16 v[26:27], v3 offset:33472
    s_lshl_b32 s77, s84, 12
    s_add_u32 s77, s77, s39
    buffer_load_dwordx4 v[176:179], v0, s[24:27], s77 offen offset:0 sc1
    s_waitcnt lgkmcnt(6)
    v_mfma_f32_32x32x16_bf16 v[64:79], v[12:15], v[116:119], v[64:79]
    ds_read_b64_tr_b16 v[28:29], v3 offset:35008
    ds_read_b64_tr_b16 v[30:31], v3 offset:35520
    buffer_load_dwordx4 v[180:183], v0, s[24:27], s77 offen offset:1024 sc1
    s_waitcnt lgkmcnt(6)
    v_mfma_f32_32x32x16_bf16 v[64:79], v[16:19], v[120:123], v[64:79]
    ds_read_b64_tr_b16 v[12:13], v3 offset:37056
    ds_read_b64_tr_b16 v[14:15], v3 offset:37568
    buffer_load_dwordx4 v[184:187], v0, s[24:27], s77 offen offset:2048 sc1
    s_waitcnt lgkmcnt(6)
    v_mfma_f32_32x32x16_bf16 v[64:79], v[20:23], v[124:127], v[64:79]
    ds_read_b64_tr_b16 v[16:17], v3 offset:39104
    ds_read_b64_tr_b16 v[18:19], v3 offset:39616
    buffer_load_dwordx4 v[188:191], v0, s[24:27], s77 offen offset:3072 sc1
    s_waitcnt lgkmcnt(6)
    v_mfma_f32_32x32x16_bf16 v[80:95], v[24:27], v[144:147], v[80:95]
    ds_read_b64_tr_b16 v[20:21], v4 offset:32960
    ds_read_b64_tr_b16 v[22:23], v4 offset:33472
    s_waitcnt lgkmcnt(6)
    v_mfma_f32_32x32x16_bf16 v[80:95], v[28:31], v[148:151], v[80:95]
    ds_read_b64_tr_b16 v[24:25], v4 offset:35008
    ds_read_b64_tr_b16 v[26:27], v4 offset:35520
    s_waitcnt lgkmcnt(6)
    v_mfma_f32_32x32x16_bf16 v[80:95], v[12:15], v[152:155], v[80:95]
    ds_read_b64_tr_b16 v[28:29], v4 offset:37056
    ds_read_b64_tr_b16 v[30:31], v4 offset:37568
    s_waitcnt lgkmcnt(6)
    v_mfma_f32_32x32x16_bf16 v[80:95], v[16:19], v[156:159], v[80:95]
    ds_read_b64_tr_b16 v[12:13], v4 offset:39104
    ds_read_b64_tr_b16 v[14:15], v4 offset:39616
    s_waitcnt lgkmcnt(6)
    v_mfma_f32_32x32x16_bf16 v[96:111], v[20:23], v[144:147], v[96:111]
    ds_read_b64_tr_b16 v[16:17], v3 offset:32896
    ds_read_b64_tr_b16 v[18:19], v3 offset:33408
    s_waitcnt lgkmcnt(6)
    v_mfma_f32_32x32x16_bf16 v[96:111], v[24:27], v[148:151], v[96:111]
    ds_read_b64_tr_b16 v[20:21], v3 offset:34944
    ds_read_b64_tr_b16 v[22:23], v3 offset:35456
    s_waitcnt lgkmcnt(6)
    v_mfma_f32_32x32x16_bf16 v[96:111], v[28:31], v[152:155], v[96:111]
    ds_read_b64_tr_b16 v[24:25], v3 offset:36992
    ds_read_b64_tr_b16 v[26:27], v3 offset:37504
    s_waitcnt lgkmcnt(6)
    v_mfma_f32_32x32x16_bf16 v[96:111], v[12:15], v[156:159], v[96:111]
    ds_read_b64_tr_b16 v[28:29], v3 offset:39040
    ds_read_b64_tr_b16 v[30:31], v3 offset:39552
    s_waitcnt lgkmcnt(6)
    v_mfma_f32_32x32x16_bf16 v[48:63], v[16:19], v[144:147], v[48:63]
    ds_read_b64_tr_b16 v[12:13], v4 offset:16448
    ds_read_b64_tr_b16 v[14:15], v4 offset:16960
    s_waitcnt lgkmcnt(6)
    v_mfma_f32_32x32x16_bf16 v[48:63], v[20:23], v[148:151], v[48:63]
    ds_read_b64_tr_b16 v[16:17], v4 offset:18496
    ds_read_b64_tr_b16 v[18:19], v4 offset:19008
    s_waitcnt lgkmcnt(6)
    v_mfma_f32_32x32x16_bf16 v[48:63], v[24:27], v[152:155], v[48:63]
    ds_read_b64_tr_b16 v[20:21], v4 offset:20544
    ds_read_b64_tr_b16 v[22:23], v4 offset:21056
    s_waitcnt lgkmcnt(6)
    v_mfma_f32_32x32x16_bf16 v[48:63], v[28:31], v[156:159], v[48:63]
    ds_read_b64_tr_b16 v[24:25], v4 offset:22592
    ds_read_b64_tr_b16 v[26:27], v4 offset:23104
    s_waitcnt vmcnt(4)
    s_barrier
    s_waitcnt lgkmcnt(6)
    v_mfma_f32_32x32x16_bf16 v[64:79], v[12:15], v[128:131], v[64:79]
    ds_read_b64_tr_b16 v[28:29], v3 offset:49408
    ds_read_b64_tr_b16 v[30:31], v3 offset:49920
    s_lshl_b32 s77, s85, 12
    s_add_u32 s77, s77, s39
    buffer_load_dwordx4 v[192:195], v0, s[24:27], s77 offen offset:0 sc1
    s_waitcnt lgkmcnt(6)
    v_mfma_f32_32x32x16_bf16 v[64:79], v[16:19], v[132:135], v[64:79]
    ds_read_b64_tr_b16 v[12:13], v3 offset:51456
    ds_read_b64_tr_b16 v[14:15], v3 offset:51968
    buffer_load_dwordx4 v[196:199], v0, s[24:27], s77 offen offset:1024 sc1
    s_waitcnt lgkmcnt(6)
    v_mfma_f32_32x32x16_bf16 v[64:79], v[20:23], v[136:139], v[64:79]
    ds_read_b64_tr_b16 v[16:17], v3 offset:53504
    ds_read_b64_tr_b16 v[18:19], v3 offset:54016
    buffer_load_dwordx4 v[200:203], v0, s[24:27], s77 offen offset:2048 sc1
    s_waitcnt lgkmcnt(6)
    v_mfma_f32_32x32x16_bf16 v[64:79], v[24:27], v[140:143], v[64:79]
    ds_read_b64_tr_b16 v[20:21], v3 offset:55552
    ds_read_b64_tr_b16 v[22:23], v3 offset:56064
    buffer_load_dwordx4 v[204:207], v0, s[24:27], s77 offen offset:3072 sc1
    s_waitcnt lgkmcnt(6)
    v_mfma_f32_32x32x16_bf16 v[80:95], v[28:31], v[160:163], v[80:95]
    ds_read_b64_tr_b16 v[24:25], v4 offset:49408
    ds_read_b64_tr_b16 v[26:27], v4 offset:49920
    s_mul_i32 s78, s88, s37
    s_add_u32 m0, s6, 0
    s_add_u32 s79, s78, s32
    buffer_load_dwordx4 v1, s[8:11], s79 offen lds
    s_waitcnt lgkmcnt(6)
    v_mfma_f32_32x32x16_bf16 v[80:95], v[12:15], v[164:167], v[80:95]
    ds_read_b64_tr_b16 v[28:29], v4 offset:51456
    ds_read_b64_tr_b16 v[30:31], v4 offset:51968
    s_mul_i32 s78, s88, s38
    s_add_u32 m0, s7, 0
    s_add_u32 s79, s78, s33
    buffer_load_dwordx4 v9, s[12:15], s79 offen lds
    s_waitcnt lgkmcnt(6)
    v_mfma_f32_32x32x16_bf16 v[80:95], v[16:19], v[168:171], v[80:95]
    ds_read_b64_tr_b16 v[12:13], v4 offset:53504
    ds_read_b64_tr_b16 v[14:15], v4 offset:54016
    s_waitcnt lgkmcnt(6)
    v_mfma_f32_32x32x16_bf16 v[80:95], v[20:23], v[172:175], v[80:95]
    ds_read_b64_tr_b16 v[16:17], v4 offset:55552
    ds_read_b64_tr_b16 v[18:19], v4 offset:56064
    s_waitcnt lgkmcnt(6)
    v_mfma_f32_32x32x16_bf16 v[96:111], v[24:27], v[160:163], v[96:111]
    ds_read_b64_tr_b16 v[20:21], v3 offset:49344
    ds_read_b64_tr_b16 v[22:23], v3 offset:49856
    s_waitcnt lgkmcnt(6)
    v_mfma_f32_32x32x16_bf16 v[96:111], v[28:31], v[164:167], v[96:111]
    ds_read_b64_tr_b16 v[24:25], v3 offset:51392
    ds_read_b64_tr_b16 v[26:27], v3 offset:51904
    s_waitcnt lgkmcnt(6)
    v_mfma_f32_32x32x16_bf16 v[96:111], v[12:15], v[168:171], v[96:111]
    ds_read_b64_tr_b16 v[28:29], v3 offset:53440
    ds_read_b64_tr_b16 v[30:31], v3 offset:53952
    s_waitcnt lgkmcnt(6)
    v_mfma_f32_32x32x16_bf16 v[96:111], v[16:19], v[172:175], v[96:111]
    ds_read_b64_tr_b16 v[12:13], v3 offset:55488
    ds_read_b64_tr_b16 v[14:15], v3 offset:56000
    s_waitcnt lgkmcnt(6)
    v_mfma_f32_32x32x16_bf16 v[48:63], v[20:23], v[160:163], v[48:63]
    ds_read_b64_tr_b16 v[16:17], v4 offset:32896
    ds_read_b64_tr_b16 v[18:19], v4 offset:33408
    s_waitcnt lgkmcnt(6)
    v_mfma_f32_32x32x16_bf16 v[48:63], v[24:27], v[164:167], v[48:63]
    ds_read_b64_tr_b16 v[20:21], v4 offset:34944
    ds_read_b64_tr_b16 v[22:23], v4 offset:35456
    s_waitcnt lgkmcnt(6)
    v_mfma_f32_32x32x16_bf16 v[48:63], v[28:31], v[168:171], v[48:63]
    ds_read_b64_tr_b16 v[24:25], v4 offset:36992
    ds_read_b64_tr_b16 v[26:27], v4 offset:37504
    s_waitcnt lgkmcnt(6)
    v_mfma_f32_32x32x16_bf16 v[48:63], v[12:15], v[172:175], v[48:63]
    ds_read_b64_tr_b16 v[28:29], v4 offset:39040
    ds_read_b64_tr_b16 v[30:31], v4 offset:39552
    s_waitcnt vmcnt(6)
    s_barrier
    s_waitcnt lgkmcnt(6)
    v_mfma_f32_32x32x16_bf16 v[64:79], v[16:19], v[144:147], v[64:79]
    ds_read_b64_tr_b16 v[12:13], v5 offset:64
    ds_read_b64_tr_b16 v[14:15], v5 offset:576
    s_lshl_b32 s77, s86, 12
    s_add_u32 s77, s77, s39
    buffer_load_dwordx4 v[208:211], v0, s[24:27], s77 offen offset:0 sc1
    s_waitcnt lgkmcnt(6)
    v_mfma_f32_32x32x16_bf16 v[64:79], v[20:23], v[148:151], v[64:79]
    ds_read_b64_tr_b16 v[16:17], v5 offset:2112
    ds_read_b64_tr_b16 v[18:19], v5 offset:2624
    buffer_load_dwordx4 v[212:215], v0, s[24:27], s77 offen offset:1024 sc1
    s_waitcnt lgkmcnt(6)
    v_mfma_f32_32x32x16_bf16 v[64:79], v[24:27], v[152:155], v[64:79]
    ds_read_b64_tr_b16 v[20:21], v5 offset:4160
    ds_read_b64_tr_b16 v[22:23], v5 offset:4672
    buffer_load_dwordx4 v[216:219], v0, s[24:27], s77 offen offset:2048 sc1
    s_waitcnt lgkmcnt(6)
    v_mfma_f32_32x32x16_bf16 v[64:79], v[28:31], v[156:159], v[64:79]
    ds_read_b64_tr_b16 v[24:25], v5 offset:6208
    ds_read_b64_tr_b16 v[26:27], v5 offset:6720
    buffer_load_dwordx4 v[220:223], v0, s[24:27], s77 offen offset:3072 sc1
    s_waitcnt lgkmcnt(6)
    v_mfma_f32_32x32x16_bf16 v[80:95], v[12:15], v[176:179], v[80:95]
    ds_read_b64_tr_b16 v[28:29], v6 offset:64
    ds_read_b64_tr_b16 v[30:31], v6 offset:576
    s_mul_i32 s78, s80, s37
    s_add_u32 m0, s6, 16448
    s_add_u32 s79, s78, s34
    buffer_load_dwordx4 v1, s[8:11], s79 offen lds
    s_waitcnt lgkmcnt(6)
    v_mfma_f32_32x32x16_bf16 v[80:95], v[16:19], v[180:183], v[80:95]
    ds_read_b64_tr_b16 v[12:13], v6 offset:2112
    ds_read_b64_tr_b16 v[14:15], v6 offset:2624
    s_mul_i32 s78, s80, s38
    s_add_u32 m0, s7, 16448
    s_add_u32 s79, s78, s35
    buffer_load_dwordx4 v9, s[12:15], s79 offen lds
    s_waitcnt lgkmcnt(6)
    v_mfma_f32_32x32x16_bf16 v[80:95], v[20:23], v[184:187], v[80:95]
    ds_read_b64_tr_b16 v[16:17], v6 offset:4160
    ds_read_b64_tr_b16 v[18:19], v6 offset:4672
    s_waitcnt lgkmcnt(6)
    v_mfma_f32_32x32x16_bf16 v[80:95], v[24:27], v[188:191], v[80:95]
    ds_read_b64_tr_b16 v[20:21], v6 offset:6208
    ds_read_b64_tr_b16 v[22:23], v6 offset:6720
    s_waitcnt lgkmcnt(6)
    v_mfma_f32_32x32x16_bf16 v[96:111], v[28:31], v[176:179], v[96:111]
    ds_read_b64_tr_b16 v[24:25], v5 offset:0
    ds_read_b64_tr_b16 v[26:27], v5 offset:512
    s_waitcnt lgkmcnt(6)
    v_mfma_f32_32x32x16_bf16 v[96:111], v[12:15], v[180:183], v[96:111]
    ds_read_b64_tr_b16 v[28:29], v5 offset:2048
    ds_read_b64_tr_b16 v[30:31], v5 offset:2560
    s_waitcnt lgkmcnt(6)
    v_mfma_f32_32x32x16_bf16 v[96:111], v[16:19], v[184:187], v[96:111]
    ds_read_b64_tr_b16 v[12:13], v5 offset:4096
    ds_read_b64_tr_b16 v[14:15], v5 offset:4608
    s_waitcnt lgkmcnt(6)
    v_mfma_f32_32x32x16_bf16 v[96:111], v[20:23], v[188:191], v[96:111]
    ds_read_b64_tr_b16 v[16:17], v5 offset:6144
    ds_read_b64_tr_b16 v[18:19], v5 offset:6656
    s_waitcnt lgkmcnt(6)
    v_mfma_f32_32x32x16_bf16 v[48:63], v[24:27], v[176:179], v[48:63]
    ds_read_b64_tr_b16 v[20:21], v4 offset:49344
    ds_read_b64_tr_b16 v[22:23], v4 offset:49856
    s_waitcnt lgkmcnt(6)
    v_mfma_f32_32x32x16_bf16 v[48:63], v[28:31], v[180:183], v[48:63]
    ds_read_b64_tr_b16 v[24:25], v4 offset:51392
    ds_read_b64_tr_b16 v[26:27], v4 offset:51904
    s_waitcnt lgkmcnt(6)
    v_mfma_f32_32x32x16_bf16 v[48:63], v[12:15], v[184:187], v[48:63]
    ds_read_b64_tr_b16 v[28:29], v4 offset:53440
    ds_read_b64_tr_b16 v[30:31], v4 offset:53952
    s_waitcnt lgkmcnt(6)
    v_mfma_f32_32x32x16_bf16 v[48:63], v[16:19], v[188:191], v[48:63]
    ds_read_b64_tr_b16 v[12:13], v4 offset:55488
    ds_read_b64_tr_b16 v[14:15], v4 offset:56000
    s_waitcnt vmcnt(8)
    s_barrier
    s_waitcnt lgkmcnt(6)
    v_mfma_f32_32x32x16_bf16 v[64:79], v[20:23], v[160:163], v[64:79]
    ds_read_b64_tr_b16 v[16:17], v5 offset:16512
    ds_read_b64_tr_b16 v[18:19], v5 offset:17024
    s_lshl_b32 s77, s87, 12
    s_add_u32 s77, s77, s39
    buffer_load_dwordx4 v[224:227], v0, s[24:27], s77 offen offset:0 sc1
    s_waitcnt lgkmcnt(6)
    v_mfma_f32_32x32x16_bf16 v[64:79], v[24:27], v[164:167], v[64:79]
    ds_read_b64_tr_b16 v[20:21], v5 offset:18560
    ds_read_b64_tr_b16 v[22:23], v5 offset:19072
    buffer_load_dwordx4 v[228:231], v0, s[24:27], s77 offen offset:1024 sc1
    s_waitcnt lgkmcnt(6)
    v_mfma_f32_32x32x16_bf16 v[64:79], v[28:31], v[168:171], v[64:79]
    ds_read_b64_tr_b16 v[24:25], v5 offset:20608
    ds_read_b64_tr_b16 v[26:27], v5 offset:21120
    buffer_load_dwordx4 v[232:235], v0, s[24:27], s77 offen offset:2048 sc1
    s_waitcnt lgkmcnt(6)
    v_mfma_f32_32x32x16_bf16 v[64:79], v[12:15], v[172:175], v[64:79]
    ds_read_b64_tr_b16 v[28:29], v5 offset:22656
    ds_read_b64_tr_b16 v[30:31], v5 offset:23168
    buffer_load_dwordx4 v[236:239], v0, s[24:27], s77 offen offset:3072 sc1
    s_waitcnt lgkmcnt(6)
    v_mfma_f32_32x32x16_bf16 v[80:95], v[16:19], v[192:195], v[80:95]
    ds_read_b64_tr_b16 v[12:13], v6 offset:16512
    ds_read_b64_tr_b16 v[14:15], v6 offset:17024
    s_mul_i32 s78, s81, s37
    s_add_u32 m0, s6, 32896
    s_add_u32 s79, s78, s34
    buffer_load_dwordx4 v1, s[8:11], s79 offen lds
    s_waitcnt lgkmcnt(6)
    v_mfma_f32_32x32x16_bf16 v[80:95], v[20:23], v[196:199], v[80:95]
    ds_read_b64_tr_b16 v[16:17], v6 offset:18560
    ds_read_b64_tr_b16 v[18:19], v6 offset:19072
    s_mul_i32 s78, s81, s38
    s_add_u32 m0, s7, 32896
    s_add_u32 s79, s78, s35
    buffer_load_dwordx4 v9, s[12:15], s79 offen lds
    s_waitcnt lgkmcnt(6)
    v_mfma_f32_32x32x16_bf16 v[80:95], v[24:27], v[200:203], v[80:95]
    ds_read_b64_tr_b16 v[20:21], v6 offset:20608
    ds_read_b64_tr_b16 v[22:23], v6 offset:21120
    s_waitcnt lgkmcnt(6)
    v_mfma_f32_32x32x16_bf16 v[80:95], v[28:31], v[204:207], v[80:95]
    ds_read_b64_tr_b16 v[24:25], v6 offset:22656
    ds_read_b64_tr_b16 v[26:27], v6 offset:23168
    s_waitcnt lgkmcnt(6)
    v_mfma_f32_32x32x16_bf16 v[96:111], v[12:15], v[192:195], v[96:111]
    ds_read_b64_tr_b16 v[28:29], v5 offset:16448
    ds_read_b64_tr_b16 v[30:31], v5 offset:16960
    s_waitcnt lgkmcnt(6)
    v_mfma_f32_32x32x16_bf16 v[96:111], v[16:19], v[196:199], v[96:111]
    ds_read_b64_tr_b16 v[12:13], v5 offset:18496
    ds_read_b64_tr_b16 v[14:15], v5 offset:19008
    s_waitcnt lgkmcnt(6)
    v_mfma_f32_32x32x16_bf16 v[96:111], v[20:23], v[200:203], v[96:111]
    ds_read_b64_tr_b16 v[16:17], v5 offset:20544
    ds_read_b64_tr_b16 v[18:19], v5 offset:21056
    s_waitcnt lgkmcnt(6)
    v_mfma_f32_32x32x16_bf16 v[96:111], v[24:27], v[204:207], v[96:111]
    ds_read_b64_tr_b16 v[20:21], v5 offset:22592
    ds_read_b64_tr_b16 v[22:23], v5 offset:23104
    s_waitcnt lgkmcnt(6)
    v_mfma_f32_32x32x16_bf16 v[48:63], v[28:31], v[192:195], v[48:63]
    ds_read_b64_tr_b16 v[24:25], v6 offset:0
    ds_read_b64_tr_b16 v[26:27], v6 offset:512
    s_waitcnt lgkmcnt(6)
    v_mfma_f32_32x32x16_bf16 v[48:63], v[12:15], v[196:199], v[48:63]
    ds_read_b64_tr_b16 v[28:29], v6 offset:2048
    ds_read_b64_tr_b16 v[30:31], v6 offset:2560
    s_waitcnt lgkmcnt(6)
    v_mfma_f32_32x32x16_bf16 v[48:63], v[16:19], v[200:203], v[48:63]
    ds_read_b64_tr_b16 v[12:13], v6 offset:4096
    ds_read_b64_tr_b16 v[14:15], v6 offset:4608
    s_waitcnt lgkmcnt(6)
    v_mfma_f32_32x32x16_bf16 v[48:63], v[20:23], v[204:207], v[48:63]
    ds_read_b64_tr_b16 v[16:17], v6 offset:6144
    ds_read_b64_tr_b16 v[18:19], v6 offset:6656
    s_waitcnt vmcnt(6)
    s_barrier
    s_waitcnt lgkmcnt(6)
    v_mfma_f32_32x32x16_bf16 v[64:79], v[24:27], v[176:179], v[64:79]
    ds_read_b64_tr_b16 v[20:21], v5 offset:32960
    ds_read_b64_tr_b16 v[22:23], v5 offset:33472
    s_lshl_b32 s77, s88, 12
    s_add_u32 s77, s77, s39
    buffer_load_dwordx4 v[240:243], v0, s[24:27], s77 offen offset:0 sc1
    s_waitcnt lgkmcnt(6)
    v_mfma_f32_32x32x16_bf16 v[64:79], v[28:31], v[180:183], v[64:79]
    ds_read_b64_tr_b16 v[24:25], v5 offset:35008
    ds_read_b64_tr_b16 v[26:27], v5 offset:35520
    buffer_load_dwordx4 v[244:247], v0, s[24:27], s77 offen offset:1024 sc1
    s_waitcnt lgkmcnt(6)
    v_mfma_f32_32x32x16_bf16 v[64:79], v[12:15], v[184:187], v[64:79]
    ds_read_b64_tr_b16 v[28:29], v5 offset:37056
    ds_read_b64_tr_b16 v[30:31], v5 offset:37568
    buffer_load_dwordx4 v[248:251], v0, s[24:27], s77 offen offset:2048 sc1
    s_waitcnt lgkmcnt(6)
    v_mfma_f32_32x32x16_bf16 v[64:79], v[16:19], v[188:191], v[64:79]
    ds_read_b64_tr_b16 v[12:13], v5 offset:39104
    ds_read_b64_tr_b16 v[14:15], v5 offset:39616
    buffer_load_dwordx4 v[252:255], v0, s[24:27], s77 offen offset:3072 sc1
    s_waitcnt lgkmcnt(6)
    v_mfma_f32_32x32x16_bf16 v[80:95], v[20:23], v[208:211], v[80:95]
    ds_read_b64_tr_b16 v[16:17], v6 offset:32960
    ds_read_b64_tr_b16 v[18:19], v6 offset:33472
    s_mul_i32 s78, s82, s37
    s_add_u32 m0, s6, 49344
    s_add_u32 s79, s78, s34
    buffer_load_dwordx4 v1, s[8:11], s79 offen lds
    s_waitcnt lgkmcnt(6)
    v_mfma_f32_32x32x16_bf16 v[80:95], v[24:27], v[212:215], v[80:95]
    ds_read_b64_tr_b16 v[20:21], v6 offset:35008
    ds_read_b64_tr_b16 v[22:23], v6 offset:35520
    s_mul_i32 s78, s82, s38
    s_add_u32 m0, s7, 49344
    s_add_u32 s79, s78, s35
    buffer_load_dwordx4 v9, s[12:15], s79 offen lds
    s_waitcnt lgkmcnt(6)
    v_mfma_f32_32x32x16_bf16 v[80:95], v[28:31], v[216:219], v[80:95]
    ds_read_b64_tr_b16 v[24:25], v6 offset:37056
    ds_read_b64_tr_b16 v[26:27], v6 offset:37568
    s_waitcnt lgkmcnt(6)
    v_mfma_f32_32x32x16_bf16 v[80:95], v[12:15], v[220:223], v[80:95]
    ds_read_b64_tr_b16 v[28:29], v6 offset:39104
    ds_read_b64_tr_b16 v[30:31], v6 offset:39616
    s_waitcnt lgkmcnt(6)
    v_mfma_f32_32x32x16_bf16 v[96:111], v[16:19], v[208:211], v[96:111]
    ds_read_b64_tr_b16 v[12:13], v5 offset:32896
    ds_read_b64_tr_b16 v[14:15], v5 offset:33408
    s_waitcnt lgkmcnt(6)
    v_mfma_f32_32x32x16_bf16 v[96:111], v[20:23], v[212:215], v[96:111]
    ds_read_b64_tr_b16 v[16:17], v5 offset:34944
    ds_read_b64_tr_b16 v[18:19], v5 offset:35456
    s_waitcnt lgkmcnt(6)
    v_mfma_f32_32x32x16_bf16 v[96:111], v[24:27], v[216:219], v[96:111]
    ds_read_b64_tr_b16 v[20:21], v5 offset:36992
    ds_read_b64_tr_b16 v[22:23], v5 offset:37504
    s_waitcnt lgkmcnt(6)
    v_mfma_f32_32x32x16_bf16 v[96:111], v[28:31], v[220:223], v[96:111]
    ds_read_b64_tr_b16 v[24:25], v5 offset:39040
    ds_read_b64_tr_b16 v[26:27], v5 offset:39552
    s_waitcnt lgkmcnt(6)
    v_mfma_f32_32x32x16_bf16 v[48:63], v[12:15], v[208:211], v[48:63]
    ds_read_b64_tr_b16 v[28:29], v6 offset:16448
    ds_read_b64_tr_b16 v[30:31], v6 offset:16960
    s_waitcnt lgkmcnt(6)
    v_mfma_f32_32x32x16_bf16 v[48:63], v[16:19], v[212:215], v[48:63]
    ds_read_b64_tr_b16 v[12:13], v6 offset:18496
    ds_read_b64_tr_b16 v[14:15], v6 offset:19008
    s_waitcnt lgkmcnt(6)
    v_mfma_f32_32x32x16_bf16 v[48:63], v[20:23], v[216:219], v[48:63]
    ds_read_b64_tr_b16 v[16:17], v6 offset:20544
    ds_read_b64_tr_b16 v[18:19], v6 offset:21056
    s_waitcnt lgkmcnt(6)
    v_mfma_f32_32x32x16_bf16 v[48:63], v[24:27], v[220:223], v[48:63]
    ds_read_b64_tr_b16 v[20:21], v6 offset:22592
    ds_read_b64_tr_b16 v[22:23], v6 offset:23104
    s_waitcnt vmcnt(6)
    s_barrier
    s_waitcnt lgkmcnt(6)
    v_mfma_f32_32x32x16_bf16 v[64:79], v[28:31], v[192:195], v[64:79]
    ds_read_b64_tr_b16 v[24:25], v5 offset:49408
    ds_read_b64_tr_b16 v[26:27], v5 offset:49920
    s_mul_i32 s78, s83, s37
    s_add_u32 m0, s6, 65792
    s_add_u32 s79, s78, s34
    buffer_load_dwordx4 v1, s[8:11], s79 offen lds
    s_waitcnt lgkmcnt(6)
    v_mfma_f32_32x32x16_bf16 v[64:79], v[12:15], v[196:199], v[64:79]
    ds_read_b64_tr_b16 v[28:29], v5 offset:51456
    ds_read_b64_tr_b16 v[30:31], v5 offset:51968
    s_mul_i32 s78, s83, s38
    s_add_u32 m0, s7, 65792
    s_add_u32 s79, s78, s35
    buffer_load_dwordx4 v9, s[12:15], s79 offen lds
    s_waitcnt lgkmcnt(6)
    v_mfma_f32_32x32x16_bf16 v[64:79], v[16:19], v[200:203], v[64:79]
    ds_read_b64_tr_b16 v[12:13], v5 offset:53504
    ds_read_b64_tr_b16 v[14:15], v5 offset:54016
    s_waitcnt lgkmcnt(6)
    v_mfma_f32_32x32x16_bf16 v[64:79], v[20:23], v[204:207], v[64:79]
    ds_read_b64_tr_b16 v[16:17], v5 offset:55552
    ds_read_b64_tr_b16 v[18:19], v5 offset:56064
    s_waitcnt lgkmcnt(6)
    v_mfma_f32_32x32x16_bf16 v[80:95], v[24:27], v[224:227], v[80:95]
    ds_read_b64_tr_b16 v[20:21], v6 offset:49408
    ds_read_b64_tr_b16 v[22:23], v6 offset:49920
    s_waitcnt lgkmcnt(6)
    v_mfma_f32_32x32x16_bf16 v[80:95], v[28:31], v[228:231], v[80:95]
    ds_read_b64_tr_b16 v[24:25], v6 offset:51456
    ds_read_b64_tr_b16 v[26:27], v6 offset:51968
    s_waitcnt lgkmcnt(6)
    v_mfma_f32_32x32x16_bf16 v[80:95], v[12:15], v[232:235], v[80:95]
    ds_read_b64_tr_b16 v[28:29], v6 offset:53504
    ds_read_b64_tr_b16 v[30:31], v6 offset:54016
    s_waitcnt lgkmcnt(6)
    v_mfma_f32_32x32x16_bf16 v[80:95], v[16:19], v[236:239], v[80:95]
    ds_read_b64_tr_b16 v[12:13], v6 offset:55552
    ds_read_b64_tr_b16 v[14:15], v6 offset:56064
    s_waitcnt lgkmcnt(6)
    v_mfma_f32_32x32x16_bf16 v[96:111], v[20:23], v[224:227], v[96:111]
    ds_read_b64_tr_b16 v[16:17], v5 offset:49344
    ds_read_b64_tr_b16 v[18:19], v5 offset:49856
    s_waitcnt lgkmcnt(6)
    v_mfma_f32_32x32x16_bf16 v[96:111], v[24:27], v[228:231], v[96:111]
    ds_read_b64_tr_b16 v[20:21], v5 offset:51392
    ds_read_b64_tr_b16 v[22:23], v5 offset:51904
    s_waitcnt lgkmcnt(6)
    v_mfma_f32_32x32x16_bf16 v[96:111], v[28:31], v[232:235], v[96:111]
    ds_read_b64_tr_b16 v[24:25], v5 offset:53440
    ds_read_b64_tr_b16 v[26:27], v5 offset:53952
    s_waitcnt lgkmcnt(6)
    v_mfma_f32_32x32x16_bf16 v[96:111], v[12:15], v[236:239], v[96:111]
    ds_read_b64_tr_b16 v[28:29], v5 offset:55488
    ds_read_b64_tr_b16 v[30:31], v5 offset:56000
    s_waitcnt lgkmcnt(6)
    v_mfma_f32_32x32x16_bf16 v[48:63], v[16:19], v[224:227], v[48:63]
    ds_read_b64_tr_b16 v[12:13], v6 offset:32896
    ds_read_b64_tr_b16 v[14:15], v6 offset:33408
    s_waitcnt lgkmcnt(6)
    v_mfma_f32_32x32x16_bf16 v[48:63], v[20:23], v[228:231], v[48:63]
    ds_read_b64_tr_b16 v[16:17], v6 offset:34944
    ds_read_b64_tr_b16 v[18:19], v6 offset:35456
    s_waitcnt lgkmcnt(6)
    v_mfma_f32_32x32x16_bf16 v[48:63], v[24:27], v[232:235], v[48:63]
    ds_read_b64_tr_b16 v[20:21], v6 offset:36992
    ds_read_b64_tr_b16 v[22:23], v6 offset:37504
    s_waitcnt lgkmcnt(6)
    v_mfma_f32_32x32x16_bf16 v[48:63], v[28:31], v[236:239], v[48:63]
    ds_read_b64_tr_b16 v[24:25], v6 offset:39040
    ds_read_b64_tr_b16 v[26:27], v6 offset:39552
    s_waitcnt vmcnt(2)
    s_barrier
    s_waitcnt lgkmcnt(6)
    v_mfma_f32_32x32x16_bf16 v[64:79], v[12:15], v[208:211], v[64:79]
    ds_read_b64_tr_b16 v[28:29], v3 offset:64
    ds_read_b64_tr_b16 v[30:31], v3 offset:576
    s_mul_i32 s78, s84, s37
    s_add_u32 m0, s6, 82240
    s_add_u32 s79, s78, s34
    buffer_load_dwordx4 v1, s[8:11], s79 offen lds
    s_waitcnt lgkmcnt(6)
    v_mfma_f32_32x32x16_bf16 v[64:79], v[16:19], v[212:215], v[64:79]
    ds_read_b64_tr_b16 v[12:13], v3 offset:2112
    ds_read_b64_tr_b16 v[14:15], v3 offset:2624
    s_mul_i32 s78, s84, s38
    s_add_u32 m0, s7, 82240
    s_add_u32 s79, s78, s35
    buffer_load_dwordx4 v9, s[12:15], s79 offen lds
    s_waitcnt lgkmcnt(6)
    v_mfma_f32_32x32x16_bf16 v[64:79], v[20:23], v[216:219], v[64:79]
    ds_read_b64_tr_b16 v[16:17], v3 offset:4160
    ds_read_b64_tr_b16 v[18:19], v3 offset:4672
    s_waitcnt lgkmcnt(6)
    v_mfma_f32_32x32x16_bf16 v[64:79], v[24:27], v[220:223], v[64:79]
    ds_read_b64_tr_b16 v[20:21], v3 offset:6208
    ds_read_b64_tr_b16 v[22:23], v3 offset:6720
    s_waitcnt lgkmcnt(6)
    v_mfma_f32_32x32x16_bf16 v[80:95], v[28:31], v[240:243], v[80:95]
    ds_read_b64_tr_b16 v[24:25], v4 offset:64
    ds_read_b64_tr_b16 v[26:27], v4 offset:576
    s_waitcnt lgkmcnt(6)
    v_mfma_f32_32x32x16_bf16 v[80:95], v[12:15], v[244:247], v[80:95]
    ds_read_b64_tr_b16 v[28:29], v4 offset:2112
    ds_read_b64_tr_b16 v[30:31], v4 offset:2624
    s_waitcnt lgkmcnt(6)
    v_mfma_f32_32x32x16_bf16 v[80:95], v[16:19], v[248:251], v[80:95]
    ds_read_b64_tr_b16 v[12:13], v4 offset:4160
    ds_read_b64_tr_b16 v[14:15], v4 offset:4672
    s_waitcnt lgkmcnt(6)
    v_mfma_f32_32x32x16_bf16 v[80:95], v[20:23], v[252:255], v[80:95]
    ds_read_b64_tr_b16 v[16:17], v4 offset:6208
    ds_read_b64_tr_b16 v[18:19], v4 offset:6720
    s_waitcnt lgkmcnt(6)
    v_mfma_f32_32x32x16_bf16 v[96:111], v[24:27], v[240:243], v[96:111]
    ds_read_b64_tr_b16 v[20:21], v3 offset:0
    ds_read_b64_tr_b16 v[22:23], v3 offset:512
    s_waitcnt lgkmcnt(6)
    v_mfma_f32_32x32x16_bf16 v[96:111], v[28:31], v[244:247], v[96:111]
    ds_read_b64_tr_b16 v[24:25], v3 offset:2048
    ds_read_b64_tr_b16 v[26:27], v3 offset:2560
    s_waitcnt lgkmcnt(6)
    v_mfma_f32_32x32x16_bf16 v[96:111], v[12:15], v[248:251], v[96:111]
    ds_read_b64_tr_b16 v[28:29], v3 offset:4096
    ds_read_b64_tr_b16 v[30:31], v3 offset:4608
    v_cvt_pk_bf16_f32 v32, v80, v81
    v_cvt_pk_bf16_f32 v33, v82, v83
    v_cvt_pk_bf16_f32 v34, v84, v85
    v_cvt_pk_bf16_f32 v35, v86, v87
    s_waitcnt lgkmcnt(6)
    v_mfma_f32_32x32x16_bf16 v[96:111], v[16:19], v[252:255], v[96:111]
    ds_read_b64_tr_b16 v[12:13], v3 offset:6144
    ds_read_b64_tr_b16 v[14:15], v3 offset:6656
    v_cvt_pk_bf16_f32 v36, v88, v89
    v_cvt_pk_bf16_f32 v37, v90, v91
    v_cvt_pk_bf16_f32 v38, v92, v93
    v_cvt_pk_bf16_f32 v39, v94, v95
    s_waitcnt lgkmcnt(6)
    v_mfma_f32_32x32x16_bf16 v[48:63], v[20:23], v[240:243], v[48:63]
    ds_read_b64_tr_b16 v[16:17], v3 offset:16512
    ds_read_b64_tr_b16 v[18:19], v3 offset:17024
    buffer_store_dwordx4 v[32:35], v0, s[24:27], s40 offen offset:2048 sc1
    buffer_store_dwordx4 v[36:39], v0, s[24:27], s43 offen offset:2048 sc1
    s_waitcnt lgkmcnt(6)
    v_mfma_f32_32x32x16_bf16 v[48:63], v[24:27], v[244:247], v[48:63]
    ds_read_b64_tr_b16 v[20:21], v3 offset:18560
    ds_read_b64_tr_b16 v[22:23], v3 offset:19072
    s_waitcnt lgkmcnt(6)
    v_mfma_f32_32x32x16_bf16 v[48:63], v[28:31], v[248:251], v[48:63]
    ds_read_b64_tr_b16 v[24:25], v3 offset:20608
    ds_read_b64_tr_b16 v[26:27], v3 offset:21120
    v_cvt_pk_bf16_f32 v40, v96, v97
    v_cvt_pk_bf16_f32 v41, v98, v99
    v_cvt_pk_bf16_f32 v42, v100, v101
    v_cvt_pk_bf16_f32 v43, v102, v103
    s_waitcnt lgkmcnt(6)
    v_mfma_f32_32x32x16_bf16 v[48:63], v[12:15], v[252:255], v[48:63]
    ds_read_b64_tr_b16 v[28:29], v3 offset:22656
    ds_read_b64_tr_b16 v[30:31], v3 offset:23168
    v_cvt_pk_bf16_f32 v44, v104, v105
    v_cvt_pk_bf16_f32 v45, v106, v107
    v_cvt_pk_bf16_f32 v46, v108, v109
    v_cvt_pk_bf16_f32 v47, v110, v111
    s_waitcnt vmcnt(4)
    s_barrier
    s_waitcnt lgkmcnt(6)
    v_mfma_f32_32x32x16_bf16 v[80:95], v[16:19], v[112:115], 0
    ds_read_b64_tr_b16 v[12:13], v3 offset:32960
    ds_read_b64_tr_b16 v[14:15], v3 offset:33472
    s_mul_i32 s78, s85, s37
    s_add_u32 m0, s6, 98688
    s_add_u32 s79, s78, s34
    buffer_load_dwordx4 v1, s[8:11], s79 offen lds
    buffer_store_dwordx4 v[40:43], v0, s[24:27], s40 offen offset:3072 sc1
    buffer_store_dwordx4 v[44:47], v0, s[24:27], s43 offen offset:3072 sc1
    s_waitcnt lgkmcnt(6)
    v_mfma_f32_32x32x16_bf16 v[80:95], v[20:23], v[116:119], v[80:95]
    ds_read_b64_tr_b16 v[16:17], v3 offset:35008
    ds_read_b64_tr_b16 v[18:19], v3 offset:35520
    s_mul_i32 s78, s85, s38
    s_add_u32 m0, s7, 98688
    s_add_u32 s79, s78, s35
    buffer_load_dwordx4 v9, s[12:15], s79 offen lds
    s_waitcnt lgkmcnt(6)
    v_mfma_f32_32x32x16_bf16 v[80:95], v[24:27], v[120:123], v[80:95]
    ds_read_b64_tr_b16 v[20:21], v3 offset:37056
    ds_read_b64_tr_b16 v[22:23], v3 offset:37568
    v_cvt_pk_bf16_f32 v32, v48, v49
    v_cvt_pk_bf16_f32 v33, v50, v51
    v_cvt_pk_bf16_f32 v34, v52, v53
    v_cvt_pk_bf16_f32 v35, v54, v55
    s_waitcnt lgkmcnt(6)
    v_mfma_f32_32x32x16_bf16 v[80:95], v[28:31], v[124:127], v[80:95]
    ds_read_b64_tr_b16 v[24:25], v3 offset:39104
    ds_read_b64_tr_b16 v[26:27], v3 offset:39616
    v_cvt_pk_bf16_f32 v36, v56, v57
    v_cvt_pk_bf16_f32 v37, v58, v59
    v_cvt_pk_bf16_f32 v38, v60, v61
    v_cvt_pk_bf16_f32 v39, v62, v63
    s_waitcnt lgkmcnt(6)
    v_mfma_f32_32x32x16_bf16 v[80:95], v[12:15], v[128:131], v[80:95]
    ds_read_b64_tr_b16 v[28:29], v4 offset:16512
    ds_read_b64_tr_b16 v[30:31], v4 offset:17024
    buffer_store_dwordx4 v[32:35], v0, s[24:27], s40 offen offset:0 sc1
    buffer_store_dwordx4 v[36:39], v0, s[24:27], s43 offen offset:0 sc1
    s_waitcnt lgkmcnt(6)
    v_mfma_f32_32x32x16_bf16 v[80:95], v[16:19], v[132:135], v[80:95]
    ds_read_b64_tr_b16 v[12:13], v4 offset:18560
    ds_read_b64_tr_b16 v[14:15], v4 offset:19072
    s_waitcnt lgkmcnt(6)
    v_mfma_f32_32x32x16_bf16 v[80:95], v[20:23], v[136:139], v[80:95]
    ds_read_b64_tr_b16 v[16:17], v4 offset:20608
    ds_read_b64_tr_b16 v[18:19], v4 offset:21120
    s_waitcnt lgkmcnt(6)
    v_mfma_f32_32x32x16_bf16 v[80:95], v[24:27], v[140:143], v[80:95]
    ds_read_b64_tr_b16 v[20:21], v4 offset:22656
    ds_read_b64_tr_b16 v[22:23], v4 offset:23168
    s_waitcnt lgkmcnt(6)
    v_mfma_f32_32x32x16_bf16 v[96:111], v[28:31], v[112:115], 0
    ds_read_b64_tr_b16 v[24:25], v3 offset:49408
    ds_read_b64_tr_b16 v[26:27], v3 offset:49920
    s_waitcnt lgkmcnt(6)
    v_mfma_f32_32x32x16_bf16 v[96:111], v[12:15], v[116:119], v[96:111]
    ds_read_b64_tr_b16 v[28:29], v3 offset:51456
    ds_read_b64_tr_b16 v[30:31], v3 offset:51968
    s_waitcnt lgkmcnt(6)
    v_mfma_f32_32x32x16_bf16 v[96:111], v[16:19], v[120:123], v[96:111]
    ds_read_b64_tr_b16 v[12:13], v3 offset:53504
    ds_read_b64_tr_b16 v[14:15], v3 offset:54016
    s_waitcnt lgkmcnt(6)
    v_mfma_f32_32x32x16_bf16 v[96:111], v[20:23], v[124:127], v[96:111]
    ds_read_b64_tr_b16 v[16:17], v3 offset:55552
    ds_read_b64_tr_b16 v[18:19], v3 offset:56064
    s_waitcnt lgkmcnt(6)
    v_mfma_f32_32x32x16_bf16 v[80:95], v[24:27], v[144:147], v[80:95]
    ds_read_b64_tr_b16 v[20:21], v4 offset:32960
    ds_read_b64_tr_b16 v[22:23], v4 offset:33472
    s_waitcnt lgkmcnt(6)
    v_mfma_f32_32x32x16_bf16 v[80:95], v[28:31], v[148:151], v[80:95]
    ds_read_b64_tr_b16 v[24:25], v4 offset:35008
    ds_read_b64_tr_b16 v[26:27], v4 offset:35520
    s_waitcnt lgkmcnt(6)
    v_mfma_f32_32x32x16_bf16 v[80:95], v[12:15], v[152:155], v[80:95]
    ds_read_b64_tr_b16 v[28:29], v4 offset:37056
    ds_read_b64_tr_b16 v[30:31], v4 offset:37568
    s_waitcnt lgkmcnt(6)
    v_mfma_f32_32x32x16_bf16 v[80:95], v[16:19], v[156:159], v[80:95]
    ds_read_b64_tr_b16 v[12:13], v4 offset:39104
    ds_read_b64_tr_b16 v[14:15], v4 offset:39616
    s_waitcnt vmcnt(8)
    s_barrier
    s_waitcnt lgkmcnt(6)
    v_mfma_f32_32x32x16_bf16 v[96:111], v[20:23], v[128:131], v[96:111]
    ds_read_b64_tr_b16 v[16:17], v3 offset:16448
    ds_read_b64_tr_b16 v[18:19], v3 offset:16960
    s_waitcnt lgkmcnt(6)
    v_mfma_f32_32x32x16_bf16 v[96:111], v[24:27], v[132:135], v[96:111]
    ds_read_b64_tr_b16 v[20:21], v3 offset:18496
    ds_read_b64_tr_b16 v[22:23], v3 offset:19008
    s_waitcnt lgkmcnt(6)
    v_mfma_f32_32x32x16_bf16 v[96:111], v[28:31], v[136:139], v[96:111]
    ds_read_b64_tr_b16 v[24:25], v3 offset:20544
    ds_read_b64_tr_b16 v[26:27], v3 offset:21056
    s_waitcnt lgkmcnt(6)
    v_mfma_f32_32x32x16_bf16 v[96:111], v[12:15], v[140:143], v[96:111]
    ds_read_b64_tr_b16 v[28:29], v3 offset:22592
    ds_read_b64_tr_b16 v[30:31], v3 offset:23104
    s_waitcnt lgkmcnt(6)
    v_mfma_f32_32x32x16_bf16 v[48:63], v[16:19], v[112:115], 0
    ds_read_b64_tr_b16 v[12:13], v6 offset:49344
    ds_read_b64_tr_b16 v[14:15], v6 offset:49856
    s_waitcnt lgkmcnt(6)
    v_mfma_f32_32x32x16_bf16 v[48:63], v[20:23], v[116:119], v[48:63]
    ds_read_b64_tr_b16 v[16:17], v6 offset:51392
    ds_read_b64_tr_b16 v[18:19], v6 offset:51904
    s_waitcnt lgkmcnt(6)
    v_mfma_f32_32x32x16_bf16 v[48:63], v[24:27], v[120:123], v[48:63]
    ds_read_b64_tr_b16 v[20:21], v6 offset:53440
    ds_read_b64_tr_b16 v[22:23], v6 offset:53952
    s_waitcnt lgkmcnt(6)
    v_mfma_f32_32x32x16_bf16 v[48:63], v[28:31], v[124:127], v[48:63]
    ds_read_b64_tr_b16 v[24:25], v6 offset:55488
    ds_read_b64_tr_b16 v[26:27], v6 offset:56000
    s_waitcnt lgkmcnt(6)
    v_mfma_f32_32x32x16_bf16 v[64:79], v[12:15], v[224:227], v[64:79]
    ds_read_b64_tr_b16 v[28:29], v5 offset:64
    ds_read_b64_tr_b16 v[30:31], v5 offset:576
    s_waitcnt lgkmcnt(6)
    v_mfma_f32_32x32x16_bf16 v[64:79], v[16:19], v[228:231], v[64:79]
    ds_read_b64_tr_b16 v[12:13], v5 offset:2112
    ds_read_b64_tr_b16 v[14:15], v5 offset:2624
    s_waitcnt lgkmcnt(6)
    v_mfma_f32_32x32x16_bf16 v[64:79], v[20:23], v[232:235], v[64:79]
    ds_read_b64_tr_b16 v[16:17], v5 offset:4160
    ds_read_b64_tr_b16 v[18:19], v5 offset:4672
    s_waitcnt lgkmcnt(6)
    v_mfma_f32_32x32x16_bf16 v[64:79], v[24:27], v[236:239], v[64:79]
    ds_read_b64_tr_b16 v[20:21], v5 offset:6208
    ds_read_b64_tr_b16 v[22:23], v5 offset:6720
    s_waitcnt lgkmcnt(6)
    v_mfma_f32_32x32x16_bf16 v[80:95], v[28:31], v[160:163], v[80:95]
    ds_read_b64_tr_b16 v[24:25], v4 offset:49408
    ds_read_b64_tr_b16 v[26:27], v4 offset:49920
    s_waitcnt lgkmcnt(6)
    v_mfma_f32_32x32x16_bf16 v[80:95], v[12:15], v[164:167], v[80:95]
    ds_read_b64_tr_b16 v[28:29], v4 offset:51456
    ds_read_b64_tr_b16 v[30:31], v4 offset:51968
    s_waitcnt lgkmcnt(6)
    v_mfma_f32_32x32x16_bf16 v[80:95], v[16:19], v[168:171], v[80:95]
    ds_read_b64_tr_b16 v[12:13], v4 offset:53504
    ds_read_b64_tr_b16 v[14:15], v4 offset:54016
    s_waitcnt lgkmcnt(6)
    v_mfma_f32_32x32x16_bf16 v[80:95], v[20:23], v[172:175], v[80:95]
    ds_read_b64_tr_b16 v[16:17], v4 offset:55552
    ds_read_b64_tr_b16 v[18:19], v4 offset:56064
    s_waitcnt vmcnt(2)
    s_barrier
    s_waitcnt lgkmcnt(6)
    v_mfma_f32_32x32x16_bf16 v[96:111], v[24:27], v[144:147], v[96:111]
    ds_read_b64_tr_b16 v[20:21], v3 offset:32896
    ds_read_b64_tr_b16 v[22:23], v3 offset:33408
    s_mul_i32 s78, s86, s37
    s_add_u32 m0, s6, 115136
    s_add_u32 s79, s78, s34
    buffer_load_dwordx4 v1, s[8:11], s79 offen lds
    s_waitcnt lgkmcnt(6)
    v_mfma_f32_32x32x16_bf16 v[96:111], v[28:31], v[148:151], v[96:111]
    ds_read_b64_tr_b16 v[24:25], v3 offset:34944
    ds_read_b64_tr_b16 v[26:27], v3 offset:35456
    s_mul_i32 s78, s86, s38
    s_add_u32 m0, s7, 115136
    s_add_u32 s79, s78, s35
    buffer_load_dwordx4 v9, s[12:15], s79 offen lds
    s_waitcnt lgkmcnt(6)
    v_mfma_f32_32x32x16_bf16 v[96:111], v[12:15], v[152:155], v[96:111]
    ds_read_b64_tr_b16 v[28:29], v3 offset:36992
    ds_read_b64_tr_b16 v[30:31], v3 offset:37504
    s_waitcnt lgkmcnt(6)
    v_mfma_f32_32x32x16_bf16 v[96:111], v[16:19], v[156:159], v[96:111]
    ds_read_b64_tr_b16 v[12:13], v3 offset:39040
    ds_read_b64_tr_b16 v[14:15], v3 offset:39552
    s_waitcnt lgkmcnt(6)
    v_mfma_f32_32x32x16_bf16 v[48:63], v[20:23], v[128:131], v[48:63]
    ds_read_b64_tr_b16 v[16:17], v4 offset:0
    ds_read_b64_tr_b16 v[18:19], v4 offset:512
    s_waitcnt lgkmcnt(6)
    v_mfma_f32_32x32x16_bf16 v[48:63], v[24:27], v[132:135], v[48:63]
    ds_read_b64_tr_b16 v[20:21], v4 offset:2048
    ds_read_b64_tr_b16 v[22:23], v4 offset:2560
    s_waitcnt lgkmcnt(6)
    v_mfma_f32_32x32x16_bf16 v[48:63], v[28:31], v[136:139], v[48:63]
    ds_read_b64_tr_b16 v[24:25], v4 offset:4096
    ds_read_b64_tr_b16 v[26:27], v4 offset:4608
    s_waitcnt lgkmcnt(6)
    v_mfma_f32_32x32x16_bf16 v[48:63], v[12:15], v[140:143], v[48:63]
    ds_read_b64_tr_b16 v[28:29], v4 offset:6144
    ds_read_b64_tr_b16 v[30:31], v4 offset:6656
    s_waitcnt lgkmcnt(6)
    v_mfma_f32_32x32x16_bf16 v[64:79], v[16:19], v[240:243], v[64:79]
    ds_read_b64_tr_b16 v[12:13], v5 offset:16512
    ds_read_b64_tr_b16 v[14:15], v5 offset:17024
    s_waitcnt lgkmcnt(6)
    v_mfma_f32_32x32x16_bf16 v[64:79], v[20:23], v[244:247], v[64:79]
    ds_read_b64_tr_b16 v[16:17], v5 offset:18560
    ds_read_b64_tr_b16 v[18:19], v5 offset:19072
    s_waitcnt lgkmcnt(6)
    v_mfma_f32_32x32x16_bf16 v[64:79], v[24:27], v[248:251], v[64:79]
    ds_read_b64_tr_b16 v[20:21], v5 offset:20608
    ds_read_b64_tr_b16 v[22:23], v5 offset:21120
    s_waitcnt lgkmcnt(6)
    v_mfma_f32_32x32x16_bf16 v[64:79], v[28:31], v[252:255], v[64:79]
    ds_read_b64_tr_b16 v[24:25], v5 offset:22656
    ds_read_b64_tr_b16 v[26:27], v5 offset:23168
    s_waitcnt lgkmcnt(6)
    v_mfma_f32_32x32x16_bf16 v[80:95], v[12:15], v[176:179], v[80:95]
    ds_read_b64_tr_b16 v[28:29], v6 offset:64
    ds_read_b64_tr_b16 v[30:31], v6 offset:576
    s_waitcnt lgkmcnt(6)
    v_mfma_f32_32x32x16_bf16 v[80:95], v[16:19], v[180:183], v[80:95]
    ds_read_b64_tr_b16 v[12:13], v6 offset:2112
    ds_read_b64_tr_b16 v[14:15], v6 offset:2624
    s_waitcnt lgkmcnt(6)
    v_mfma_f32_32x32x16_bf16 v[80:95], v[20:23], v[184:187], v[80:95]
    ds_read_b64_tr_b16 v[16:17], v6 offset:4160
    ds_read_b64_tr_b16 v[18:19], v6 offset:4672
    v_cvt_pk_bf16_f32 v40, v64, v65
    v_cvt_pk_bf16_f32 v41, v66, v67
    v_cvt_pk_bf16_f32 v42, v68, v69
    v_cvt_pk_bf16_f32 v43, v70, v71
    s_waitcnt lgkmcnt(6)
    v_mfma_f32_32x32x16_bf16 v[80:95], v[24:27], v[188:191], v[80:95]
    ds_read_b64_tr_b16 v[20:21], v6 offset:6208
    ds_read_b64_tr_b16 v[22:23], v6 offset:6720
    v_cvt_pk_bf16_f32 v44, v72, v73
    v_cvt_pk_bf16_f32 v45, v74, v75
    v_cvt_pk_bf16_f32 v46, v76, v77
    v_cvt_pk_bf16_f32 v47, v78, v79
    s_barrier
    s_waitcnt lgkmcnt(6)
    v_mfma_f32_32x32x16_bf16 v[96:111], v[28:31], v[160:163], v[96:111]
    ds_read_b64_tr_b16 v[24:25], v3 offset:49344
    ds_read_b64_tr_b16 v[26:27], v3 offset:49856
    s_mul_i32 s78, s87, s37
    s_add_u32 m0, s6, 0
    s_add_u32 s79, s78, s34
    buffer_load_dwordx4 v1, s[8:11], s79 offen lds
    buffer_store_dwordx4 v[40:43], v0, s[24:27], s40 offen offset:1024 sc1
    buffer_store_dwordx4 v[44:47], v0, s[24:27], s43 offen offset:1024 sc1
    s_waitcnt lgkmcnt(6)
    v_mfma_f32_32x32x16_bf16 v[96:111], v[12:15], v[164:167], v[96:111]
    ds_read_b64_tr_b16 v[28:29], v3 offset:51392
    ds_read_b64_tr_b16 v[30:31], v3 offset:51904
    s_mul_i32 s78, s87, s38
    s_add_u32 m0, s7, 0
    s_add_u32 s79, s78, s35
    buffer_load_dwordx4 v9, s[12:15], s79 offen lds
    s_waitcnt lgkmcnt(6)
    v_mfma_f32_32x32x16_bf16 v[96:111], v[16:19], v[168:171], v[96:111]
    ds_read_b64_tr_b16 v[12:13], v3 offset:53440
    ds_read_b64_tr_b16 v[14:15], v3 offset:53952
    s_waitcnt lgkmcnt(6)
    v_mfma_f32_32x32x16_bf16 v[96:111], v[20:23], v[172:175], v[96:111]
    ds_read_b64_tr_b16 v[16:17], v3 offset:55488
    ds_read_b64_tr_b16 v[18:19], v3 offset:56000
    s_waitcnt lgkmcnt(6)
    v_mfma_f32_32x32x16_bf16 v[48:63], v[24:27], v[144:147], v[48:63]
    ds_read_b64_tr_b16 v[20:21], v4 offset:16448
    ds_read_b64_tr_b16 v[22:23], v4 offset:16960
    s_waitcnt lgkmcnt(6)
    v_mfma_f32_32x32x16_bf16 v[48:63], v[28:31], v[148:151], v[48:63]
    ds_read_b64_tr_b16 v[24:25], v4 offset:18496
    ds_read_b64_tr_b16 v[26:27], v4 offset:19008
    s_waitcnt lgkmcnt(6)
    v_mfma_f32_32x32x16_bf16 v[48:63], v[12:15], v[152:155], v[48:63]
    ds_read_b64_tr_b16 v[28:29], v4 offset:20544
    ds_read_b64_tr_b16 v[30:31], v4 offset:21056
    s_waitcnt lgkmcnt(6)
    v_mfma_f32_32x32x16_bf16 v[48:63], v[16:19], v[156:159], v[48:63]
    ds_read_b64_tr_b16 v[12:13], v4 offset:22592
    ds_read_b64_tr_b16 v[14:15], v4 offset:23104
    s_waitcnt lgkmcnt(6)
    v_mfma_f32_32x32x16_bf16 v[64:79], v[20:23], v[112:115], 0
    ds_read_b64_tr_b16 v[16:17], v5 offset:32960
    ds_read_b64_tr_b16 v[18:19], v5 offset:33472
    s_waitcnt lgkmcnt(6)
    v_mfma_f32_32x32x16_bf16 v[64:79], v[24:27], v[116:119], v[64:79]
    ds_read_b64_tr_b16 v[20:21], v5 offset:35008
    ds_read_b64_tr_b16 v[22:23], v5 offset:35520
    s_waitcnt lgkmcnt(6)
    v_mfma_f32_32x32x16_bf16 v[64:79], v[28:31], v[120:123], v[64:79]
    ds_read_b64_tr_b16 v[24:25], v5 offset:37056
    ds_read_b64_tr_b16 v[26:27], v5 offset:37568
    s_waitcnt lgkmcnt(6)
    v_mfma_f32_32x32x16_bf16 v[64:79], v[12:15], v[124:127], v[64:79]
    ds_read_b64_tr_b16 v[28:29], v5 offset:39104
    ds_read_b64_tr_b16 v[30:31], v5 offset:39616
    s_waitcnt lgkmcnt(6)
    v_mfma_f32_32x32x16_bf16 v[80:95], v[16:19], v[192:195], v[80:95]
    ds_read_b64_tr_b16 v[12:13], v6 offset:16512
    ds_read_b64_tr_b16 v[14:15], v6 offset:17024
    s_waitcnt lgkmcnt(6)
    v_mfma_f32_32x32x16_bf16 v[80:95], v[20:23], v[196:199], v[80:95]
    ds_read_b64_tr_b16 v[16:17], v6 offset:18560
    ds_read_b64_tr_b16 v[18:19], v6 offset:19072
    s_waitcnt lgkmcnt(6)
    v_mfma_f32_32x32x16_bf16 v[80:95], v[24:27], v[200:203], v[80:95]
    ds_read_b64_tr_b16 v[20:21], v6 offset:20608
    ds_read_b64_tr_b16 v[22:23], v6 offset:21120
    s_waitcnt lgkmcnt(6)
    v_mfma_f32_32x32x16_bf16 v[80:95], v[28:31], v[204:207], v[80:95]
    ds_read_b64_tr_b16 v[24:25], v6 offset:22656
    ds_read_b64_tr_b16 v[26:27], v6 offset:23168
    s_waitcnt vmcnt(4)
    s_barrier
    s_waitcnt lgkmcnt(6)
    v_mfma_f32_32x32x16_bf16 v[96:111], v[12:15], v[176:179], v[96:111]
    ds_read_b64_tr_b16 v[28:29], v5 offset:0
    ds_read_b64_tr_b16 v[30:31], v5 offset:512
    s_mul_i32 s78, s88, s37
    s_add_u32 m0, s6, 16448
    s_add_u32 s79, s78, s34
    buffer_load_dwordx4 v1, s[8:11], s79 offen lds
    s_waitcnt lgkmcnt(6)
    v_mfma_f32_32x32x16_bf16 v[96:111], v[16:19], v[180:183], v[96:111]
    ds_read_b64_tr_b16 v[12:13], v5 offset:2048
    ds_read_b64_tr_b16 v[14:15], v5 offset:2560
    s_mul_i32 s78, s88, s38
    s_add_u32 m0, s7, 16448
    s_add_u32 s79, s78, s35
    buffer_load_dwordx4 v9, s[12:15], s79 offen lds
    s_waitcnt lgkmcnt(6)
    v_mfma_f32_32x32x16_bf16 v[96:111], v[20:23], v[184:187], v[96:111]
    ds_read_b64_tr_b16 v[16:17], v5 offset:4096
    ds_read_b64_tr_b16 v[18:19], v5 offset:4608
    s_waitcnt lgkmcnt(6)
    v_mfma_f32_32x32x16_bf16 v[96:111], v[24:27], v[188:191], v[96:111]
    ds_read_b64_tr_b16 v[20:21], v5 offset:6144
    ds_read_b64_tr_b16 v[22:23], v5 offset:6656
    s_waitcnt lgkmcnt(6)
    v_mfma_f32_32x32x16_bf16 v[48:63], v[28:31], v[160:163], v[48:63]
    ds_read_b64_tr_b16 v[24:25], v4 offset:32896
    ds_read_b64_tr_b16 v[26:27], v4 offset:33408
    s_waitcnt lgkmcnt(6)
    v_mfma_f32_32x32x16_bf16 v[48:63], v[12:15], v[164:167], v[48:63]
    ds_read_b64_tr_b16 v[28:29], v4 offset:34944
    ds_read_b64_tr_b16 v[30:31], v4 offset:35456
    s_waitcnt lgkmcnt(6)
    v_mfma_f32_32x32x16_bf16 v[48:63], v[16:19], v[168:171], v[48:63]
    ds_read_b64_tr_b16 v[12:13], v4 offset:36992
    ds_read_b64_tr_b16 v[14:15], v4 offset:37504
    s_waitcnt lgkmcnt(6)
    v_mfma_f32_32x32x16_bf16 v[48:63], v[20:23], v[172:175], v[48:63]
    ds_read_b64_tr_b16 v[16:17], v4 offset:39040
    ds_read_b64_tr_b16 v[18:19], v4 offset:39552
    s_waitcnt lgkmcnt(6)
    v_mfma_f32_32x32x16_bf16 v[64:79], v[24:27], v[128:131], v[64:79]
    ds_read_b64_tr_b16 v[20:21], v5 offset:49408
    ds_read_b64_tr_b16 v[22:23], v5 offset:49920
    s_waitcnt lgkmcnt(6)
    v_mfma_f32_32x32x16_bf16 v[64:79], v[28:31], v[132:135], v[64:79]
    ds_read_b64_tr_b16 v[24:25], v5 offset:51456
    ds_read_b64_tr_b16 v[26:27], v5 offset:51968
    s_waitcnt lgkmcnt(6)
    v_mfma_f32_32x32x16_bf16 v[64:79], v[12:15], v[136:139], v[64:79]
    ds_read_b64_tr_b16 v[28:29], v5 offset:53504
    ds_read_b64_tr_b16 v[30:31], v5 offset:54016
    s_waitcnt lgkmcnt(6)
    v_mfma_f32_32x32x16_bf16 v[64:79], v[16:19], v[140:143], v[64:79]
    ds_read_b64_tr_b16 v[12:13], v5 offset:55552
    ds_read_b64_tr_b16 v[14:15], v5 offset:56064
    s_waitcnt lgkmcnt(6)
    v_mfma_f32_32x32x16_bf16 v[80:95], v[20:23], v[208:211], v[80:95]
    ds_read_b64_tr_b16 v[16:17], v6 offset:32960
    ds_read_b64_tr_b16 v[18:19], v6 offset:33472
    s_waitcnt lgkmcnt(6)
    v_mfma_f32_32x32x16_bf16 v[80:95], v[24:27], v[212:215], v[80:95]
    ds_read_b64_tr_b16 v[20:21], v6 offset:35008
    ds_read_b64_tr_b16 v[22:23], v6 offset:35520
    s_waitcnt lgkmcnt(6)
    v_mfma_f32_32x32x16_bf16 v[80:95], v[28:31], v[216:219], v[80:95]
    ds_read_b64_tr_b16 v[24:25], v6 offset:37056
    ds_read_b64_tr_b16 v[26:27], v6 offset:37568
    s_waitcnt lgkmcnt(6)
    v_mfma_f32_32x32x16_bf16 v[80:95], v[12:15], v[220:223], v[80:95]
    ds_read_b64_tr_b16 v[28:29], v6 offset:39104
    ds_read_b64_tr_b16 v[30:31], v6 offset:39616
    s_waitcnt vmcnt(2)
    s_barrier
    s_waitcnt lgkmcnt(6)
    v_mfma_f32_32x32x16_bf16 v[96:111], v[16:19], v[192:195], v[96:111]
    ds_read_b64_tr_b16 v[12:13], v5 offset:16448
    ds_read_b64_tr_b16 v[14:15], v5 offset:16960
    s_waitcnt lgkmcnt(6)
    v_mfma_f32_32x32x16_bf16 v[96:111], v[20:23], v[196:199], v[96:111]
    ds_read_b64_tr_b16 v[16:17], v5 offset:18496
    ds_read_b64_tr_b16 v[18:19], v5 offset:19008
    s_waitcnt lgkmcnt(6)
    v_mfma_f32_32x32x16_bf16 v[96:111], v[24:27], v[200:203], v[96:111]
    ds_read_b64_tr_b16 v[20:21], v5 offset:20544
    ds_read_b64_tr_b16 v[22:23], v5 offset:21056
    s_waitcnt lgkmcnt(6)
    v_mfma_f32_32x32x16_bf16 v[96:111], v[28:31], v[204:207], v[96:111]
    ds_read_b64_tr_b16 v[24:25], v5 offset:22592
    ds_read_b64_tr_b16 v[26:27], v5 offset:23104
    s_waitcnt lgkmcnt(6)
    v_mfma_f32_32x32x16_bf16 v[48:63], v[12:15], v[176:179], v[48:63]
    ds_read_b64_tr_b16 v[28:29], v4 offset:49344
    ds_read_b64_tr_b16 v[30:31], v4 offset:49856
    s_waitcnt lgkmcnt(6)
    v_mfma_f32_32x32x16_bf16 v[48:63], v[16:19], v[180:183], v[48:63]
    ds_read_b64_tr_b16 v[12:13], v4 offset:51392
    ds_read_b64_tr_b16 v[14:15], v4 offset:51904
    s_waitcnt lgkmcnt(6)
    v_mfma_f32_32x32x16_bf16 v[48:63], v[20:23], v[184:187], v[48:63]
    ds_read_b64_tr_b16 v[16:17], v4 offset:53440
    ds_read_b64_tr_b16 v[18:19], v4 offset:53952
    s_waitcnt lgkmcnt(6)
    v_mfma_f32_32x32x16_bf16 v[48:63], v[24:27], v[188:191], v[48:63]
    ds_read_b64_tr_b16 v[20:21], v4 offset:55488
    ds_read_b64_tr_b16 v[22:23], v4 offset:56000
    s_waitcnt lgkmcnt(6)
    v_mfma_f32_32x32x16_bf16 v[64:79], v[28:31], v[144:147], v[64:79]
    ds_read_b64_tr_b16 v[24:25], v3 offset:64
    ds_read_b64_tr_b16 v[26:27], v3 offset:576
    s_waitcnt lgkmcnt(6)
    v_mfma_f32_32x32x16_bf16 v[64:79], v[12:15], v[148:151], v[64:79]
    ds_read_b64_tr_b16 v[28:29], v3 offset:2112
    ds_read_b64_tr_b16 v[30:31], v3 offset:2624
    s_waitcnt lgkmcnt(6)
    v_mfma_f32_32x32x16_bf16 v[64:79], v[16:19], v[152:155], v[64:79]
    ds_read_b64_tr_b16 v[12:13], v3 offset:4160
    ds_read_b64_tr_b16 v[14:15], v3 offset:4672
    s_waitcnt lgkmcnt(6)
    v_mfma_f32_32x32x16_bf16 v[64:79], v[20:23], v[156:159], v[64:79]
    ds_read_b64_tr_b16 v[16:17], v3 offset:6208
    ds_read_b64_tr_b16 v[18:19], v3 offset:6720
    s_waitcnt lgkmcnt(6)
    v_mfma_f32_32x32x16_bf16 v[80:95], v[24:27], v[224:227], v[80:95]
    ds_read_b64_tr_b16 v[20:21], v6 offset:49408
    ds_read_b64_tr_b16 v[22:23], v6 offset:49920
    s_waitcnt lgkmcnt(6)
    v_mfma_f32_32x32x16_bf16 v[80:95], v[28:31], v[228:231], v[80:95]
    ds_read_b64_tr_b16 v[24:25], v6 offset:51456
    ds_read_b64_tr_b16 v[26:27], v6 offset:51968
    s_waitcnt lgkmcnt(6)
    v_mfma_f32_32x32x16_bf16 v[80:95], v[12:15], v[232:235], v[80:95]
    ds_read_b64_tr_b16 v[28:29], v6 offset:53504
    ds_read_b64_tr_b16 v[30:31], v6 offset:54016
    s_waitcnt lgkmcnt(6)
    v_mfma_f32_32x32x16_bf16 v[80:95], v[16:19], v[236:239], v[80:95]
    ds_read_b64_tr_b16 v[12:13], v6 offset:55552
    ds_read_b64_tr_b16 v[14:15], v6 offset:56064
    s_waitcnt vmcnt(0)
    s_barrier
    s_waitcnt lgkmcnt(6)
    v_mfma_f32_32x32x16_bf16 v[96:111], v[20:23], v[208:211], v[96:111]
    ds_read_b64_tr_b16 v[16:17], v5 offset:32896
    ds_read_b64_tr_b16 v[18:19], v5 offset:33408
    s_waitcnt lgkmcnt(6)
    v_mfma_f32_32x32x16_bf16 v[96:111], v[24:27], v[212:215], v[96:111]
    ds_read_b64_tr_b16 v[20:21], v5 offset:34944
    ds_read_b64_tr_b16 v[22:23], v5 offset:35456
    s_waitcnt lgkmcnt(6)
    v_mfma_f32_32x32x16_bf16 v[96:111], v[28:31], v[216:219], v[96:111]
    ds_read_b64_tr_b16 v[24:25], v5 offset:36992
    ds_read_b64_tr_b16 v[26:27], v5 offset:37504
    s_waitcnt lgkmcnt(6)
    v_mfma_f32_32x32x16_bf16 v[96:111], v[12:15], v[220:223], v[96:111]
    ds_read_b64_tr_b16 v[28:29], v5 offset:39040
    ds_read_b64_tr_b16 v[30:31], v5 offset:39552
    s_waitcnt lgkmcnt(6)
    v_mfma_f32_32x32x16_bf16 v[48:63], v[16:19], v[192:195], v[48:63]
    ds_read_b64_tr_b16 v[12:13], v6 offset:0
    ds_read_b64_tr_b16 v[14:15], v6 offset:512
    s_waitcnt lgkmcnt(6)
    v_mfma_f32_32x32x16_bf16 v[48:63], v[20:23], v[196:199], v[48:63]
    ds_read_b64_tr_b16 v[16:17], v6 offset:2048
    ds_read_b64_tr_b16 v[18:19], v6 offset:2560
    s_waitcnt lgkmcnt(6)
    v_mfma_f32_32x32x16_bf16 v[48:63], v[24:27], v[200:203], v[48:63]
    ds_read_b64_tr_b16 v[20:21], v6 offset:4096
    ds_read_b64_tr_b16 v[22:23], v6 offset:4608
    s_waitcnt lgkmcnt(6)
    v_mfma_f32_32x32x16_bf16 v[48:63], v[28:31], v[204:207], v[48:63]
    ds_read_b64_tr_b16 v[24:25], v6 offset:6144
    ds_read_b64_tr_b16 v[26:27], v6 offset:6656
    s_waitcnt lgkmcnt(6)
    v_mfma_f32_32x32x16_bf16 v[64:79], v[12:15], v[160:163], v[64:79]
    ds_read_b64_tr_b16 v[28:29], v3 offset:16512
    ds_read_b64_tr_b16 v[30:31], v3 offset:17024
    s_waitcnt lgkmcnt(6)
    v_mfma_f32_32x32x16_bf16 v[64:79], v[16:19], v[164:167], v[64:79]
    ds_read_b64_tr_b16 v[12:13], v3 offset:18560
    ds_read_b64_tr_b16 v[14:15], v3 offset:19072
    s_waitcnt lgkmcnt(6)
    v_mfma_f32_32x32x16_bf16 v[64:79], v[20:23], v[168:171], v[64:79]
    ds_read_b64_tr_b16 v[16:17], v3 offset:20608
    ds_read_b64_tr_b16 v[18:19], v3 offset:21120
    s_waitcnt lgkmcnt(6)
    v_mfma_f32_32x32x16_bf16 v[64:79], v[24:27], v[172:175], v[64:79]
    ds_read_b64_tr_b16 v[20:21], v3 offset:22656
    ds_read_b64_tr_b16 v[22:23], v3 offset:23168
    s_waitcnt lgkmcnt(6)
    v_mfma_f32_32x32x16_bf16 v[80:95], v[28:31], v[240:243], v[80:95]
    ds_read_b64_tr_b16 v[24:25], v4 offset:64
    ds_read_b64_tr_b16 v[26:27], v4 offset:576
    s_waitcnt lgkmcnt(6)
    v_mfma_f32_32x32x16_bf16 v[80:95], v[12:15], v[244:247], v[80:95]
    ds_read_b64_tr_b16 v[28:29], v4 offset:2112
    ds_read_b64_tr_b16 v[30:31], v4 offset:2624
    s_waitcnt lgkmcnt(6)
    v_mfma_f32_32x32x16_bf16 v[80:95], v[16:19], v[248:251], v[80:95]
    ds_read_b64_tr_b16 v[12:13], v4 offset:4160
    ds_read_b64_tr_b16 v[14:15], v4 offset:4672
    s_waitcnt lgkmcnt(6)
    v_mfma_f32_32x32x16_bf16 v[80:95], v[20:23], v[252:255], v[80:95]
    ds_read_b64_tr_b16 v[16:17], v4 offset:6208
    ds_read_b64_tr_b16 v[18:19], v4 offset:6720
    s_waitcnt lgkmcnt(6)
    v_mfma_f32_32x32x16_bf16 v[96:111], v[24:27], v[224:227], v[96:111]
    ds_read_b64_tr_b16 v[20:21], v5 offset:49344
    ds_read_b64_tr_b16 v[22:23], v5 offset:49856
    s_waitcnt lgkmcnt(6)
    v_mfma_f32_32x32x16_bf16 v[96:111], v[28:31], v[228:231], v[96:111]
    ds_read_b64_tr_b16 v[24:25], v5 offset:51392
    ds_read_b64_tr_b16 v[26:27], v5 offset:51904
    s_waitcnt lgkmcnt(6)
    v_mfma_f32_32x32x16_bf16 v[96:111], v[12:15], v[232:235], v[96:111]
    ds_read_b64_tr_b16 v[28:29], v5 offset:53440
    ds_read_b64_tr_b16 v[30:31], v5 offset:53952
    v_cvt_pk_bf16_f32 v32, v80, v81
    v_cvt_pk_bf16_f32 v33, v82, v83
    v_cvt_pk_bf16_f32 v34, v84, v85
    v_cvt_pk_bf16_f32 v35, v86, v87
    s_waitcnt lgkmcnt(6)
    v_mfma_f32_32x32x16_bf16 v[96:111], v[16:19], v[236:239], v[96:111]
    ds_read_b64_tr_b16 v[12:13], v5 offset:55488
    ds_read_b64_tr_b16 v[14:15], v5 offset:56000
    v_cvt_pk_bf16_f32 v36, v88, v89
    v_cvt_pk_bf16_f32 v37, v90, v91
    v_cvt_pk_bf16_f32 v38, v92, v93
    v_cvt_pk_bf16_f32 v39, v94, v95
    s_waitcnt lgkmcnt(6)
    v_mfma_f32_32x32x16_bf16 v[48:63], v[20:23], v[208:211], v[48:63]
    ds_read_b64_tr_b16 v[16:17], v6 offset:16448
    ds_read_b64_tr_b16 v[18:19], v6 offset:16960
    buffer_store_dwordx4 v[32:35], v0, s[24:27], s41 offen offset:2048 sc1
    buffer_store_dwordx4 v[36:39], v0, s[24:27], s44 offen offset:2048 sc1
    s_waitcnt lgkmcnt(6)
    v_mfma_f32_32x32x16_bf16 v[48:63], v[24:27], v[212:215], v[48:63]
    ds_read_b64_tr_b16 v[20:21], v6 offset:18496
    ds_read_b64_tr_b16 v[22:23], v6 offset:19008
    s_waitcnt lgkmcnt(6)
    v_mfma_f32_32x32x16_bf16 v[48:63], v[28:31], v[216:219], v[48:63]
    ds_read_b64_tr_b16 v[24:25], v6 offset:20544
    ds_read_b64_tr_b16 v[26:27], v6 offset:21056
    s_waitcnt lgkmcnt(6)
    v_mfma_f32_32x32x16_bf16 v[48:63], v[12:15], v[220:223], v[48:63]
    ds_read_b64_tr_b16 v[28:29], v6 offset:22592
    ds_read_b64_tr_b16 v[30:31], v6 offset:23104
    s_waitcnt lgkmcnt(6)
    v_mfma_f32_32x32x16_bf16 v[64:79], v[16:19], v[176:179], v[64:79]
    ds_read_b64_tr_b16 v[12:13], v4 offset:16512
    ds_read_b64_tr_b16 v[14:15], v4 offset:17024
    s_waitcnt lgkmcnt(6)
    v_mfma_f32_32x32x16_bf16 v[64:79], v[20:23], v[180:183], v[64:79]
    ds_read_b64_tr_b16 v[16:17], v4 offset:18560
    ds_read_b64_tr_b16 v[18:19], v4 offset:19072
    s_waitcnt lgkmcnt(6)
    v_mfma_f32_32x32x16_bf16 v[64:79], v[24:27], v[184:187], v[64:79]
    ds_read_b64_tr_b16 v[20:21], v4 offset:20608
    ds_read_b64_tr_b16 v[22:23], v4 offset:21120
    s_waitcnt lgkmcnt(6)
    v_mfma_f32_32x32x16_bf16 v[64:79], v[28:31], v[188:191], v[64:79]
    ds_read_b64_tr_b16 v[24:25], v4 offset:22656
    ds_read_b64_tr_b16 v[26:27], v4 offset:23168
    s_waitcnt lgkmcnt(6)
    v_mfma_f32_32x32x16_bf16 v[96:111], v[12:15], v[240:243], v[96:111]
    ds_read_b64_tr_b16 v[28:29], v3 offset:0
    ds_read_b64_tr_b16 v[30:31], v3 offset:512
    s_waitcnt lgkmcnt(6)
    v_mfma_f32_32x32x16_bf16 v[96:111], v[16:19], v[244:247], v[96:111]
    ds_read_b64_tr_b16 v[12:13], v3 offset:2048
    ds_read_b64_tr_b16 v[14:15], v3 offset:2560
    s_waitcnt lgkmcnt(6)
    v_mfma_f32_32x32x16_bf16 v[96:111], v[20:23], v[248:251], v[96:111]
    ds_read_b64_tr_b16 v[16:17], v3 offset:4096
    ds_read_b64_tr_b16 v[18:19], v3 offset:4608
    s_waitcnt lgkmcnt(6)
    v_mfma_f32_32x32x16_bf16 v[96:111], v[24:27], v[252:255], v[96:111]
    ds_read_b64_tr_b16 v[20:21], v3 offset:6144
    ds_read_b64_tr_b16 v[22:23], v3 offset:6656
    s_waitcnt lgkmcnt(6)
    v_mfma_f32_32x32x16_bf16 v[48:63], v[28:31], v[224:227], v[48:63]
    ds_read_b64_tr_b16 v[24:25], v6 offset:32896
    ds_read_b64_tr_b16 v[26:27], v6 offset:33408
    s_waitcnt lgkmcnt(6)
    v_mfma_f32_32x32x16_bf16 v[48:63], v[12:15], v[228:231], v[48:63]
    ds_read_b64_tr_b16 v[28:29], v6 offset:34944
    ds_read_b64_tr_b16 v[30:31], v6 offset:35456
    s_waitcnt lgkmcnt(6)
    v_mfma_f32_32x32x16_bf16 v[48:63], v[16:19], v[232:235], v[48:63]
    ds_read_b64_tr_b16 v[12:13], v6 offset:36992
    ds_read_b64_tr_b16 v[14:15], v6 offset:37504
    v_cvt_pk_bf16_f32 v40, v96, v97
    v_cvt_pk_bf16_f32 v41, v98, v99
    v_cvt_pk_bf16_f32 v42, v100, v101
    v_cvt_pk_bf16_f32 v43, v102, v103
    s_waitcnt lgkmcnt(6)
    v_mfma_f32_32x32x16_bf16 v[48:63], v[20:23], v[236:239], v[48:63]
    ds_read_b64_tr_b16 v[16:17], v6 offset:39040
    ds_read_b64_tr_b16 v[18:19], v6 offset:39552
    v_cvt_pk_bf16_f32 v44, v104, v105
    v_cvt_pk_bf16_f32 v45, v106, v107
    v_cvt_pk_bf16_f32 v46, v108, v109
    v_cvt_pk_bf16_f32 v47, v110, v111
    s_waitcnt lgkmcnt(6)
    v_mfma_f32_32x32x16_bf16 v[64:79], v[24:27], v[192:195], v[64:79]
    ds_read_b64_tr_b16 v[20:21], v3 offset:16448
    ds_read_b64_tr_b16 v[22:23], v3 offset:16960
    buffer_store_dwordx4 v[40:43], v0, s[24:27], s41 offen offset:3072 sc1
    buffer_store_dwordx4 v[44:47], v0, s[24:27], s44 offen offset:3072 sc1
    s_waitcnt lgkmcnt(6)
    v_mfma_f32_32x32x16_bf16 v[64:79], v[28:31], v[196:199], v[64:79]
    ds_read_b64_tr_b16 v[24:25], v3 offset:18496
    ds_read_b64_tr_b16 v[26:27], v3 offset:19008
    s_waitcnt lgkmcnt(6)
    v_mfma_f32_32x32x16_bf16 v[64:79], v[12:15], v[200:203], v[64:79]
    ds_read_b64_tr_b16 v[28:29], v3 offset:20544
    ds_read_b64_tr_b16 v[30:31], v3 offset:21056
    s_waitcnt lgkmcnt(6)
    v_mfma_f32_32x32x16_bf16 v[64:79], v[16:19], v[204:207], v[64:79]
    ds_read_b64_tr_b16 v[12:13], v3 offset:22592
    ds_read_b64_tr_b16 v[14:15], v3 offset:23104
    s_waitcnt lgkmcnt(6)
    v_mfma_f32_32x32x16_bf16 v[48:63], v[20:23], v[240:243], v[48:63]
    ds_read_b64_tr_b16 v[16:17], v6 offset:49344
    ds_read_b64_tr_b16 v[18:19], v6 offset:49856
    s_waitcnt lgkmcnt(6)
    v_mfma_f32_32x32x16_bf16 v[48:63], v[24:27], v[244:247], v[48:63]
    ds_read_b64_tr_b16 v[20:21], v6 offset:51392
    ds_read_b64_tr_b16 v[22:23], v6 offset:51904
    s_waitcnt lgkmcnt(6)
    v_mfma_f32_32x32x16_bf16 v[48:63], v[28:31], v[248:251], v[48:63]
    ds_read_b64_tr_b16 v[24:25], v6 offset:53440
    ds_read_b64_tr_b16 v[26:27], v6 offset:53952
    s_waitcnt lgkmcnt(6)
    v_mfma_f32_32x32x16_bf16 v[48:63], v[12:15], v[252:255], v[48:63]
    ds_read_b64_tr_b16 v[28:29], v6 offset:55488
    ds_read_b64_tr_b16 v[30:31], v6 offset:56000
    s_waitcnt lgkmcnt(6)
    v_mfma_f32_32x32x16_bf16 v[64:79], v[16:19], v[208:211], v[64:79]
    ds_read_b64_tr_b16 v[12:13], v4 offset:0
    ds_read_b64_tr_b16 v[14:15], v4 offset:512
    s_waitcnt lgkmcnt(6)
    v_mfma_f32_32x32x16_bf16 v[64:79], v[20:23], v[212:215], v[64:79]
    ds_read_b64_tr_b16 v[16:17], v4 offset:2048
    ds_read_b64_tr_b16 v[18:19], v4 offset:2560
    s_waitcnt lgkmcnt(6)
    v_mfma_f32_32x32x16_bf16 v[64:79], v[24:27], v[216:219], v[64:79]
    ds_read_b64_tr_b16 v[20:21], v4 offset:4096
    ds_read_b64_tr_b16 v[22:23], v4 offset:4608
    v_cvt_pk_bf16_f32 v32, v48, v49
    v_cvt_pk_bf16_f32 v33, v50, v51
    v_cvt_pk_bf16_f32 v34, v52, v53
    v_cvt_pk_bf16_f32 v35, v54, v55
    s_waitcnt lgkmcnt(6)
    v_mfma_f32_32x32x16_bf16 v[64:79], v[28:31], v[220:223], v[64:79]
    ds_read_b64_tr_b16 v[24:25], v4 offset:6144
    ds_read_b64_tr_b16 v[26:27], v4 offset:6656
    v_cvt_pk_bf16_f32 v36, v56, v57
    v_cvt_pk_bf16_f32 v37, v58, v59
    v_cvt_pk_bf16_f32 v38, v60, v61
    v_cvt_pk_bf16_f32 v39, v62, v63
    s_waitcnt lgkmcnt(6)
    v_mfma_f32_32x32x16_bf16 v[64:79], v[12:15], v[224:227], v[64:79]
    ds_read_b64_tr_b16 v[28:29], v4 offset:16448
    ds_read_b64_tr_b16 v[30:31], v4 offset:16960
    buffer_store_dwordx4 v[32:35], v0, s[24:27], s41 offen offset:0 sc1
    buffer_store_dwordx4 v[36:39], v0, s[24:27], s44 offen offset:0 sc1
    s_waitcnt lgkmcnt(6)
    v_mfma_f32_32x32x16_bf16 v[64:79], v[16:19], v[228:231], v[64:79]
    ds_read_b64_tr_b16 v[12:13], v4 offset:18496
    ds_read_b64_tr_b16 v[14:15], v4 offset:19008
    s_waitcnt lgkmcnt(6)
    v_mfma_f32_32x32x16_bf16 v[64:79], v[20:23], v[232:235], v[64:79]
    ds_read_b64_tr_b16 v[16:17], v4 offset:20544
    ds_read_b64_tr_b16 v[18:19], v4 offset:21056
    s_waitcnt lgkmcnt(6)
    v_mfma_f32_32x32x16_bf16 v[64:79], v[24:27], v[236:239], v[64:79]
    ds_read_b64_tr_b16 v[20:21], v4 offset:22592
    ds_read_b64_tr_b16 v[22:23], v4 offset:23104
    s_waitcnt lgkmcnt(6)
    v_mfma_f32_32x32x16_bf16 v[64:79], v[28:31], v[240:243], v[64:79]
    s_waitcnt lgkmcnt(4)
    v_mfma_f32_32x32x16_bf16 v[64:79], v[12:15], v[244:247], v[64:79]
    s_waitcnt lgkmcnt(2)
    v_mfma_f32_32x32x16_bf16 v[64:79], v[16:19], v[248:251], v[64:79]
    s_waitcnt lgkmcnt(0)
    v_mfma_f32_32x32x16_bf16 v[64:79], v[20:23], v[252:255], v[64:79]
    s_nop 15
    v_cvt_pk_bf16_f32 v40, v64, v65
    v_cvt_pk_bf16_f32 v41, v66, v67
    v_cvt_pk_bf16_f32 v42, v68, v69
    v_cvt_pk_bf16_f32 v43, v70, v71
    v_cvt_pk_bf16_f32 v44, v72, v73
    v_cvt_pk_bf16_f32 v45, v74, v75
    v_cvt_pk_bf16_f32 v46, v76, v77
    v_cvt_pk_bf16_f32 v47, v78, v79
    buffer_store_dwordx4 v[40:43], v0, s[24:27], s41 offen offset:1024 sc1
    buffer_store_dwordx4 v[44:47], v0, s[24:27], s44 offen offset:1024 sc1
    s_waitcnt vmcnt(0)
    s_barrier
    s_cmp_lg_u32 s3, 0
    s_cbranch_scc1 L_lp_q8
    v_mov_b32 v32, s98
    v_mov_b32 v33, s99
    v_mov_b32 v34, s98
    v_mov_b32 v35, s99
    s_lshl_b32 s55, s100, 7
    s_add_u32 s55, s55, 49315840
    s_mov_b64 exec, 0xff
    buffer_store_dwordx4 v[32:35], v0, s[24:27], s55 offen sc1
    s_mov_b64 exec, -1
L_lp_q8:
    s_branch L_late
L_st_kv:
    s_add_u32 s40, s75, 32768
    s_add_u32 s43, s75, 34816
    s_lshr_b32 s73, s71, 1
    s_mul_i32 s73, s73, 5120
    s_add_u32 s73, s73, 25165824
    s_and_b32 s74, s71, 1
    s_mul_i32 s42, s74, 1280
    s_add_u32 s42, s42, s73
    s_add_u32 s42, s42, 2048
    s_lshl_b32 s45, s74, 10
    s_add_u32 s45, s45, s73
    s_lshl_b32 s49, s74, 8
    s_add_u32 s49, s49, s73
    s_add_u32 s49, s49, 4608
    s_lshl_b32 s48, s71, 7
    s_add_u32 s48, s48, 25427968
    s_mov_b32 s46, 0x3eae1a93
    v_mov_b32 v3, v7
    v_mov_b32 v5, v8
    v_lshl_add_u32 v7, v25, 5, v28
    v_add_u32 v8, 65792, v7
    s_waitcnt vmcnt(4)
    s_barrier
    ds_read_b64_tr_b16 v[12:13], v3 offset:8224
    ds_read_b64_tr_b16 v[14:15], v3 offset:8480
    ds_read_b64_tr_b16 v[16:17], v3 offset:9248
    ds_read_b64_tr_b16 v[18:19], v3 offset:9504
    ds_read_b64_tr_b16 v[20:21], v3 offset:10272
    ds_read_b64_tr_b16 v[22:23], v3 offset:10528
    ds_read_b64_tr_b16 v[24:25], v3 offset:11296
    ds_read_b64_tr_b16 v[26:27], v3 offset:11552
    s_waitcnt lgkmcnt(6)
    v_mfma_f32_32x32x16_bf16 v[80:95], v[12:15], v[112:115], 0
    ds_read_b64_tr_b16 v[28:29], v3 offset:8256
    ds_read_b64_tr_b16 v[30:31], v3 offset:8512
    s_lshl_b32 s77, s82, 12
    s_add_u32 s77, s77, s39
    buffer_load_dwordx4 v[144:147], v0, s[24:27], s77 offen offset:0 sc1
    s_waitcnt lgkmcnt(6)
    v_mfma_f32_32x32x16_bf16 v[80:95], v[16:19], v[116:119], v[80:95]
    ds_read_b64_tr_b16 v[12:13], v3 offset:9280
    ds_read_b64_tr_b16 v[14:15], v3 offset:9536
    buffer_load_dwordx4 v[148:151], v0, s[24:27], s77 offen offset:1024 sc1
    s_waitcnt lgkmcnt(6)
    v_mfma_f32_32x32x16_bf16 v[80:95], v[20:23], v[120:123], v[80:95]
    ds_read_b64_tr_b16 v[16:17], v3 offset:10304
    ds_read_b64_tr_b16 v[18:19], v3 offset:10560
    buffer_load_dwordx4 v[152:155], v0, s[24:27], s77 offen offset:2048 sc1
    s_waitcnt lgkmcnt(6)
    v_mfma_f32_32x32x16_bf16 v[80:95], v[24:27], v[124:127], v[80:95]
    ds_read_b64_tr_b16 v[20:21], v3 offset:11328
    ds_read_b64_tr_b16 v[22:23], v3 offset:11584
    buffer_load_dwordx4 v[156:159], v0, s[24:27], s77 offen offset:3072 sc1
    s_waitcnt lgkmcnt(6)
    v_mfma_f32_32x32x16_bf16 v[96:111], v[28:31], v[112:115], 0
    ds_read_b64_tr_b16 v[24:25], v7 offset:0
    ds_read_b64_tr_b16 v[26:27], v7 offset:256
    s_waitcnt lgkmcnt(6)
    v_mfma_f32_32x32x16_bf16 v[96:111], v[12:15], v[116:119], v[96:111]
    ds_read_b64_tr_b16 v[28:29], v7 offset:1024
    ds_read_b64_tr_b16 v[30:31], v7 offset:1280
    s_waitcnt lgkmcnt(6)
    v_mfma_f32_32x32x16_bf16 v[96:111], v[16:19], v[120:123], v[96:111]
    ds_read_b64_tr_b16 v[12:13], v7 offset:2048
    ds_read_b64_tr_b16 v[14:15], v7 offset:2304
    s_waitcnt lgkmcnt(6)
    v_mfma_f32_32x32x16_bf16 v[96:111], v[20:23], v[124:127], v[96:111]
    ds_read_b64_tr_b16 v[16:17], v7 offset:3072
    ds_read_b64_tr_b16 v[18:19], v7 offset:3328
    s_waitcnt vmcnt(4)
    s_barrier
    s_waitcnt lgkmcnt(6)
    v_mfma_f32_32x32x16_bf16 v[48:63], v[24:27], v[112:115], 0
    ds_read_b64_tr_b16 v[20:21], v3 offset:24672
    ds_read_b64_tr_b16 v[22:23], v3 offset:24928
    s_lshl_b32 s77, s83, 12
    s_add_u32 s77, s77, s39
    buffer_load_dwordx4 v[160:163], v0, s[24:27], s77 offen offset:0 sc1
    s_waitcnt lgkmcnt(6)
    v_mfma_f32_32x32x16_bf16 v[48:63], v[28:31], v[116:119], v[48:63]
    ds_read_b64_tr_b16 v[24:25], v3 offset:25696
    ds_read_b64_tr_b16 v[26:27], v3 offset:25952
    buffer_load_dwordx4 v[164:167], v0, s[24:27], s77 offen offset:1024 sc1
    s_waitcnt lgkmcnt(6)
    v_mfma_f32_32x32x16_bf16 v[48:63], v[12:15], v[120:123], v[48:63]
    ds_read_b64_tr_b16 v[28:29], v3 offset:26720
    ds_read_b64_tr_b16 v[30:31], v3 offset:26976
    buffer_load_dwordx4 v[168:171], v0, s[24:27], s77 offen offset:2048 sc1
    s_waitcnt lgkmcnt(6)
    v_mfma_f32_32x32x16_bf16 v[48:63], v[16:19], v[124:127], v[48:63]
    ds_read_b64_tr_b16 v[12:13], v3 offset:27744
    ds_read_b64_tr_b16 v[14:15], v3 offset:28000
    buffer_load_dwordx4 v[172:175], v0, s[24:27], s77 offen offset:3072 sc1
    s_waitcnt lgkmcnt(6)
    v_mfma_f32_32x32x16_bf16 v[80:95], v[20:23], v[128:131], v[80:95]
    ds_read_b64_tr_b16 v[16:17], v3 offset:24704
    ds_read_b64_tr_b16 v[18:19], v3 offset:24960
    s_waitcnt lgkmcnt(6)
    v_mfma_f32_32x32x16_bf16 v[80:95], v[24:27], v[132:135], v[80:95]
    ds_read_b64_tr_b16 v[20:21], v3 offset:25728
    ds_read_b64_tr_b16 v[22:23], v3 offset:25984
    s_waitcnt lgkmcnt(6)
    v_mfma_f32_32x32x16_bf16 v[80:95], v[28:31], v[136:139], v[80:95]
    ds_read_b64_tr_b16 v[24:25], v3 offset:26752
    ds_read_b64_tr_b16 v[26:27], v3 offset:27008
    s_waitcnt lgkmcnt(6)
    v_mfma_f32_32x32x16_bf16 v[80:95], v[12:15], v[140:143], v[80:95]
    ds_read_b64_tr_b16 v[28:29], v3 offset:27776
    ds_read_b64_tr_b16 v[30:31], v3 offset:28032
    s_waitcnt lgkmcnt(6)
    v_mfma_f32_32x32x16_bf16 v[96:111], v[16:19], v[128:131], v[96:111]
    ds_read_b64_tr_b16 v[12:13], v7 offset:16448
    ds_read_b64_tr_b16 v[14:15], v7 offset:16704
    s_waitcnt lgkmcnt(6)
    v_mfma_f32_32x32x16_bf16 v[96:111], v[20:23], v[132:135], v[96:111]
    ds_read_b64_tr_b16 v[16:17], v7 offset:17472
    ds_read_b64_tr_b16 v[18:19], v7 offset:17728
    s_waitcnt lgkmcnt(6)
    v_mfma_f32_32x32x16_bf16 v[96:111], v[24:27], v[136:139], v[96:111]
    ds_read_b64_tr_b16 v[20:21], v7 offset:18496
    ds_read_b64_tr_b16 v[22:23], v7 offset:18752
    s_waitcnt lgkmcnt(6)
    v_mfma_f32_32x32x16_bf16 v[96:111], v[28:31], v[140:143], v[96:111]
    ds_read_b64_tr_b16 v[24:25], v7 offset:19520
    ds_read_b64_tr_b16 v[26:27], v7 offset:19776
    s_waitcnt lgkmcnt(6)
    v_mfma_f32_32x32x16_bf16 v[48:63], v[12:15], v[128:131], v[48:63]
    ds_read_b64_tr_b16 v[28:29], v7 offset:4128
    ds_read_b64_tr_b16 v[30:31], v7 offset:4384
    s_waitcnt lgkmcnt(6)
    v_mfma_f32_32x32x16_bf16 v[48:63], v[16:19], v[132:135], v[48:63]
    ds_read_b64_tr_b16 v[12:13], v7 offset:5152
    ds_read_b64_tr_b16 v[14:15], v7 offset:5408
    s_waitcnt lgkmcnt(6)
    v_mfma_f32_32x32x16_bf16 v[48:63], v[20:23], v[136:139], v[48:63]
    ds_read_b64_tr_b16 v[16:17], v7 offset:6176
    ds_read_b64_tr_b16 v[18:19], v7 offset:6432
    s_waitcnt lgkmcnt(6)
    v_mfma_f32_32x32x16_bf16 v[48:63], v[24:27], v[140:143], v[48:63]
    ds_read_b64_tr_b16 v[20:21], v7 offset:7200
    ds_read_b64_tr_b16 v[22:23], v7 offset:7456
    s_waitcnt vmcnt(4)
    s_barrier
    s_waitcnt lgkmcnt(6)
    v_mfma_f32_32x32x16_bf16 v[64:79], v[112:115], v[28:31], 0
    ds_read_b64_tr_b16 v[24:25], v3 offset:41120
    ds_read_b64_tr_b16 v[26:27], v3 offset:41376
    s_lshl_b32 s77, s84, 12
    s_add_u32 s77, s77, s39
    buffer_load_dwordx4 v[176:179], v0, s[24:27], s77 offen offset:0 sc1
    s_waitcnt lgkmcnt(6)
    v_mfma_f32_32x32x16_bf16 v[64:79], v[116:119], v[12:15], v[64:79]
    ds_read_b64_tr_b16 v[28:29], v3 offset:42144
    ds_read_b64_tr_b16 v[30:31], v3 offset:42400
    buffer_load_dwordx4 v[180:183], v0, s[24:27], s77 offen offset:1024 sc1
    s_waitcnt lgkmcnt(6)
    v_mfma_f32_32x32x16_bf16 v[64:79], v[120:123], v[16:19], v[64:79]
    ds_read_b64_tr_b16 v[12:13], v3 offset:43168
    ds_read_b64_tr_b16 v[14:15], v3 offset:43424
    buffer_load_dwordx4 v[184:187], v0, s[24:27], s77 offen offset:2048 sc1
    s_waitcnt lgkmcnt(6)
    v_mfma_f32_32x32x16_bf16 v[64:79], v[124:127], v[20:23], v[64:79]
    ds_read_b64_tr_b16 v[16:17], v3 offset:44192
    ds_read_b64_tr_b16 v[18:19], v3 offset:44448
    buffer_load_dwordx4 v[188:191], v0, s[24:27], s77 offen offset:3072 sc1
    s_waitcnt lgkmcnt(6)
    v_mfma_f32_32x32x16_bf16 v[80:95], v[24:27], v[144:147], v[80:95]
    ds_read_b64_tr_b16 v[20:21], v3 offset:41152
    ds_read_b64_tr_b16 v[22:23], v3 offset:41408
    s_waitcnt lgkmcnt(6)
    v_mfma_f32_32x32x16_bf16 v[80:95], v[28:31], v[148:151], v[80:95]
    ds_read_b64_tr_b16 v[24:25], v3 offset:42176
    ds_read_b64_tr_b16 v[26:27], v3 offset:42432
    s_waitcnt lgkmcnt(6)
    v_mfma_f32_32x32x16_bf16 v[80:95], v[12:15], v[152:155], v[80:95]
    ds_read_b64_tr_b16 v[28:29], v3 offset:43200
    ds_read_b64_tr_b16 v[30:31], v3 offset:43456
    s_waitcnt lgkmcnt(6)
    v_mfma_f32_32x32x16_bf16 v[80:95], v[16:19], v[156:159], v[80:95]
    ds_read_b64_tr_b16 v[12:13], v3 offset:44224
    ds_read_b64_tr_b16 v[14:15], v3 offset:44480
    s_waitcnt lgkmcnt(6)
    v_mfma_f32_32x32x16_bf16 v[96:111], v[20:23], v[144:147], v[96:111]
    ds_read_b64_tr_b16 v[16:17], v7 offset:32896
    ds_read_b64_tr_b16 v[18:19], v7 offset:33152
    s_waitcnt lgkmcnt(6)
    v_mfma_f32_32x32x16_bf16 v[96:111], v[24:27], v[148:151], v[96:111]
    ds_read_b64_tr_b16 v[20:21], v7 offset:33920
    ds_read_b64_tr_b16 v[22:23], v7 offset:34176
    s_waitcnt lgkmcnt(6)
    v_mfma_f32_32x32x16_bf16 v[96:111], v[28:31], v[152:155], v[96:111]
    ds_read_b64_tr_b16 v[24:25], v7 offset:34944
    ds_read_b64_tr_b16 v[26:27], v7 offset:35200
    s_waitcnt lgkmcnt(6)
    v_mfma_f32_32x32x16_bf16 v[96:111], v[12:15], v[156:159], v[96:111]
    ds_read_b64_tr_b16 v[28:29], v7 offset:35968
    ds_read_b64_tr_b16 v[30:31], v7 offset:36224
    s_waitcnt lgkmcnt(6)
    v_mfma_f32_32x32x16_bf16 v[48:63], v[16:19], v[144:147], v[48:63]
    ds_read_b64_tr_b16 v[12:13], v7 offset:20576
    ds_read_b64_tr_b16 v[14:15], v7 offset:20832
    s_waitcnt lgkmcnt(6)
    v_mfma_f32_32x32x16_bf16 v[48:63], v[20:23], v[148:151], v[48:63]
    ds_read_b64_tr_b16 v[16:17], v7 offset:21600
    ds_read_b64_tr_b16 v[18:19], v7 offset:21856
    s_waitcnt lgkmcnt(6)
    v_mfma_f32_32x32x16_bf16 v[48:63], v[24:27], v[152:155], v[48:63]
    ds_read_b64_tr_b16 v[20:21], v7 offset:22624
    ds_read_b64_tr_b16 v[22:23], v7 offset:22880
    s_waitcnt lgkmcnt(6)
    v_mfma_f32_32x32x16_bf16 v[48:63], v[28:31], v[156:159], v[48:63]
    ds_read_b64_tr_b16 v[24:25], v7 offset:23648
    ds_read_b64_tr_b16 v[26:27], v7 offset:23904
    s_waitcnt vmcnt(4)
    s_barrier
    s_waitcnt lgkmcnt(6)
    v_mfma_f32_32x32x16_bf16 v[64:79], v[128:131], v[12:15], v[64:79]
    ds_read_b64_tr_b16 v[28:29], v3 offset:57568
    ds_read_b64_tr_b16 v[30:31], v3 offset:57824
    s_lshl_b32 s77, s85, 12
    s_add_u32 s77, s77, s39
    buffer_load_dwordx4 v[192:195], v0, s[24:27], s77 offen offset:0 sc1
    s_waitcnt lgkmcnt(6)
    v_mfma_f32_32x32x16_bf16 v[64:79], v[132:135], v[16:19], v[64:79]
    ds_read_b64_tr_b16 v[12:13], v3 offset:58592
    ds_read_b64_tr_b16 v[14:15], v3 offset:58848
    buffer_load_dwordx4 v[196:199], v0, s[24:27], s77 offen offset:1024 sc1
    s_waitcnt lgkmcnt(6)
    v_mfma_f32_32x32x16_bf16 v[64:79], v[136:139], v[20:23], v[64:79]
    ds_read_b64_tr_b16 v[16:17], v3 offset:59616
    ds_read_b64_tr_b16 v[18:19], v3 offset:59872
    buffer_load_dwordx4 v[200:203], v0, s[24:27], s77 offen offset:2048 sc1
    s_waitcnt lgkmcnt(6)
    v_mfma_f32_32x32x16_bf16 v[64:79], v[140:143], v[24:27], v[64:79]
    ds_read_b64_tr_b16 v[20:21], v3 offset:60640
    ds_read_b64_tr_b16 v[22:23], v3 offset:60896
    buffer_load_dwordx4 v[204:207], v0, s[24:27], s77 offen offset:3072 sc1
    s_waitcnt lgkmcnt(6)
    v_mfma_f32_32x32x16_bf16 v[80:95], v[28:31], v[160:163], v[80:95]
    ds_read_b64_tr_b16 v[24:25], v3 offset:57600
    ds_read_b64_tr_b16 v[26:27], v3 offset:57856
    s_mul_i32 s78, s88, s37
    s_add_u32 m0, s6, 0
    s_add_u32 s79, s78, s32
    buffer_load_dwordx4 v1, s[8:11], s79 offen lds
    s_waitcnt lgkmcnt(6)
    v_mfma_f32_32x32x16_bf16 v[80:95], v[12:15], v[164:167], v[80:95]
    ds_read_b64_tr_b16 v[28:29], v3 offset:58624
    ds_read_b64_tr_b16 v[30:31], v3 offset:58880
    s_mul_i32 s78, s88, s38
    s_add_u32 m0, s7, 0
    s_add_u32 s79, s78, s33
    buffer_load_dwordx4 v9, s[12:15], s79 offen lds
    s_waitcnt lgkmcnt(6)
    v_mfma_f32_32x32x16_bf16 v[80:95], v[16:19], v[168:171], v[80:95]
    ds_read_b64_tr_b16 v[12:13], v3 offset:59648
    ds_read_b64_tr_b16 v[14:15], v3 offset:59904
    s_waitcnt lgkmcnt(6)
    v_mfma_f32_32x32x16_bf16 v[80:95], v[20:23], v[172:175], v[80:95]
    ds_read_b64_tr_b16 v[16:17], v3 offset:60672
    ds_read_b64_tr_b16 v[18:19], v3 offset:60928
    s_waitcnt lgkmcnt(6)
    v_mfma_f32_32x32x16_bf16 v[96:111], v[24:27], v[160:163], v[96:111]
    ds_read_b64_tr_b16 v[20:21], v7 offset:49344
    ds_read_b64_tr_b16 v[22:23], v7 offset:49600
    s_waitcnt lgkmcnt(6)
    v_mfma_f32_32x32x16_bf16 v[96:111], v[28:31], v[164:167], v[96:111]
    ds_read_b64_tr_b16 v[24:25], v7 offset:50368
    ds_read_b64_tr_b16 v[26:27], v7 offset:50624
    s_waitcnt lgkmcnt(6)
    v_mfma_f32_32x32x16_bf16 v[96:111], v[12:15], v[168:171], v[96:111]
    ds_read_b64_tr_b16 v[28:29], v7 offset:51392
    ds_read_b64_tr_b16 v[30:31], v7 offset:51648
    s_waitcnt lgkmcnt(6)
    v_mfma_f32_32x32x16_bf16 v[96:111], v[16:19], v[172:175], v[96:111]
    ds_read_b64_tr_b16 v[12:13], v7 offset:52416
    ds_read_b64_tr_b16 v[14:15], v7 offset:52672
    s_waitcnt lgkmcnt(6)
    v_mfma_f32_32x32x16_bf16 v[48:63], v[20:23], v[160:163], v[48:63]
    ds_read_b64_tr_b16 v[16:17], v7 offset:37024
    ds_read_b64_tr_b16 v[18:19], v7 offset:37280
    s_waitcnt lgkmcnt(6)
    v_mfma_f32_32x32x16_bf16 v[48:63], v[24:27], v[164:167], v[48:63]
    ds_read_b64_tr_b16 v[20:21], v7 offset:38048
    ds_read_b64_tr_b16 v[22:23], v7 offset:38304
    s_waitcnt lgkmcnt(6)
    v_mfma_f32_32x32x16_bf16 v[48:63], v[28:31], v[168:171], v[48:63]
    ds_read_b64_tr_b16 v[24:25], v7 offset:39072
    ds_read_b64_tr_b16 v[26:27], v7 offset:39328
    s_waitcnt lgkmcnt(6)
    v_mfma_f32_32x32x16_bf16 v[48:63], v[12:15], v[172:175], v[48:63]
    ds_read_b64_tr_b16 v[28:29], v7 offset:40096
    ds_read_b64_tr_b16 v[30:31], v7 offset:40352
    s_waitcnt vmcnt(6)
    s_barrier
    s_waitcnt lgkmcnt(6)
    v_mfma_f32_32x32x16_bf16 v[64:79], v[144:147], v[16:19], v[64:79]
    ds_read_b64_tr_b16 v[12:13], v5 offset:8224
    ds_read_b64_tr_b16 v[14:15], v5 offset:8480
    s_lshl_b32 s77, s86, 12
    s_add_u32 s77, s77, s39
    buffer_load_dwordx4 v[208:211], v0, s[24:27], s77 offen offset:0 sc1
    s_waitcnt lgkmcnt(6)
    v_mfma_f32_32x32x16_bf16 v[64:79], v[148:151], v[20:23], v[64:79]
    ds_read_b64_tr_b16 v[16:17], v5 offset:9248
    ds_read_b64_tr_b16 v[18:19], v5 offset:9504
    buffer_load_dwordx4 v[212:215], v0, s[24:27], s77 offen offset:1024 sc1
    s_waitcnt lgkmcnt(6)
    v_mfma_f32_32x32x16_bf16 v[64:79], v[152:155], v[24:27], v[64:79]
    ds_read_b64_tr_b16 v[20:21], v5 offset:10272
    ds_read_b64_tr_b16 v[22:23], v5 offset:10528
    buffer_load_dwordx4 v[216:219], v0, s[24:27], s77 offen offset:2048 sc1
    s_waitcnt lgkmcnt(6)
    v_mfma_f32_32x32x16_bf16 v[64:79], v[156:159], v[28:31], v[64:79]
    ds_read_b64_tr_b16 v[24:25], v5 offset:11296
    ds_read_b64_tr_b16 v[26:27], v5 offset:11552
    buffer_load_dwordx4 v[220:223], v0, s[24:27], s77 offen offset:3072 sc1
    s_waitcnt lgkmcnt(6)
    v_mfma_f32_32x32x16_bf16 v[80:95], v[12:15], v[176:179], v[80:95]
    ds_read_b64_tr_b16 v[28:29], v5 offset:8256
    ds_read_b64_tr_b16 v[30:31], v5 offset:8512
    s_waitcnt lgkmcnt(6)
    v_mfma_f32_32x32x16_bf16 v[80:95], v[16:19], v[180:183], v[80:95]
    ds_read_b64_tr_b16 v[12:13], v5 offset:9280
    ds_read_b64_tr_b16 v[14:15], v5 offset:9536
    s_waitcnt lgkmcnt(6)
    v_mfma_f32_32x32x16_bf16 v[80:95], v[20:23], v[184:187], v[80:95]
    ds_read_b64_tr_b16 v[16:17], v5 offset:10304
    ds_read_b64_tr_b16 v[18:19], v5 offset:10560
    s_waitcnt lgkmcnt(6)
    v_mfma_f32_32x32x16_bf16 v[80:95], v[24:27], v[188:191], v[80:95]
    ds_read_b64_tr_b16 v[20:21], v5 offset:11328
    ds_read_b64_tr_b16 v[22:23], v5 offset:11584
    s_waitcnt lgkmcnt(6)
    v_mfma_f32_32x32x16_bf16 v[96:111], v[28:31], v[176:179], v[96:111]
    ds_read_b64_tr_b16 v[24:25], v8 offset:0
    ds_read_b64_tr_b16 v[26:27], v8 offset:256
    s_waitcnt lgkmcnt(6)
    v_mfma_f32_32x32x16_bf16 v[96:111], v[12:15], v[180:183], v[96:111]
    ds_read_b64_tr_b16 v[28:29], v8 offset:1024
    ds_read_b64_tr_b16 v[30:31], v8 offset:1280
    s_waitcnt lgkmcnt(6)
    v_mfma_f32_32x32x16_bf16 v[96:111], v[16:19], v[184:187], v[96:111]
    ds_read_b64_tr_b16 v[12:13], v8 offset:2048
    ds_read_b64_tr_b16 v[14:15], v8 offset:2304
    s_waitcnt lgkmcnt(6)
    v_mfma_f32_32x32x16_bf16 v[96:111], v[20:23], v[188:191], v[96:111]
    ds_read_b64_tr_b16 v[16:17], v8 offset:3072
    ds_read_b64_tr_b16 v[18:19], v8 offset:3328
    s_waitcnt lgkmcnt(6)
    v_mfma_f32_32x32x16_bf16 v[48:63], v[24:27], v[176:179], v[48:63]
    ds_read_b64_tr_b16 v[20:21], v7 offset:53472
    ds_read_b64_tr_b16 v[22:23], v7 offset:53728
    s_waitcnt lgkmcnt(6)
    v_mfma_f32_32x32x16_bf16 v[48:63], v[28:31], v[180:183], v[48:63]
    ds_read_b64_tr_b16 v[24:25], v7 offset:54496
    ds_read_b64_tr_b16 v[26:27], v7 offset:54752
    s_waitcnt lgkmcnt(6)
    v_mfma_f32_32x32x16_bf16 v[48:63], v[12:15], v[184:187], v[48:63]
    ds_read_b64_tr_b16 v[28:29], v7 offset:55520
    ds_read_b64_tr_b16 v[30:31], v7 offset:55776
    s_waitcnt lgkmcnt(6)
    v_mfma_f32_32x32x16_bf16 v[48:63], v[16:19], v[188:191], v[48:63]
    ds_read_b64_tr_b16 v[12:13], v7 offset:56544
    ds_read_b64_tr_b16 v[14:15], v7 offset:56800
    s_waitcnt vmcnt(6)
    s_barrier
    s_waitcnt lgkmcnt(6)
    v_mfma_f32_32x32x16_bf16 v[64:79], v[160:163], v[20:23], v[64:79]
    ds_read_b64_tr_b16 v[16:17], v5 offset:24672
    ds_read_b64_tr_b16 v[18:19], v5 offset:24928
    s_lshl_b32 s77, s87, 12
    s_add_u32 s77, s77, s39
    buffer_load_dwordx4 v[224:227], v0, s[24:27], s77 offen offset:0 sc1
    s_waitcnt lgkmcnt(6)
    v_mfma_f32_32x32x16_bf16 v[64:79], v[164:167], v[24:27], v[64:79]
    ds_read_b64_tr_b16 v[20:21], v5 offset:25696
    ds_read_b64_tr_b16 v[22:23], v5 offset:25952
    buffer_load_dwordx4 v[228:231], v0, s[24:27], s77 offen offset:1024 sc1
    s_waitcnt lgkmcnt(6)
    v_mfma_f32_32x32x16_bf16 v[64:79], v[168:171], v[28:31], v[64:79]
    ds_read_b64_tr_b16 v[24:25], v5 offset:26720
    ds_read_b64_tr_b16 v[26:27], v5 offset:26976
    buffer_load_dwordx4 v[232:235], v0, s[24:27], s77 offen offset:2048 sc1
    s_waitcnt lgkmcnt(6)
    v_mfma_f32_32x32x16_bf16 v[64:79], v[172:175], v[12:15], v[64:79]
    ds_read_b64_tr_b16 v[28:29], v5 offset:27744
    ds_read_b64_tr_b16 v[30:31], v5 offset:28000
    buffer_load_dwordx4 v[236:239], v0, s[24:27], s77 offen offset:3072 sc1
    s_waitcnt lgkmcnt(6)
    v_mfma_f32_32x32x16_bf16 v[80:95], v[16:19], v[192:195], v[80:95]
    ds_read_b64_tr_b16 v[12:13], v5 offset:24704
    ds_read_b64_tr_b16 v[14:15], v5 offset:24960
    s_waitcnt lgkmcnt(6)
    v_mfma_f32_32x32x16_bf16 v[80:95], v[20:23], v[196:199], v[80:95]
    ds_read_b64_tr_b16 v[16:17], v5 offset:25728
    ds_read_b64_tr_b16 v[18:19], v5 offset:25984
    s_waitcnt lgkmcnt(6)
    v_mfma_f32_32x32x16_bf16 v[80:95], v[24:27], v[200:203], v[80:95]
    ds_read_b64_tr_b16 v[20:21], v5 offset:26752
    ds_read_b64_tr_b16 v[22:23], v5 offset:27008
    s_waitcnt lgkmcnt(6)
    v_mfma_f32_32x32x16_bf16 v[80:95], v[28:31], v[204:207], v[80:95]
    ds_read_b64_tr_b16 v[24:25], v5 offset:27776
    ds_read_b64_tr_b16 v[26:27], v5 offset:28032
    s_waitcnt lgkmcnt(6)
    v_mfma_f32_32x32x16_bf16 v[96:111], v[12:15], v[192:195], v[96:111]
    ds_read_b64_tr_b16 v[28:29], v8 offset:16448
    ds_read_b64_tr_b16 v[30:31], v8 offset:16704
    s_waitcnt lgkmcnt(6)
    v_mfma_f32_32x32x16_bf16 v[96:111], v[16:19], v[196:199], v[96:111]
    ds_read_b64_tr_b16 v[12:13], v8 offset:17472
    ds_read_b64_tr_b16 v[14:15], v8 offset:17728
    s_waitcnt lgkmcnt(6)
    v_mfma_f32_32x32x16_bf16 v[96:111], v[20:23], v[200:203], v[96:111]
    ds_read_b64_tr_b16 v[16:17], v8 offset:18496
    ds_read_b64_tr_b16 v[18:19], v8 offset:18752
    s_waitcnt lgkmcnt(6)
    v_mfma_f32_32x32x16_bf16 v[96:111], v[24:27], v[204:207], v[96:111]
    ds_read_b64_tr_b16 v[20:21], v8 offset:19520
    ds_read_b64_tr_b16 v[22:23], v8 offset:19776
    s_waitcnt lgkmcnt(6)
    v_mfma_f32_32x32x16_bf16 v[48:63], v[28:31], v[192:195], v[48:63]
    ds_read_b64_tr_b16 v[24:25], v8 offset:4128
    ds_read_b64_tr_b16 v[26:27], v8 offset:4384
    s_waitcnt lgkmcnt(6)
    v_mfma_f32_32x32x16_bf16 v[48:63], v[12:15], v[196:199], v[48:63]
    ds_read_b64_tr_b16 v[28:29], v8 offset:5152
    ds_read_b64_tr_b16 v[30:31], v8 offset:5408
    s_waitcnt lgkmcnt(6)
    v_mfma_f32_32x32x16_bf16 v[48:63], v[16:19], v[200:203], v[48:63]
    ds_read_b64_tr_b16 v[12:13], v8 offset:6176
    ds_read_b64_tr_b16 v[14:15], v8 offset:6432
    s_waitcnt lgkmcnt(6)
    v_mfma_f32_32x32x16_bf16 v[48:63], v[20:23], v[204:207], v[48:63]
    ds_read_b64_tr_b16 v[16:17], v8 offset:7200
    ds_read_b64_tr_b16 v[18:19], v8 offset:7456
    s_waitcnt vmcnt(4)
    s_barrier
    s_waitcnt lgkmcnt(6)
    v_mfma_f32_32x32x16_bf16 v[64:79], v[176:179], v[24:27], v[64:79]
    ds_read_b64_tr_b16 v[20:21], v5 offset:41120
    ds_read_b64_tr_b16 v[22:23], v5 offset:41376
    s_lshl_b32 s77, s88, 12
    s_add_u32 s77, s77, s39
    buffer_load_dwordx4 v[240:243], v0, s[24:27], s77 offen offset:0 sc1
    s_waitcnt lgkmcnt(6)
    v_mfma_f32_32x32x16_bf16 v[64:79], v[180:183], v[28:31], v[64:79]
    ds_read_b64_tr_b16 v[24:25], v5 offset:42144
    ds_read_b64_tr_b16 v[26:27], v5 offset:42400
    buffer_load_dwordx4 v[244:247], v0, s[24:27], s77 offen offset:1024 sc1
    s_waitcnt lgkmcnt(6)
    v_mfma_f32_32x32x16_bf16 v[64:79], v[184:187], v[12:15], v[64:79]
    ds_read_b64_tr_b16 v[28:29], v5 offset:43168
    ds_read_b64_tr_b16 v[30:31], v5 offset:43424
    buffer_load_dwordx4 v[248:251], v0, s[24:27], s77 offen offset:2048 sc1
    s_waitcnt lgkmcnt(6)
    v_mfma_f32_32x32x16_bf16 v[64:79], v[188:191], v[16:19], v[64:79]
    ds_read_b64_tr_b16 v[12:13], v5 offset:44192
    ds_read_b64_tr_b16 v[14:15], v5 offset:44448
    buffer_load_dwordx4 v[252:255], v0, s[24:27], s77 offen offset:3072 sc1
    s_waitcnt lgkmcnt(6)
    v_mfma_f32_32x32x16_bf16 v[80:95], v[20:23], v[208:211], v[80:95]
    ds_read_b64_tr_b16 v[16:17], v5 offset:41152
    ds_read_b64_tr_b16 v[18:19], v5 offset:41408
    s_waitcnt lgkmcnt(6)
    v_mfma_f32_32x32x16_bf16 v[80:95], v[24:27], v[212:215], v[80:95]
    ds_read_b64_tr_b16 v[20:21], v5 offset:42176
    ds_read_b64_tr_b16 v[22:23], v5 offset:42432
    s_waitcnt lgkmcnt(6)
    v_mfma_f32_32x32x16_bf16 v[80:95], v[28:31], v[216:219], v[80:95]
    ds_read_b64_tr_b16 v[24:25], v5 offset:43200
    ds_read_b64_tr_b16 v[26:27], v5 offset:43456
    s_waitcnt lgkmcnt(6)
    v_mfma_f32_32x32x16_bf16 v[80:95], v[12:15], v[220:223], v[80:95]
    ds_read_b64_tr_b16 v[28:29], v5 offset:44224
    ds_read_b64_tr_b16 v[30:31], v5 offset:44480
    s_waitcnt lgkmcnt(6)
    v_mfma_f32_32x32x16_bf16 v[96:111], v[16:19], v[208:211], v[96:111]
    ds_read_b64_tr_b16 v[12:13], v8 offset:32896
    ds_read_b64_tr_b16 v[14:15], v8 offset:33152
    s_waitcnt lgkmcnt(6)
    v_mfma_f32_32x32x16_bf16 v[96:111], v[20:23], v[212:215], v[96:111]
    ds_read_b64_tr_b16 v[16:17], v8 offset:33920
    ds_read_b64_tr_b16 v[18:19], v8 offset:34176
    s_waitcnt lgkmcnt(6)
    v_mfma_f32_32x32x16_bf16 v[96:111], v[24:27], v[216:219], v[96:111]
    ds_read_b64_tr_b16 v[20:21], v8 offset:34944
    ds_read_b64_tr_b16 v[22:23], v8 offset:35200
    s_waitcnt lgkmcnt(6)
    v_mfma_f32_32x32x16_bf16 v[96:111], v[28:31], v[220:223], v[96:111]
    ds_read_b64_tr_b16 v[24:25], v8 offset:35968
    ds_read_b64_tr_b16 v[26:27], v8 offset:36224
    s_waitcnt lgkmcnt(6)
    v_mfma_f32_32x32x16_bf16 v[48:63], v[12:15], v[208:211], v[48:63]
    ds_read_b64_tr_b16 v[28:29], v8 offset:20576
    ds_read_b64_tr_b16 v[30:31], v8 offset:20832
    s_waitcnt lgkmcnt(6)
    v_mfma_f32_32x32x16_bf16 v[48:63], v[16:19], v[212:215], v[48:63]
    ds_read_b64_tr_b16 v[12:13], v8 offset:21600
    ds_read_b64_tr_b16 v[14:15], v8 offset:21856
    s_waitcnt lgkmcnt(6)
    v_mfma_f32_32x32x16_bf16 v[48:63], v[20:23], v[216:219], v[48:63]
    ds_read_b64_tr_b16 v[16:17], v8 offset:22624
    ds_read_b64_tr_b16 v[18:19], v8 offset:22880
    s_waitcnt lgkmcnt(6)
    v_mfma_f32_32x32x16_bf16 v[48:63], v[24:27], v[220:223], v[48:63]
    ds_read_b64_tr_b16 v[20:21], v8 offset:23648
    ds_read_b64_tr_b16 v[22:23], v8 offset:23904
    s_waitcnt vmcnt(4)
    s_barrier
    s_waitcnt lgkmcnt(6)
    v_mfma_f32_32x32x16_bf16 v[64:79], v[192:195], v[28:31], v[64:79]
    ds_read_b64_tr_b16 v[24:25], v5 offset:57568
    ds_read_b64_tr_b16 v[26:27], v5 offset:57824
    s_waitcnt lgkmcnt(6)
    v_mfma_f32_32x32x16_bf16 v[64:79], v[196:199], v[12:15], v[64:79]
    ds_read_b64_tr_b16 v[28:29], v5 offset:58592
    ds_read_b64_tr_b16 v[30:31], v5 offset:58848
    s_waitcnt lgkmcnt(6)
    v_mfma_f32_32x32x16_bf16 v[64:79], v[200:203], v[16:19], v[64:79]
    ds_read_b64_tr_b16 v[12:13], v5 offset:59616
    ds_read_b64_tr_b16 v[14:15], v5 offset:59872
    s_waitcnt lgkmcnt(6)
    v_mfma_f32_32x32x16_bf16 v[64:79], v[204:207], v[20:23], v[64:79]
    ds_read_b64_tr_b16 v[16:17], v5 offset:60640
    ds_read_b64_tr_b16 v[18:19], v5 offset:60896
    s_waitcnt lgkmcnt(6)
    v_mfma_f32_32x32x16_bf16 v[80:95], v[24:27], v[224:227], v[80:95]
    ds_read_b64_tr_b16 v[20:21], v5 offset:57600
    ds_read_b64_tr_b16 v[22:23], v5 offset:57856
    s_waitcnt lgkmcnt(6)
    v_mfma_f32_32x32x16_bf16 v[80:95], v[28:31], v[228:231], v[80:95]
    ds_read_b64_tr_b16 v[24:25], v5 offset:58624
    ds_read_b64_tr_b16 v[26:27], v5 offset:58880
    s_waitcnt lgkmcnt(6)
    v_mfma_f32_32x32x16_bf16 v[80:95], v[12:15], v[232:235], v[80:95]
    ds_read_b64_tr_b16 v[28:29], v5 offset:59648
    ds_read_b64_tr_b16 v[30:31], v5 offset:59904
    s_waitcnt lgkmcnt(6)
    v_mfma_f32_32x32x16_bf16 v[80:95], v[16:19], v[236:239], v[80:95]
    ds_read_b64_tr_b16 v[12:13], v5 offset:60672
    ds_read_b64_tr_b16 v[14:15], v5 offset:60928
    s_waitcnt lgkmcnt(6)
    v_mfma_f32_32x32x16_bf16 v[96:111], v[20:23], v[224:227], v[96:111]
    ds_read_b64_tr_b16 v[16:17], v8 offset:49344
    ds_read_b64_tr_b16 v[18:19], v8 offset:49600
    s_waitcnt lgkmcnt(6)
    v_mfma_f32_32x32x16_bf16 v[96:111], v[24:27], v[228:231], v[96:111]
    ds_read_b64_tr_b16 v[20:21], v8 offset:50368
    ds_read_b64_tr_b16 v[22:23], v8 offset:50624
    s_waitcnt lgkmcnt(6)
    v_mfma_f32_32x32x16_bf16 v[96:111], v[28:31], v[232:235], v[96:111]
    ds_read_b64_tr_b16 v[24:25], v8 offset:51392
    ds_read_b64_tr_b16 v[26:27], v8 offset:51648
    s_waitcnt lgkmcnt(6)
    v_mfma_f32_32x32x16_bf16 v[96:111], v[12:15], v[236:239], v[96:111]
    ds_read_b64_tr_b16 v[28:29], v8 offset:52416
    ds_read_b64_tr_b16 v[30:31], v8 offset:52672
    s_waitcnt lgkmcnt(6)
    v_mfma_f32_32x32x16_bf16 v[48:63], v[16:19], v[224:227], v[48:63]
    ds_read_b64_tr_b16 v[12:13], v8 offset:37024
    ds_read_b64_tr_b16 v[14:15], v8 offset:37280
    s_waitcnt lgkmcnt(6)
    v_mfma_f32_32x32x16_bf16 v[48:63], v[20:23], v[228:231], v[48:63]
    ds_read_b64_tr_b16 v[16:17], v8 offset:38048
    ds_read_b64_tr_b16 v[18:19], v8 offset:38304
    s_waitcnt lgkmcnt(6)
    v_mfma_f32_32x32x16_bf16 v[48:63], v[24:27], v[232:235], v[48:63]
    ds_read_b64_tr_b16 v[20:21], v8 offset:39072
    ds_read_b64_tr_b16 v[22:23], v8 offset:39328
    s_waitcnt lgkmcnt(6)
    v_mfma_f32_32x32x16_bf16 v[48:63], v[28:31], v[236:239], v[48:63]
    ds_read_b64_tr_b16 v[24:25], v8 offset:40096
    ds_read_b64_tr_b16 v[26:27], v8 offset:40352
    s_waitcnt vmcnt(0)
    s_barrier
    s_waitcnt lgkmcnt(6)
    v_mfma_f32_32x32x16_bf16 v[64:79], v[208:211], v[12:15], v[64:79]
    ds_read_b64_tr_b16 v[28:29], v3 offset:8224
    ds_read_b64_tr_b16 v[30:31], v3 offset:8480
    s_waitcnt lgkmcnt(6)
    v_mfma_f32_32x32x16_bf16 v[64:79], v[212:215], v[16:19], v[64:79]
    ds_read_b64_tr_b16 v[12:13], v3 offset:9248
    ds_read_b64_tr_b16 v[14:15], v3 offset:9504
    s_waitcnt lgkmcnt(6)
    v_mfma_f32_32x32x16_bf16 v[64:79], v[216:219], v[20:23], v[64:79]
    ds_read_b64_tr_b16 v[16:17], v3 offset:10272
    ds_read_b64_tr_b16 v[18:19], v3 offset:10528
    s_waitcnt lgkmcnt(6)
    v_mfma_f32_32x32x16_bf16 v[64:79], v[220:223], v[24:27], v[64:79]
    ds_read_b64_tr_b16 v[20:21], v3 offset:11296
    ds_read_b64_tr_b16 v[22:23], v3 offset:11552
    s_waitcnt lgkmcnt(6)
    v_mfma_f32_32x32x16_bf16 v[80:95], v[28:31], v[240:243], v[80:95]
    ds_read_b64_tr_b16 v[24:25], v3 offset:8256
    ds_read_b64_tr_b16 v[26:27], v3 offset:8512
    s_waitcnt lgkmcnt(6)
    v_mfma_f32_32x32x16_bf16 v[80:95], v[12:15], v[244:247], v[80:95]
    ds_read_b64_tr_b16 v[28:29], v3 offset:9280
    ds_read_b64_tr_b16 v[30:31], v3 offset:9536
    s_waitcnt lgkmcnt(6)
    v_mfma_f32_32x32x16_bf16 v[80:95], v[16:19], v[248:251], v[80:95]
    ds_read_b64_tr_b16 v[12:13], v3 offset:10304
    ds_read_b64_tr_b16 v[14:15], v3 offset:10560
    s_waitcnt lgkmcnt(6)
    v_mfma_f32_32x32x16_bf16 v[80:95], v[20:23], v[252:255], v[80:95]
    ds_read_b64_tr_b16 v[16:17], v3 offset:11328
    ds_read_b64_tr_b16 v[18:19], v3 offset:11584
    s_waitcnt lgkmcnt(6)
    v_mfma_f32_32x32x16_bf16 v[96:111], v[24:27], v[240:243], v[96:111]
    ds_read_b64_tr_b16 v[20:21], v7 offset:0
    ds_read_b64_tr_b16 v[22:23], v7 offset:256
    s_waitcnt lgkmcnt(6)
    v_mfma_f32_32x32x16_bf16 v[96:111], v[28:31], v[244:247], v[96:111]
    ds_read_b64_tr_b16 v[24:25], v7 offset:1024
    ds_read_b64_tr_b16 v[26:27], v7 offset:1280
    s_waitcnt lgkmcnt(6)
    v_mfma_f32_32x32x16_bf16 v[96:111], v[12:15], v[248:251], v[96:111]
    ds_read_b64_tr_b16 v[28:29], v7 offset:2048
    ds_read_b64_tr_b16 v[30:31], v7 offset:2304
    s_waitcnt lgkmcnt(6)
    v_mfma_f32_32x32x16_bf16 v[96:111], v[16:19], v[252:255], v[96:111]
    ds_read_b64_tr_b16 v[12:13], v7 offset:3072
    ds_read_b64_tr_b16 v[14:15], v7 offset:3328
    s_waitcnt lgkmcnt(6)
    v_mfma_f32_32x32x16_bf16 v[48:63], v[20:23], v[240:243], v[48:63]
    ds_read_b64_tr_b16 v[16:17], v8 offset:53472
    ds_read_b64_tr_b16 v[18:19], v8 offset:53728
    s_waitcnt lgkmcnt(6)
    v_mfma_f32_32x32x16_bf16 v[48:63], v[24:27], v[244:247], v[48:63]
    ds_read_b64_tr_b16 v[20:21], v8 offset:54496
    ds_read_b64_tr_b16 v[22:23], v8 offset:54752
    s_waitcnt lgkmcnt(6)
    v_mfma_f32_32x32x16_bf16 v[48:63], v[28:31], v[248:251], v[48:63]
    ds_read_b64_tr_b16 v[24:25], v8 offset:55520
    ds_read_b64_tr_b16 v[26:27], v8 offset:55776
    s_waitcnt lgkmcnt(6)
    v_mfma_f32_32x32x16_bf16 v[48:63], v[12:15], v[252:255], v[48:63]
    ds_read_b64_tr_b16 v[28:29], v8 offset:56544
    ds_read_b64_tr_b16 v[30:31], v8 offset:56800
    s_waitcnt lgkmcnt(6)
    v_mfma_f32_32x32x16_bf16 v[64:79], v[224:227], v[16:19], v[64:79]
    ds_read_b64_tr_b16 v[12:13], v7 offset:4128
    ds_read_b64_tr_b16 v[14:15], v7 offset:4384
    s_waitcnt lgkmcnt(6)
    v_mfma_f32_32x32x16_bf16 v[64:79], v[228:231], v[20:23], v[64:79]
    ds_read_b64_tr_b16 v[16:17], v7 offset:5152
    ds_read_b64_tr_b16 v[18:19], v7 offset:5408
    s_waitcnt lgkmcnt(6)
    v_mfma_f32_32x32x16_bf16 v[64:79], v[232:235], v[24:27], v[64:79]
    ds_read_b64_tr_b16 v[20:21], v7 offset:6176
    ds_read_b64_tr_b16 v[22:23], v7 offset:6432
    s_waitcnt lgkmcnt(6)
    v_mfma_f32_32x32x16_bf16 v[64:79], v[236:239], v[28:31], v[64:79]
    ds_read_b64_tr_b16 v[24:25], v7 offset:7200
    ds_read_b64_tr_b16 v[26:27], v7 offset:7456
    s_waitcnt lgkmcnt(6)
    v_mfma_f32_32x32x16_bf16 v[64:79], v[240:243], v[12:15], v[64:79]
    s_waitcnt lgkmcnt(4)
    v_mfma_f32_32x32x16_bf16 v[64:79], v[244:247], v[16:19], v[64:79]
    s_waitcnt lgkmcnt(2)
    v_mfma_f32_32x32x16_bf16 v[64:79], v[248:251], v[20:23], v[64:79]
    s_waitcnt lgkmcnt(0)
    v_mfma_f32_32x32x16_bf16 v[64:79], v[252:255], v[24:27], v[64:79]
    s_nop 15
    v_cvt_pk_bf16_f32 v32, v80, v81
    v_cvt_pk_bf16_f32 v33, v82, v83
    v_cvt_pk_bf16_f32 v34, v84, v85
    v_cvt_pk_bf16_f32 v35, v86, v87
    v_cvt_pk_bf16_f32 v36, v88, v89
    v_cvt_pk_bf16_f32 v37, v90, v91
    v_cvt_pk_bf16_f32 v38, v92, v93
    v_cvt_pk_bf16_f32 v39, v94, v95
    buffer_store_dwordx4 v[32:35], v0, s[24:27], s40 offen offset:0 sc1
    buffer_store_dwordx4 v[36:39], v0, s[24:27], s43 offen offset:0 sc1
    v_cvt_pk_bf16_f32 v40, v96, v97
    v_cvt_pk_bf16_f32 v41, v98, v99
    v_cvt_pk_bf16_f32 v42, v100, v101
    v_cvt_pk_bf16_f32 v43, v102, v103
    v_cvt_pk_bf16_f32 v44, v104, v105
    v_cvt_pk_bf16_f32 v45, v106, v107
    v_cvt_pk_bf16_f32 v46, v108, v109
    v_cvt_pk_bf16_f32 v47, v110, v111
    buffer_store_dwordx4 v[40:43], v0, s[24:27], s40 offen offset:1024 sc1
    buffer_store_dwordx4 v[44:47], v0, s[24:27], s43 offen offset:1024 sc1
    v_mul_f32 v48, s46, v48
    v_mul_f32 v49, s46, v49
    v_mul_f32 v50, s46, v50
    v_mul_f32 v51, s46, v51
    v_mul_f32 v52, s46, v52
    v_mul_f32 v53, s46, v53
    v_mul_f32 v54, s46, v54
    v_mul_f32 v55, s46, v55
    v_mul_f32 v56, s46, v56
    v_mul_f32 v57, s46, v57
    v_cvt_pk_bf16_f32 v32, v48, v49
    v_cvt_pk_bf16_f32 v33, v50, v51
    v_cvt_pk_bf16_f32 v34, v52, v53
    v_cvt_pk_bf16_f32 v35, v54, v55
    v_cvt_pk_bf16_f32 v36, v56, v57
    buffer_store_dwordx4 v[32:35], v0, s[24:27], s45 offen sc1
    v_mov_b32 v60, v36
    v_mov_b32 v61, 0x3f803f80
    v_cmp_gt_u32 vcc, 512, v0
    v_mov_b32 v58, 1073741824
    v_lshrrev_b32 v59, 1, v0
    v_cndmask_b32 v58, v58, v59, vcc
    buffer_store_dwordx2 v[60:61], v58, s[24:27], s49 offen sc1
    v_mul_f32 v37, v48, v48
    v_fmac_f32 v37, v49, v49
    v_fmac_f32 v37, v50, v50
    v_fmac_f32 v37, v51, v51
    v_fmac_f32 v37, v52, v52
    v_fmac_f32 v37, v53, v53
    v_fmac_f32 v37, v54, v54
    v_fmac_f32 v37, v55, v55
    v_mul_f32 v38, v56, v56
    v_fmac_f32 v38, v57, v57
    v_cndmask_b32 v38, 0, v38, vcc
    v_add_f32 v37, v37, v38
    v_mov_b32 v38, v37
    s_nop 1
    v_permlane32_swap_b32 v37, v38
    v_add_f32 v37, v37, v38
    s_nop 1
    v_max_f32 v37, v37, v37 row_shr:1 row_mask:0xf bank_mask:0xf bound_ctrl:0
    s_nop 1
    v_max_f32 v37, v37, v37 row_shr:2 row_mask:0xf bank_mask:0xf bound_ctrl:0
    s_nop 1
    v_max_f32 v37, v37, v37 row_shr:4 row_mask:0xf bank_mask:0xf bound_ctrl:0
    s_nop 1
    v_max_f32 v37, v37, v37 row_shr:8 row_mask:0xf bank_mask:0xf bound_ctrl:0
    s_nop 1
    v_max_f32 v37, v37, v37 row_bcast:15 row_mask:0xa bank_mask:0xf
    s_nop 0
    v_readlane_b32 s47, v37, 31
    v_lshrrev_b32 v59, 2, v0
    v_mov_b32 v62, 1073741824
    v_mov_b32 v37, s47
    v_cndmask_b32 v59, v62, v59, vcc
    buffer_store_dword v37, v59, s[24:27], s48 offen sc1
    v_cvt_pk_bf16_f32 v40, v64, v65
    v_cvt_pk_bf16_f32 v41, v66, v67
    v_cvt_pk_bf16_f32 v42, v68, v69
    v_cvt_pk_bf16_f32 v43, v70, v71
    v_cvt_pk_bf16_f32 v44, v72, v73
    v_cvt_pk_bf16_f32 v45, v74, v75
    v_cvt_pk_bf16_f32 v46, v76, v77
    v_cvt_pk_bf16_f32 v47, v78, v79
    v_and_b32 v64, 0x1f0, v0
    v_cmp_eq_u32 vcc, 288, v64
    v_mov_b32 v65, 0x3f803f80
    s_nop 0
    v_cndmask_b32 v65, 0, v65, vcc
    v_cmp_gt_u32 vcc, 288, v64
    s_nop 1
    v_cndmask_b32 v40, v65, v40, vcc
    v_cndmask_b32 v41, v65, v41, vcc
    v_cndmask_b32 v42, v65, v42, vcc
    v_cndmask_b32 v43, v65, v43, vcc
    v_cndmask_b32 v44, v65, v44, vcc
    v_cndmask_b32 v45, v65, v45, vcc
    v_cndmask_b32 v46, v65, v46, vcc
    v_cndmask_b32 v47, v65, v47, vcc
    v_lshrrev_b32 v66, 9, v0
    v_mul_u32_u24 v66, 320, v66
    v_add_u32 v66, v66, v64
    v_cmp_gt_u32 vcc, 320, v64
    v_mov_b32 v67, 1073741824
    s_nop 0
    v_cndmask_b32 v66, v67, v66, vcc
    buffer_store_dwordx4 v[40:43], v66, s[24:27], s42 offen sc1
    buffer_store_dwordx4 v[44:47], v66, s[24:27], s42 offen offset:640 sc1
    s_waitcnt vmcnt(0)
    s_barrier
    s_cmp_lg_u32 s3, 0
    s_cbranch_scc1 L_lp_kvq
    v_mov_b32 v32, s98
    v_mov_b32 v33, s99
    v_mov_b32 v34, s98
    v_mov_b32 v35, s99
    s_lshl_b32 s55, s100, 7
    s_add_u32 s55, s55, 49315840
    s_mov_b64 exec, 0xff
    buffer_store_dwordx4 v[32:35], v0, s[24:27], s55 offen sc1
    s_mov_b64 exec, -1
L_lp_kvq:
    s_load_dwordx2 s[60:61], s[0:1], 32
    v_lshrrev_b32 v16, 4, v0
    s_waitcnt lgkmcnt(0)
    s_barrier
    s_mov_b32 s8, s60
    s_mov_b32 s9, s61
    s_mov_b32 s10, 663552
    s_mov_b32 s11, 0x00020000
    s_mul_i32 s33, s4, 82944
    s_lshl_b32 s34, s3, 10
    s_add_u32 s33, s33, s34
    s_mov_b32 m0, s34
    s_add_u32 s34, s34, 8192
    buffer_load_dwordx4 v0, s[8:11], s33 offen lds
    s_add_u32 s33, s33, 8192
    s_mov_b32 m0, s34
    s_add_u32 s34, s34, 8192
    buffer_load_dwordx4 v0, s[8:11], s33 offen lds
    s_add_u32 s33, s33, 8192
    s_mov_b32 m0, s34
    s_add_u32 s34, s34, 8192
    buffer_load_dwordx4 v0, s[8:11], s33 offen lds
    s_add_u32 s33, s33, 8192
    s_mov_b32 m0, s34
    s_add_u32 s34, s34, 8192
    buffer_load_dwordx4 v0, s[8:11], s33 offen lds
    s_add_u32 s33, s33, 8192
    s_mov_b32 m0, s34
    s_add_u32 s34, s34, 8192
    buffer_load_dwordx4 v0, s[8:11], s33 offen lds
    s_add_u32 s33, s33, 8192
    s_mov_b32 m0, s34
    s_add_u32 s34, s34, 8192
    buffer_load_dwordx4 v0, s[8:11], s33 offen lds
    s_add_u32 s33, s33, 8192
    s_mov_b32 m0, s34
    s_add_u32 s34, s34, 8192
    buffer_load_dwordx4 v0, s[8:11], s33 offen lds
    s_add_u32 s33, s33, 8192
    s_mov_b32 m0, s34
    s_add_u32 s34, s34, 8192
    buffer_load_dwordx4 v0, s[8:11], s33 offen lds
    s_add_u32 s33, s33, 8192
    s_mov_b32 m0, s34
    s_add_u32 s34, s34, 8192
    buffer_load_dwordx4 v0, s[8:11], s33 offen lds
    s_add_u32 s33, s33, 8192
    s_mov_b32 m0, s34
    s_add_u32 s34, s34, 8192
    buffer_load_dwordx4 v0, s[8:11], s33 offen lds
    s_add_u32 s33, s33, 8192
    s_mov_b32 m0, s34
    s_add_u32 s34, s34, 8192
    buffer_load_dwordx4 v0, s[8:11], s33 offen lds
    s_add_u32 s33, s33, 8192
    v_lshrrev_b32 v6, 5, v16
    v_bfe_u32 v7, v16, 2, 2
    v_lshl_add_u32 v8, v6, 2, v7
    v_mul_u32_u24 v8, 1152, v8
    v_bfe_u32 v9, v16, 4, 1
    v_lshlrev_b32 v9, 5, v9
    v_and_b32 v13, 3, v16
    v_lshl_add_u32 v9, v13, 3, v9
    s_lshl_b32 s34, s3, 6
    v_add3_u32 v8, v8, v9, s34
    v_lshrrev_b32 v13, 1, v7
    v_mul_u32_u24 v13, 18, v13
    v_and_b32 v7, 1, v7
    v_add_u32 v13, v13, v7
    v_mul_u32_u24 v13, 1152, v13
    v_add3_u32 v13, v13, v9, s34
    s_lshr_b32 s35, s4, 1
    s_mul_i32 s35, s35, 9216
    s_mul_i32 s36, s3, 36864
    s_add_u32 s35, s35, s36
    s_add_u32 s35, s35, 29360128
    s_and_b32 s36, s4, 1
    s_lshl_b32 s37, s36, 9
    s_add_u32 s37, s37, s35
    s_add_u32 s37, s37, 8192
    s_lshl_b32 s36, s36, 12
    s_add_u32 s36, s36, s35
    v_cmp_gt_u32 vcc, 32, v16
    v_mov_b32 v14, 1073741824
    s_nop 0
    v_cndmask_b32 v14, v14, v0, vcc
    s_mov_b32 s38, s3
    s_waitcnt vmcnt(0)
    s_barrier
L_wofl:
    v_add_u32 v12, 0x8000, v8
    ds_read_b64_tr_b16 v[20:21], v8 offset:0
    ds_read_b64_tr_b16 v[22:23], v8 offset:9216
    ds_read_b64_tr_b16 v[24:25], v8 offset:20736
    ds_read_b64_tr_b16 v[26:27], v8 offset:29952
    ds_read_b64_tr_b16 v[28:29], v12 offset:8704
    ds_read_b64_tr_b16 v[30:31], v12 offset:17920
    ds_read_b64_tr_b16 v[32:33], v12 offset:29440
    ds_read_b64_tr_b16 v[34:35], v12 offset:38656
    ds_read_b64_tr_b16 v[36:37], v13 offset:18432
    ds_read_b64_tr_b16 v[38:39], v13 offset:59904
    s_waitcnt lgkmcnt(0)
    buffer_store_dwordx4 v[20:23], v0, s[24:27], s36 offen offset:0 sc1
    buffer_store_dwordx4 v[24:27], v0, s[24:27], s36 offen offset:1024 sc1
    buffer_store_dwordx4 v[28:31], v0, s[24:27], s36 offen offset:2048 sc1
    buffer_store_dwordx4 v[32:35], v0, s[24:27], s36 offen offset:3072 sc1
    buffer_store_dwordx4 v[36:39], v14, s[24:27], s37 offen sc1
    v_add_u32 v8, 512, v8
    v_add_u32 v13, 512, v13
    s_add_u32 s36, s36, 294912
    s_add_u32 s37, s37, 294912
    s_add_u32 s38, s38, 8
    s_waitcnt vmcnt(0)
    s_cmp_lt_u32 s38, 18
    s_cbranch_scc1 L_wofl
L_late:
    s_and_b32 s4, s2, 7
    s_lshr_b32 s61, s2, 3
    s_mul_i32 s60, s61, 43
    s_lshr_b32 s60, s60, 7
    s_mul_i32 s59, s60, 3
    s_sub_u32 s59, s61, s59
    s_mul_i32 s5, s4, 10
    s_add_u32 s5, s5, s60
    s_lshr_b32 s57, s5, 4
    s_and_b32 s58, s5, 15
    s_and_b32 s62, s3, 3
    s_lshr_b32 s63, s3, 2
    s_cmp_eq_u32 s57, 4
    s_cselect_b32 s56, 28, 29
    s_cmp_ge_u32 s61, 30
    s_cselect_b32 s56, 0, s56
    s_and_b32 s20, s2, 0xe0
    s_add_u32 s20, s20, 29
    s_lshr_b32 s23, s58, 1
    s_lshl_b32 s23, s23, 5
    s_sub_u32 s23, s23, 32
    s_mov_b32 s96, 0
    s_cmp_eq_u32 s56, 0
    s_cselect_b32 s97, 0, 0x1fffffff
    s_lshr_b32 s4, s2, 2
    s_and_b32 s5, s2, 3
    s_lshl_b32 s52, s5, 3
    s_lshl_b32 s74, s62, 1
    s_add_u32 s52, s52, s74
    s_mul_i32 s4, s4, 36864
    s_add_u32 s51, s4, 26214400
    s_mul_i32 s5, s5, 9216
    s_add_u32 s50, s4, s5
    s_lshl_b32 s4, s3, 10
    s_add_u32 s50, s50, s4
    s_add_u32 s50, s50, 22020096
    s_mul_i32 s22, s62, 36
    s_lshl_b32 s4, s62, 8
    s_add_u32 s4, s4, 4096
    s_lshl_b32 s72, s62, 10
    s_cmp_eq_u32 s63, 0
    s_cselect_b32 s4, s4, s72
    s_add_u32 s73, s4, 131584
    s_add_u32 s101, s4, 25165824
    s_mul_i32 s66, s57, 12
    s_mul_i32 s68, s57, 17
    s_cmp_eq_u32 s57, 4
    s_cselect_b32 s66, 47, s66
    s_cselect_b32 s68, 69, s68
    s_add_u32 s68, s68, 58
    s_cmp_ge_u32 s57, 3
    s_cselect_b32 s67, 11, 12
    s_sub_u32 s69, s56, s67
    s_lshr_b32 s70, s60, 1
    s_add_u32 s70, s70, s60
    s_sub_u32 s70, s70, s67
    s_mul_i32 s64, s59, 384
    s_mul_i32 s65, s62, 9216
    s_add_u32 s64, s64, s65
    s_lshl_b32 s4, s58, 2
    s_add_u32 s4, s4, s62
    s_mul_i32 s65, s4, 294912
    s_add_u32 s65, s65, 3145728
    s_lshl_b32 s89, s62, 11
    s_add_u32 s89, s89, 49152
    s_cmp_eq_u32 s56, 0
    s_cselect_b32 s64, 1073741824, s64
    s_cselect_b32 s65, 1073741824, s65
    s_mul_i32 s75, s57, 2359296
    s_mul_i32 s4, s4, 18
    s_mul_i32 s5, s59, 6
    s_add_u32 s4, s4, s5
    s_mul_i32 s5, s63, 3
    s_add_u32 s4, s4, s5
    s_lshl_b32 s4, s4, 11
    s_add_u32 s75, s75, s4
    s_add_u32 s75, s75, 30408704
    s_lshl_b32 s58, s63, 10
    s_add_u32 s58, s58, 131584
    s_mul_i32 s59, s63, 1280
    s_add_u32 s59, s59, 133632
    s_lshl_b32 s71, s63, 12
    s_lshl_b32 s74, s63, 13
    s_cmp_eq_u32 s3, 0
    s_cselect_b32 s53, 6, -1
    s_cselect_b32 s54, 9, -1
    s_movk_i32 s4, 0x7f8
    s_mov_b32 s5, 0
    v_lshrrev_b32 v95, 4, v0
    v_min_u32 v110, 2, v95
    v_add_u32 v110, s20, v110
    v_lshl_add_u32 v109, v95, 5, -1
    v_subrev_u32 v109, 64, v109
    v_add_u32 v108, s23, v95
    v_cndmask_b32 v110, v110, v109, s[4:5]
    v_cndmask_b32 v110, v110, v108, s[96:97]
    v_lshlrev_b32 v110, 7, v110
    v_add_u32 v86, 49348608, v110
    v_add_u32 v94, 49315840, v110
    v_lshlrev_b32 v91, 7, v95
    v_add_u32 v91, 25427968, v91
    v_add_u32 v88, s61, v95
    v_and_b32 v88, 31, v88
    v_mul_u32_u24 v88, 5120, v88
    v_add_u32 v88, s101, v88
    v_lshlrev_b32 v90, 2, v95
    v_and_b32 v81, 0x1f0, v0
    v_lshrrev_b32 v111, 5, v95
    v_lshl_add_u32 v111, v111, 2, s22
    v_add_u32 v110, 152064, v81
    v_add_u32 v108, 0, v111
    v_lshrrev_b32 v96, 3, v108
    v_lshl_add_u32 v96, v96, 9, v110
    v_and_b32 v109, 6, v108
    v_lshl_add_u32 v96, v109, 1, v96
    v_add_u32 v108, 2, v111
    v_lshrrev_b32 v97, 3, v108
    v_lshl_add_u32 v97, v97, 9, v110
    v_and_b32 v109, 6, v108
    v_lshl_add_u32 v97, v109, 1, v97
    v_add_u32 v98, 512, v96
    v_add_u32 v99, 512, v97
    v_add_u32 v100, 512, v98
    v_mov_b32 v101, 0
    v_add_u32 v108, 18, v111
    v_lshrrev_b32 v102, 3, v108
    v_lshl_add_u32 v102, v102, 9, v110
    v_and_b32 v109, 6, v108
    v_lshl_add_u32 v102, v109, 1, v102
    v_add_u32 v108, 20, v111
    v_lshrrev_b32 v103, 3, v108
    v_lshl_add_u32 v103, v103, 9, v110
    v_and_b32 v109, 6, v108
    v_lshl_add_u32 v103, v109, 1, v103
    v_add_u32 v104, 512, v102
    v_add_u32 v105, 512, v103
    v_add_u32 v106, 512, v104
    v_mov_b32 v107, 0
    v_subrev_u32 v108, 2, v95
    v_add_u32 v109, s60, v108
    v_subrev_u32 v110, s67, v109
    v_min_u32 v109, v109, v110
    v_add_u32 v109, s66, v109
    v_add_u32 v110, s70, v108
    v_subrev_u32 v111, s69, v110
    v_min_u32 v110, v110, v111
    v_add_u32 v110, s68, v110
    v_cmp_gt_u32 s[4:5], s67, v108
    v_cmp_gt_u32 s[96:97], s56, v108
    v_mov_b32 v111, s66
    v_cndmask_b32 v109, v110, v109, s[4:5]
    v_cndmask_b32 v87, v111, v109, s[96:97]
    v_add_u32 v83, s89, v0
    v_lshrrev_b32 v89, 3, v95
    v_mul_u32_u24 v89, 1152, v89
    v_bfe_u32 v108, v95, 4, 1
    v_lshlrev_b32 v110, 2, v108
    v_and_b32 v109, 7, v95
    v_xor_b32 v110, v110, v109
    v_lshl_add_u32 v89, v110, 4, v89
    v_add_u32 v80, s58, v0
    v_and_b32 v110, 31, v95
    v_min_u32 v110, 19, v110
    v_lshrrev_b32 v109, 5, v95
    v_mad_u32_u24 v110, v109, 20, v110
    v_lshl_add_u32 v82, v110, 4, s59
    v_bfe_u32 v110, v95, 2, 2
    v_lshl_add_u32 v110, v109, 2, v110
    v_lshlrev_b32 v110, 7, v110
    v_lshl_add_u32 v110, v108, 5, v110
    v_and_b32 v109, 3, v95
    v_lshl_add_u32 v108, v109, 3, v110
    v_bfe_u32 v109, v95, 3, 1
    v_xor_b32 v109, s63, v109
    v_lshlrev_b32 v109, 6, v109
    v_xor_b32 v110, 64, v109
    v_add3_u32 v84, v108, v109, s71
    v_add3_u32 v85, v108, v110, s74
    v_lshrrev_b32 v81, 1, v81
    s_cmp_lg_u32 s3, 0
    s_cbranch_scc1 L_late_w
    s_mov_b32 s55, 0
L_poll_26:
    buffer_load_dwordx2 v[92:93], v94, s[24:27], 0 offen sc1
    s_add_u32 s55, s55, 1
    s_waitcnt vmcnt(0)
    v_cmp_ne_u64 vcc, s[98:99], v[92:93]
    s_cbranch_vccz L_poll_26_d
    s_cmp_lt_u32 s55, 0x100000
    s_cbranch_scc1 L_poll_26
L_poll_26_d:
L_late_w:
    s_barrier
    s_lshl_b32 s21, s3, 10
    s_add_u32 m0, s21, 152064
    s_cmp_gt_u32 s3, 1
    buffer_load_dwordx4 v0, s[24:27], s50 offen sc1 lds
    s_cbranch_scc1 L_q_28
    s_cmp_eq_u32 s3, 1
    s_cbranch_scc1 L_q_27
    s_mov_b32 m0, 160256
    s_add_u32 s21, s50, 8192
    buffer_load_dwordx4 v0, s[24:27], s21 offen sc1 lds
    s_branch L_q_28
L_q_27:
    s_mov_b32 m0, 161280
    s_nop 0
    buffer_load_dword v91, s[24:27], 0 offen sc1 lds
L_q_28:
    v_readlane_b32 s21, v88, 0
    s_add_u32 m0, s73, 0
    s_cmp_eq_u32 s63, 0
    s_nop 2
    s_cbranch_scc1 L_kv_29
    buffer_load_dwordx4 v0, s[24:27], s21 offen sc1 lds
    s_branch L_kv_30
L_kv_29:
    buffer_load_dword v90, s[24:27], s21 offen sc1 lds
L_kv_30:
    v_readlane_b32 s21, v88, 1
    s_add_u32 m0, s73, 5120
    s_cmp_eq_u32 s63, 0
    s_nop 2
    s_cbranch_scc1 L_kv_31
    buffer_load_dwordx4 v0, s[24:27], s21 offen sc1 lds
    s_branch L_kv_32
L_kv_31:
    buffer_load_dword v90, s[24:27], s21 offen sc1 lds
L_kv_32:
    v_readlane_b32 s21, v88, 2
    s_add_u32 m0, s73, 10240
    s_cmp_eq_u32 s63, 0
    s_nop 2
    s_cbranch_scc1 L_kv_33
    buffer_load_dwordx4 v0, s[24:27], s21 offen sc1 lds
    s_branch L_kv_34
L_kv_33:
    buffer_load_dword v90, s[24:27], s21 offen sc1 lds
L_kv_34:
    v_readlane_b32 s21, v88, 3
    s_add_u32 m0, s73, 15360
    s_cmp_eq_u32 s63, 0
    s_nop 2
    s_cbranch_scc1 L_kv_35
    buffer_load_dwordx4 v0, s[24:27], s21 offen sc1 lds
    s_branch L_kv_36
L_kv_35:
    buffer_load_dword v90, s[24:27], s21 offen sc1 lds
L_kv_36:
    s_waitcnt vmcnt(0)
    s_barrier
    s_cmp_lg_u32 s63, 0
    s_cbranch_scc1 L_eg_37
    v_readlane_b32 s22, v87, 2
    s_nop 3
    s_lshl_b32 s70, s22, 11
    s_add_u32 m0, s89, 16384
    s_add_u32 s70, s70, s65
    buffer_load_dwordx4 v0, s[24:27], s70 offen sc1 lds
L_eg_37:
    s_cmp_lg_u32 s63, 0
    s_cbranch_scc1 L_eg_38
    buffer_load_dwordx4 v0, s[24:27], s70 offen offset:1024 sc1 lds
L_eg_38:
    s_cmp_lg_u32 s63, 0
    s_cbranch_scc1 L_eg_39
    s_mul_i32 s71, s22, 36864
    s_add_u32 m0, s72, 24576
    s_add_u32 s71, s71, s64
    buffer_load_dwordx4 v89, s[28:31], s71 offen lds
L_eg_39:
    s_cmp_lg_u32 s63, 0
    s_cbranch_scc1 L_eg_40
    s_add_u32 m0, s72, 28544
    s_nop 0
    buffer_load_dwordx4 v89, s[28:31], s71 offen offset:128 lds
L_eg_40:
    s_cmp_lg_u32 s63, 0
    s_cbranch_scc1 L_eg_41
    s_add_u32 m0, s72, 32512
    s_nop 0
    buffer_load_dwordx4 v89, s[28:31], s71 offen offset:256 lds
L_eg_41:
    s_cmp_lg_u32 s63, 0
    s_cbranch_scc1 L_eg_42
    v_readlane_b32 s22, v87, 3
    s_nop 3
    s_lshl_b32 s70, s22, 11
    s_add_u32 m0, s89, 24576
    s_add_u32 s70, s70, s65
    buffer_load_dwordx4 v0, s[24:27], s70 offen sc1 lds
L_eg_42:
    s_cmp_lg_u32 s63, 0
    s_cbranch_scc1 L_eg_43
    buffer_load_dwordx4 v0, s[24:27], s70 offen offset:1024 sc1 lds
L_eg_43:
    s_cmp_lg_u32 s63, 0
    s_cbranch_scc1 L_eg_44
    s_mul_i32 s71, s22, 36864
    s_add_u32 m0, s72, 36864
    s_add_u32 s71, s71, s64
    buffer_load_dwordx4 v89, s[28:31], s71 offen lds
L_eg_44:
    s_cmp_lg_u32 s63, 0
    s_cbranch_scc1 L_eg_45
    s_add_u32 m0, s72, 40832
    s_nop 0
    buffer_load_dwordx4 v89, s[28:31], s71 offen offset:128 lds
L_eg_45:
    s_cmp_lg_u32 s63, 0
    s_cbranch_scc1 L_eg_46
    s_add_u32 m0, s72, 44800
    s_nop 0
    buffer_load_dwordx4 v89, s[28:31], s71 offen offset:256 lds
L_eg_46:
    v_add_u32 v91, 161280, v90
    ds_read_b32 v91, v91
    ds_read_b32 v96, v96
    ds_read_b32 v97, v97
    ds_read_b32 v98, v98
    ds_read_b32 v99, v99
    ds_read_b32 v100, v100
    ds_read_b32 v102, v102
    ds_read_b32 v103, v103
    ds_read_b32 v104, v104
    ds_read_b32 v105, v105
    ds_read_b32 v106, v106
    v_cmp_gt_u32 s[4:5], 32, v95
    s_nop 0
    s_nop 0
    s_nop 0
    s_nop 0
    s_nop 0
    s_nop 0
    s_waitcnt lgkmcnt(0)
    v_cndmask_b32 v100, 0, v100, s[4:5]
    v_cndmask_b32 v106, 0, v106, s[4:5]
    s_nop 1
    v_max_f32 v91, v91, v91 row_shr:1 row_mask:0xf bank_mask:0xf bound_ctrl:0
    s_nop 1
    v_max_f32 v91, v91, v91 row_shr:2 row_mask:0xf bank_mask:0xf bound_ctrl:0
    s_nop 1
    v_max_f32 v91, v91, v91 row_shr:4 row_mask:0xf bank_mask:0xf bound_ctrl:0
    s_nop 1
    v_max_f32 v91, v91, v91 row_shr:8 row_mask:0xf bank_mask:0xf bound_ctrl:0
    s_nop 1
    v_max_f32 v91, v91, v91 row_bcast:15 row_mask:0xa bank_mask:0xf
    s_nop 1
    v_max_f32 v91, v91, v91 row_bcast:31 row_mask:0xc bank_mask:0xf
    s_nop 0
    v_readlane_b32 s66, v91, 63
    v_lshlrev_b32 v108, 16, v96
    v_and_b32 v109, 0xffff0000, v96
    v_mul_f32 v110, v108, v108
    v_fmac_f32 v110, v109, v109
    v_lshlrev_b32 v108, 16, v97
    v_and_b32 v109, 0xffff0000, v97
    v_fmac_f32 v110, v108, v108
    v_fmac_f32 v110, v109, v109
    v_lshlrev_b32 v108, 16, v98
    v_and_b32 v109, 0xffff0000, v98
    v_fmac_f32 v110, v108, v108
    v_fmac_f32 v110, v109, v109
    v_lshlrev_b32 v108, 16, v99
    v_and_b32 v109, 0xffff0000, v99
    v_fmac_f32 v110, v108, v108
    v_fmac_f32 v110, v109, v109
    v_lshlrev_b32 v108, 16, v100
    v_and_b32 v109, 0xffff0000, v100
    v_fmac_f32 v110, v108, v108
    v_fmac_f32 v110, v109, v109
    v_mov_b32 v108, v110
    s_nop 1
    v_permlane32_swap_b32 v110, v108
    v_add_f32 v110, v110, v108
    v_lshlrev_b32 v108, 16, v102
    v_and_b32 v109, 0xffff0000, v102
    v_mul_f32 v111, v108, v108
    v_fmac_f32 v111, v109, v109
    v_lshlrev_b32 v108, 16, v103
    v_and_b32 v109, 0xffff0000, v103
    v_fmac_f32 v111, v108, v108
    v_fmac_f32 v111, v109, v109
    v_lshlrev_b32 v108, 16, v104
    v_and_b32 v109, 0xffff0000, v104
    v_fmac_f32 v111, v108, v108
    v_fmac_f32 v111, v109, v109
    v_lshlrev_b32 v108, 16, v105
    v_and_b32 v109, 0xffff0000, v105
    v_fmac_f32 v111, v108, v108
    v_fmac_f32 v111, v109, v109
    v_lshlrev_b32 v108, 16, v106
    v_and_b32 v109, 0xffff0000, v106
    v_fmac_f32 v111, v108, v108
    v_fmac_f32 v111, v109, v109
    v_mov_b32 v108, v111
    s_nop 1
    v_permlane32_swap_b32 v111, v108
    v_add_f32 v111, v111, v108
    v_max_f32 v110, v110, v111
    v_mul_f32 v110, s66, v110
    v_mov_b32 v108, 0x45610000
    v_cmp_nle_f32 s[4:5], v110, v108
L_p1_done:
    s_cmp_eq_u64 s[4:5], 0
    s_cbranch_scc0 L_p2_slow0
L_p2_fast:
    s_lshl_b32 s66, s63, 8
    s_add_u32 s66, s66, 136192
    v_add_u32 v81, s66, v81
    s_mov_b32 s20, 0
    s_mov_b32 s74, 4
    s_and_b32 s4, s2, 7
    s_lshr_b32 s5, s2, 3
    s_lshr_b32 s6, s5, 3
    s_and_b32 s7, s5, 7
    s_lshl_b32 s4, s4, 2
    s_add_u32 s4, s4, s6
    s_and_b32 s10, s3, 3
    s_lshr_b32 s8, s7, 2
    s_bfe_u32 s9, s7, 0x10001
    s_and_b32 s48, s7, 1
    s_add_u32 s48, s48, 16
    s_mul_i32 s33, s10, 9216
    s_mul_i32 s34, s7, 73728
    s_add_u32 s34, s34, s33
    s_add_u32 s34, s34, 29360128
    s_mul_i32 s42, s48, 36864
    s_add_u32 s42, s42, s33
    s_add_u32 s42, s42, 29360128
    s_cmp_eq_u32 s3, 0
    s_cselect_b32 s49, 2, -1
    s_mul_i32 s57, s62, 768
    s_sub_u32 s57, s57, 4096
    ds_read_b128 v[112:115], v80 offset:0
    ds_read_b64 v[116:117], v81 offset:0
    ds_read_b128 v[124:127], v82 offset:0
    ds_read_b128 v[128:131], v82 offset:640
    s_waitcnt lgkmcnt(0)
    v_mfma_f32_32x32x16_bf16 v[160:175], v[112:115], v[96:99], 0
    v_mfma_f32_32x32x8_bf16 v[160:175], v[116:117], v[100:101], v[160:175]
    s_cmp_eq_u32 s63, 1
    s_cbranch_scc1 L_p2_h1
L_p2_h0:
    s_setprio 1
    s_nop 9
    v_exp_f32 v160, v160
    v_exp_f32 v161, v161
    v_exp_f32 v162, v162
    v_exp_f32 v163, v163
    v_exp_f32 v164, v164
    s_waitcnt vmcnt(63) lgkmcnt(0)
    s_barrier
    v_mfma_f32_32x32x16_bf16 v[176:191], v[112:115], v[102:105], 0
    ds_read_b128 v[118:121], v80 offset:5120
    ds_read_b64 v[122:123], v81 offset:5120
    ds_read_b128 v[132:135], v82 offset:5120
    ds_read_b128 v[136:139], v82 offset:5760
    v_readlane_b32 s21, v88, s74
    v_readlane_b32 s22, v87, s74
    s_add_u32 s74, s74, 1
    v_exp_f32 v165, v165
    v_cvt_pk_bf16_f32 v160, v160, v161
    v_exp_f32 v166, v166
    v_cvt_pk_bf16_f32 v161, v162, v163
    s_lshl_b32 s70, s22, 11
    s_add_u32 m0, s89, 0
    s_add_u32 s70, s70, s65
    buffer_load_dwordx4 v0, s[24:27], s70 offen sc1 lds
    v_exp_f32 v167, v167
    v_cvt_pk_bf16_f32 v162, v164, v165
    v_exp_f32 v168, v168
    v_mfma_f32_32x32x8_bf16 v[176:191], v[116:117], v[106:107], v[176:191]
    buffer_load_dwordx4 v0, s[24:27], s70 offen offset:1024 sc1 lds
    v_cvt_pk_bf16_f32 v163, v166, v167
    v_exp_f32 v169, v169
    v_exp_f32 v170, v170
    v_mfma_f32_32x32x16_bf16 v[192:207], v[124:127], v[160:163], 0
    s_mul_i32 s71, s22, 36864
    s_add_u32 m0, s72, 0
    s_add_u32 s71, s71, s64
    buffer_load_dwordx4 v89, s[28:31], s71 offen lds
    v_exp_f32 v171, v171
    v_exp_f32 v172, v172
    v_exp_f32 v173, v173
    s_add_u32 m0, s72, 3968
    s_nop 0
    buffer_load_dwordx4 v89, s[28:31], s71 offen offset:128 lds
    v_cvt_pk_bf16_f32 v168, v168, v169
    v_exp_f32 v174, v174
    v_cvt_pk_bf16_f32 v169, v170, v171
    v_exp_f32 v175, v175
    s_add_u32 m0, s72, 7936
    s_nop 0
    buffer_load_dwordx4 v89, s[28:31], s71 offen offset:256 lds
    v_cvt_pk_bf16_f32 v170, v172, v173
    v_cvt_pk_bf16_f32 v171, v174, v175
    v_exp_f32 v176, v176
    v_exp_f32 v177, v177
    v_mfma_f32_32x32x16_bf16 v[192:207], v[128:131], v[168:171], v[192:207]
    s_add_u32 m0, s73, 0
    s_add_u32 s71, s21, s57
    buffer_load_dword v90, s[24:27], s21 offen sc1 lds
    v_exp_f32 v178, v178
    v_exp_f32 v179, v179
    v_exp_f32 v180, v180
    s_waitcnt lgkmcnt(0)
    v_mfma_f32_32x32x16_bf16 v[160:175], v[118:121], v[96:99], 0
    s_add_u32 m0, m0, s57
    s_nop 0
    buffer_load_dwordx4 v0, s[24:27], s71 offen sc1 lds
    v_exp_f32 v181, v181
    v_cvt_pk_bf16_f32 v176, v176, v177
    v_exp_f32 v182, v182
    v_cvt_pk_bf16_f32 v177, v178, v179
    v_exp_f32 v183, v183
    v_cvt_pk_bf16_f32 v178, v180, v181
    v_exp_f32 v184, v184
    v_mfma_f32_32x32x8_bf16 v[160:175], v[122:123], v[100:101], v[160:175]
    v_cvt_pk_bf16_f32 v179, v182, v183
    v_exp_f32 v185, v185
    v_exp_f32 v186, v186
    v_mfma_f32_32x32x16_bf16 v[208:223], v[124:127], v[176:179], 0
    v_exp_f32 v187, v187
    v_exp_f32 v188, v188
    v_exp_f32 v189, v189
    v_cvt_pk_bf16_f32 v184, v184, v185
    v_exp_f32 v190, v190
    v_cvt_pk_bf16_f32 v185, v186, v187
    v_exp_f32 v191, v191
    v_cvt_pk_bf16_f32 v186, v188, v189
    v_cvt_pk_bf16_f32 v187, v190, v191
    v_exp_f32 v160, v160
    v_exp_f32 v161, v161
    v_mfma_f32_32x32x16_bf16 v[208:223], v[128:131], v[184:187], v[208:223]
    v_exp_f32 v162, v162
    v_exp_f32 v163, v163
    v_exp_f32 v164, v164
    s_waitcnt vmcnt(7) lgkmcnt(0)
    s_barrier
    v_mfma_f32_32x32x16_bf16 v[176:191], v[118:121], v[102:105], 0
    ds_read_b128 v[112:115], v80 offset:10240
    ds_read_b64 v[116:117], v81 offset:10240
    ds_read_b128 v[124:127], v82 offset:10240
    ds_read_b128 v[128:131], v82 offset:10880
    v_readlane_b32 s21, v88, s74
    v_readlane_b32 s22, v87, s74
    s_add_u32 s74, s74, 1
    s_cmp_lg_u32 s3, 0
    s_cbranch_scc1 L_p2_pub
    v_mov_b32 v108, s98
    v_mov_b32 v109, s99
    v_mov_b32 v110, s98
    v_mov_b32 v111, s99
    s_lshl_b32 s55, s100, 7
    s_add_u32 s55, s55, 49348608
    s_mov_b64 exec, 0xff
    buffer_store_dwordx4 v[108:111], v0, s[24:27], s55 offen sc1
    s_mov_b64 exec, -1
L_p2_pub:
    v_exp_f32 v165, v165
    v_cvt_pk_bf16_f32 v160, v160, v161
    v_exp_f32 v166, v166
    v_cvt_pk_bf16_f32 v161, v162, v163
    ds_read_b64_tr_b16 v[140:141], v84 offset:24576
    ds_read_b64_tr_b16 v[142:143], v84 offset:25600
    s_lshl_b32 s70, s22, 11
    s_add_u32 m0, s89, 8192
    s_add_u32 s70, s70, s65
    buffer_load_dwordx4 v0, s[24:27], s70 offen sc1 lds
    v_exp_f32 v167, v167
    v_cvt_pk_bf16_f32 v162, v164, v165
    v_exp_f32 v168, v168
    v_mfma_f32_32x32x8_bf16 v[176:191], v[122:123], v[106:107], v[176:191]
    ds_read_b128 v[152:155], v83 offset:16384
    buffer_load_dwordx4 v0, s[24:27], s70 offen offset:1024 sc1 lds
    v_cvt_pk_bf16_f32 v163, v166, v167
    v_exp_f32 v169, v169
    v_exp_f32 v170, v170
    v_mfma_f32_32x32x16_bf16 v[192:207], v[132:135], v[160:163], v[192:207]
    s_mul_i32 s71, s22, 36864
    s_add_u32 m0, s72, 12288
    s_add_u32 s71, s71, s64
    buffer_load_dwordx4 v89, s[28:31], s71 offen lds
    v_exp_f32 v171, v171
    v_exp_f32 v172, v172
    v_exp_f32 v173, v173
    ds_read_b64_tr_b16 v[144:145], v85 offset:24576
    ds_read_b64_tr_b16 v[146:147], v85 offset:25600
    s_add_u32 m0, s72, 16256
    s_nop 0
    buffer_load_dwordx4 v89, s[28:31], s71 offen offset:128 lds
    v_cvt_pk_bf16_f32 v168, v168, v169
    v_exp_f32 v174, v174
    v_cvt_pk_bf16_f32 v169, v170, v171
    v_exp_f32 v175, v175
    ds_read_b64_tr_b16 v[148:149], v84 offset:28672
    ds_read_b64_tr_b16 v[150:151], v84 offset:29696
    s_add_u32 m0, s72, 20224
    s_nop 0
    buffer_load_dwordx4 v89, s[28:31], s71 offen offset:256 lds
    v_cvt_pk_bf16_f32 v170, v172, v173
    v_cvt_pk_bf16_f32 v171, v174, v175
    v_exp_f32 v176, v176
    v_exp_f32 v177, v177
    v_mfma_f32_32x32x16_bf16 v[192:207], v[136:139], v[168:171], v[192:207]
    s_add_u32 m0, s73, 5120
    s_add_u32 s71, s21, s57
    buffer_load_dword v90, s[24:27], s21 offen sc1 lds
    v_exp_f32 v178, v178
    v_exp_f32 v179, v179
    v_exp_f32 v180, v180
    s_waitcnt lgkmcnt(4)
    v_mfma_f32_32x32x16_bf16 v[160:175], v[112:115], v[96:99], 0
    s_add_u32 m0, m0, s57
    s_nop 0
    buffer_load_dwordx4 v0, s[24:27], s71 offen sc1 lds
    v_exp_f32 v181, v181
    v_cvt_pk_bf16_f32 v176, v176, v177
    v_exp_f32 v182, v182
    v_cvt_pk_bf16_f32 v177, v178, v179
    v_mfma_f32_32x32x16_bf16 v[12:27], v[140:143], v[152:155], 0
    ds_read_b64_tr_b16 v[140:141], v84 offset:26624
    ds_read_b64_tr_b16 v[142:143], v84 offset:27648
    v_exp_f32 v183, v183
    v_cvt_pk_bf16_f32 v178, v180, v181
    v_exp_f32 v184, v184
    v_mfma_f32_32x32x8_bf16 v[160:175], v[116:117], v[100:101], v[160:175]
    ds_read_b128 v[156:159], v83 offset:17408
    v_cvt_pk_bf16_f32 v179, v182, v183
    v_exp_f32 v185, v185
    v_exp_f32 v186, v186
    v_mfma_f32_32x32x16_bf16 v[208:223], v[132:135], v[176:179], v[208:223]
    v_exp_f32 v187, v187
    v_exp_f32 v188, v188
    v_exp_f32 v189, v189
    s_waitcnt lgkmcnt(3)
    v_mfma_f32_32x32x16_bf16 v[28:43], v[144:147], v[152:155], 0
    ds_read_b64_tr_b16 v[144:145], v85 offset:26624
    ds_read_b64_tr_b16 v[146:147], v85 offset:27648
    v_cvt_pk_bf16_f32 v184, v184, v185
    v_exp_f32 v190, v190
    v_cvt_pk_bf16_f32 v185, v186, v187
    v_exp_f32 v191, v191
    v_mfma_f32_32x32x16_bf16 v[44:59], v[148:151], v[152:155], 0
    ds_read_b64_tr_b16 v[148:149], v84 offset:30720
    ds_read_b64_tr_b16 v[150:151], v84 offset:31744
    v_cvt_pk_bf16_f32 v186, v188, v189
    v_cvt_pk_bf16_f32 v187, v190, v191
    v_exp_f32 v160, v160
    v_exp_f32 v161, v161
    s_mov_b32 s20, 2
    s_add_u32 s23, s56, 1
    s_cmp_eq_u32 s56, 0
    s_cbranch_scc1 L_h0_n2
    s_branch L_h0_g2x
L_h0_g0:
    v_mfma_f32_32x32x16_bf16 v[208:223], v[136:139], v[184:187], v[208:223]
    v_exp_f32 v162, v162
    v_exp_f32 v163, v163
    v_exp_f32 v164, v164
    s_waitcnt vmcnt(14) lgkmcnt(0)
    s_barrier
    v_mfma_f32_32x32x16_bf16 v[176:191], v[112:115], v[102:105], 0
    ds_read_b128 v[118:121], v80 offset:5120
    ds_read_b64 v[122:123], v81 offset:5120
    ds_read_b128 v[132:135], v82 offset:5120
    ds_read_b128 v[136:139], v82 offset:5760
    v_readlane_b32 s21, v88, s74
    v_readlane_b32 s22, v87, s74
    s_add_u32 s74, s74, 1
    v_exp_f32 v165, v165
    v_cvt_pk_bf16_f32 v160, v160, v161
    v_exp_f32 v166, v166
    v_cvt_pk_bf16_f32 v161, v162, v163
    v_mfma_f32_32x32x16_bf16 v[12:27], v[140:143], v[156:159], v[12:27]
    ds_read_b64_tr_b16 v[140:141], v84 offset:12288
    ds_read_b64_tr_b16 v[142:143], v84 offset:13312
    s_lshl_b32 s70, s22, 11
    s_add_u32 m0, s89, 0
    s_add_u32 s70, s70, s65
    buffer_load_dwordx4 v0, s[24:27], s70 offen sc1 lds
    v_exp_f32 v167, v167
    v_cvt_pk_bf16_f32 v162, v164, v165
    v_exp_f32 v168, v168
    v_mfma_f32_32x32x8_bf16 v[176:191], v[116:117], v[106:107], v[176:191]
    ds_read_b128 v[152:155], v83 offset:8192
    buffer_load_dwordx4 v0, s[24:27], s70 offen offset:1024 sc1 lds
    v_cvt_pk_bf16_f32 v163, v166, v167
    v_exp_f32 v169, v169
    v_exp_f32 v170, v170
    v_mfma_f32_32x32x16_bf16 v[192:207], v[124:127], v[160:163], v[192:207]
    s_mul_i32 s71, s22, 36864
    s_add_u32 m0, s72, 0
    s_add_u32 s71, s71, s64
    buffer_load_dwordx4 v89, s[28:31], s71 offen lds
    v_exp_f32 v171, v171
    v_exp_f32 v172, v172
    v_exp_f32 v173, v173
    v_mfma_f32_32x32x16_bf16 v[28:43], v[144:147], v[156:159], v[28:43]
    ds_read_b64_tr_b16 v[144:145], v85 offset:12288
    ds_read_b64_tr_b16 v[146:147], v85 offset:13312
    s_add_u32 m0, s72, 3968
    s_nop 0
    buffer_load_dwordx4 v89, s[28:31], s71 offen offset:128 lds
    v_cvt_pk_bf16_f32 v168, v168, v169
    v_exp_f32 v174, v174
    v_cvt_pk_bf16_f32 v169, v170, v171
    v_exp_f32 v175, v175
    v_mfma_f32_32x32x16_bf16 v[44:59], v[148:151], v[156:159], v[44:59]
    ds_read_b64_tr_b16 v[148:149], v84 offset:16384
    ds_read_b64_tr_b16 v[150:151], v84 offset:17408
    s_add_u32 m0, s72, 7936
    s_nop 0
    buffer_load_dwordx4 v89, s[28:31], s71 offen offset:256 lds
    v_cvt_pk_bf16_f32 v170, v172, v173
    v_cvt_pk_bf16_f32 v171, v174, v175
    v_exp_f32 v176, v176
    v_exp_f32 v177, v177
    v_mfma_f32_32x32x16_bf16 v[192:207], v[128:131], v[168:171], v[192:207]
    s_add_u32 m0, s73, 0
    s_add_u32 s71, s21, s57
    buffer_load_dword v90, s[24:27], s21 offen sc1 lds
    v_exp_f32 v178, v178
    v_exp_f32 v179, v179
    v_exp_f32 v180, v180
    s_waitcnt lgkmcnt(4)
    v_mfma_f32_32x32x16_bf16 v[160:175], v[118:121], v[96:99], 0
    s_add_u32 m0, m0, s57
    s_nop 0
    buffer_load_dwordx4 v0, s[24:27], s71 offen sc1 lds
    v_exp_f32 v181, v181
    v_cvt_pk_bf16_f32 v176, v176, v177
    v_exp_f32 v182, v182
    v_cvt_pk_bf16_f32 v177, v178, v179
    v_mfma_f32_32x32x16_bf16 v[12:27], v[140:143], v[152:155], v[12:27]
    ds_read_b64_tr_b16 v[140:141], v84 offset:14336
    ds_read_b64_tr_b16 v[142:143], v84 offset:15360
    s_cmp_lg_u32 s20, 16
    s_cbranch_scc1 L_al_47_0
    s_add_u32 s43, s34, 0
    buffer_load_dwordx4 v[60:63], v0, s[24:27], s43 offen offset:0 sc1
L_al_47_0:
    v_exp_f32 v183, v183
    v_cvt_pk_bf16_f32 v178, v180, v181
    v_exp_f32 v184, v184
    v_mfma_f32_32x32x8_bf16 v[160:175], v[122:123], v[100:101], v[160:175]
    ds_read_b128 v[156:159], v83 offset:9216
    s_cmp_lg_u32 s20, 16
    s_cbranch_scc1 L_al_47_1
    s_add_u32 s43, s34, 0
    buffer_load_dwordx4 v[64:67], v0, s[24:27], s43 offen offset:1024 sc1
L_al_47_1:
    v_cvt_pk_bf16_f32 v179, v182, v183
    v_exp_f32 v185, v185
    v_exp_f32 v186, v186
    v_mfma_f32_32x32x16_bf16 v[208:223], v[124:127], v[176:179], v[208:223]
    s_cmp_lg_u32 s20, 16
    s_cbranch_scc1 L_al_47_2
    s_add_u32 s43, s34, 0
    buffer_load_dwordx4 v[68:71], v0, s[24:27], s43 offen offset:2048 sc1
L_al_47_2:
    v_exp_f32 v187, v187
    v_exp_f32 v188, v188
    v_exp_f32 v189, v189
    s_waitcnt lgkmcnt(3)
    v_mfma_f32_32x32x16_bf16 v[28:43], v[144:147], v[152:155], v[28:43]
    ds_read_b64_tr_b16 v[144:145], v85 offset:14336
    ds_read_b64_tr_b16 v[146:147], v85 offset:15360
    v_cvt_pk_bf16_f32 v184, v184, v185
    v_exp_f32 v190, v190
    v_cvt_pk_bf16_f32 v185, v186, v187
    v_exp_f32 v191, v191
    v_mfma_f32_32x32x16_bf16 v[44:59], v[148:151], v[152:155], v[44:59]
    ds_read_b64_tr_b16 v[148:149], v84 offset:18432
    ds_read_b64_tr_b16 v[150:151], v84 offset:19456
    v_cvt_pk_bf16_f32 v186, v188, v189
    v_cvt_pk_bf16_f32 v187, v190, v191
    v_exp_f32 v160, v160
    v_exp_f32 v161, v161
    s_add_u32 s20, s20, 1
    s_cmp_eq_u32 s20, s23
L_h0_g1:
    s_cbranch_scc1 L_h0_t1
    v_mfma_f32_32x32x16_bf16 v[208:223], v[128:131], v[184:187], v[208:223]
    v_exp_f32 v162, v162
    v_exp_f32 v163, v163
    v_exp_f32 v164, v164
    s_waitcnt vmcnt(14) lgkmcnt(0)
    s_cmp_lg_u32 s20, s54
    s_cbranch_scc1 L_p2_chk_r
    v_cmp_ne_u64 vcc, s[98:99], v[92:93]
    s_cbranch_vccnz L_p2_chk
L_p2_chk_r:
    s_barrier
    v_mfma_f32_32x32x16_bf16 v[176:191], v[118:121], v[102:105], 0
    ds_read_b128 v[112:115], v80 offset:10240
    ds_read_b64 v[116:117], v81 offset:10240
    ds_read_b128 v[124:127], v82 offset:10240
    ds_read_b128 v[128:131], v82 offset:10880
    v_readlane_b32 s21, v88, s74
    v_readlane_b32 s22, v87, s74
    s_add_u32 s74, s74, 1
    v_exp_f32 v165, v165
    v_cvt_pk_bf16_f32 v160, v160, v161
    v_exp_f32 v166, v166
    v_cvt_pk_bf16_f32 v161, v162, v163
    v_mfma_f32_32x32x16_bf16 v[12:27], v[140:143], v[156:159], v[12:27]
    ds_read_b64_tr_b16 v[140:141], v84 offset:24576
    ds_read_b64_tr_b16 v[142:143], v84 offset:25600
    s_lshl_b32 s70, s22, 11
    s_add_u32 m0, s89, 8192
    s_add_u32 s70, s70, s65
    buffer_load_dwordx4 v0, s[24:27], s70 offen sc1 lds
    v_exp_f32 v167, v167
    v_cvt_pk_bf16_f32 v162, v164, v165
    v_exp_f32 v168, v168
    v_mfma_f32_32x32x8_bf16 v[176:191], v[122:123], v[106:107], v[176:191]
    ds_read_b128 v[152:155], v83 offset:16384
    buffer_load_dwordx4 v0, s[24:27], s70 offen offset:1024 sc1 lds
    v_cvt_pk_bf16_f32 v163, v166, v167
    v_exp_f32 v169, v169
    v_exp_f32 v170, v170
    v_mfma_f32_32x32x16_bf16 v[192:207], v[132:135], v[160:163], v[192:207]
    s_mul_i32 s71, s22, 36864
    s_add_u32 m0, s72, 12288
    s_add_u32 s71, s71, s64
    buffer_load_dwordx4 v89, s[28:31], s71 offen lds
    v_exp_f32 v171, v171
    v_exp_f32 v172, v172
    v_exp_f32 v173, v173
    v_mfma_f32_32x32x16_bf16 v[28:43], v[144:147], v[156:159], v[28:43]
    ds_read_b64_tr_b16 v[144:145], v85 offset:24576
    ds_read_b64_tr_b16 v[146:147], v85 offset:25600
    s_add_u32 m0, s72, 16256
    s_nop 0
    buffer_load_dwordx4 v89, s[28:31], s71 offen offset:128 lds
    v_cvt_pk_bf16_f32 v168, v168, v169
    v_exp_f32 v174, v174
    v_cvt_pk_bf16_f32 v169, v170, v171
    v_exp_f32 v175, v175
    v_mfma_f32_32x32x16_bf16 v[44:59], v[148:151], v[156:159], v[44:59]
    ds_read_b64_tr_b16 v[148:149], v84 offset:28672
    ds_read_b64_tr_b16 v[150:151], v84 offset:29696
    s_add_u32 m0, s72, 20224
    s_nop 0
    buffer_load_dwordx4 v89, s[28:31], s71 offen offset:256 lds
    v_cvt_pk_bf16_f32 v170, v172, v173
    v_cvt_pk_bf16_f32 v171, v174, v175
    v_exp_f32 v176, v176
    v_exp_f32 v177, v177
    v_mfma_f32_32x32x16_bf16 v[192:207], v[136:139], v[168:171], v[192:207]
    s_add_u32 m0, s73, 5120
    s_add_u32 s71, s21, s57
    buffer_load_dword v90, s[24:27], s21 offen sc1 lds
    v_exp_f32 v178, v178
    v_exp_f32 v179, v179
    v_exp_f32 v180, v180
    s_waitcnt lgkmcnt(4)
    v_mfma_f32_32x32x16_bf16 v[160:175], v[112:115], v[96:99], 0
    s_add_u32 m0, m0, s57
    s_nop 0
    buffer_load_dwordx4 v0, s[24:27], s71 offen sc1 lds
    v_exp_f32 v181, v181
    v_cvt_pk_bf16_f32 v176, v176, v177
    v_exp_f32 v182, v182
    v_cvt_pk_bf16_f32 v177, v178, v179
    v_mfma_f32_32x32x16_bf16 v[12:27], v[140:143], v[152:155], v[12:27]
    ds_read_b64_tr_b16 v[140:141], v84 offset:26624
    ds_read_b64_tr_b16 v[142:143], v84 offset:27648
    s_cmp_lg_u32 s20, 17
    s_cbranch_scc1 L_al_48_3
    s_add_u32 s43, s34, 0
    buffer_load_dwordx4 v[72:75], v0, s[24:27], s43 offen offset:3072 sc1
L_al_48_3:
    v_exp_f32 v183, v183
    v_cvt_pk_bf16_f32 v178, v180, v181
    v_exp_f32 v184, v184
    v_mfma_f32_32x32x8_bf16 v[160:175], v[116:117], v[100:101], v[160:175]
    ds_read_b128 v[156:159], v83 offset:17408
    s_cmp_lg_u32 s20, 17
    s_cbranch_scc1 L_al_48_4
    s_add_u32 s43, s34, 4096
    buffer_load_dwordx4 v[76:79], v0, s[24:27], s43 offen offset:0 sc1
L_al_48_4:
    v_cvt_pk_bf16_f32 v179, v182, v183
    v_exp_f32 v185, v185
    v_exp_f32 v186, v186
    v_mfma_f32_32x32x16_bf16 v[208:223], v[132:135], v[176:179], v[208:223]
    s_cmp_lg_u32 s20, 17
    s_cbranch_scc1 L_al_48_5
    s_add_u32 s43, s34, 4096
    buffer_load_dwordx4 v[224:227], v0, s[24:27], s43 offen offset:1024 sc1
L_al_48_5:
    v_exp_f32 v187, v187
    v_exp_f32 v188, v188
    v_exp_f32 v189, v189
    s_waitcnt lgkmcnt(3)
    v_mfma_f32_32x32x16_bf16 v[28:43], v[144:147], v[152:155], v[28:43]
    ds_read_b64_tr_b16 v[144:145], v85 offset:26624
    ds_read_b64_tr_b16 v[146:147], v85 offset:27648
    v_cvt_pk_bf16_f32 v184, v184, v185
    v_exp_f32 v190, v190
    v_cvt_pk_bf16_f32 v185, v186, v187
    v_exp_f32 v191, v191
    v_mfma_f32_32x32x16_bf16 v[44:59], v[148:151], v[152:155], v[44:59]
    ds_read_b64_tr_b16 v[148:149], v84 offset:30720
    ds_read_b64_tr_b16 v[150:151], v84 offset:31744
    v_cvt_pk_bf16_f32 v186, v188, v189
    v_cvt_pk_bf16_f32 v187, v190, v191
    v_exp_f32 v160, v160
    v_exp_f32 v161, v161
    s_add_u32 s20, s20, 1
    s_cmp_eq_u32 s20, s23
L_h0_g2:
    s_cbranch_scc1 L_h0_t2
L_h0_g2x:
    v_mfma_f32_32x32x16_bf16 v[208:223], v[136:139], v[184:187], v[208:223]
    v_exp_f32 v162, v162
    v_exp_f32 v163, v163
    v_exp_f32 v164, v164
    s_waitcnt vmcnt(14) lgkmcnt(0)
    s_barrier
    v_mfma_f32_32x32x16_bf16 v[176:191], v[112:115], v[102:105], 0
    ds_read_b128 v[118:121], v80 offset:15360
    ds_read_b64 v[122:123], v81 offset:15360
    ds_read_b128 v[132:135], v82 offset:15360
    ds_read_b128 v[136:139], v82 offset:16000
    v_readlane_b32 s21, v88, s74
    v_readlane_b32 s22, v87, s74
    s_add_u32 s74, s74, 1
    v_exp_f32 v165, v165
    v_cvt_pk_bf16_f32 v160, v160, v161
    v_exp_f32 v166, v166
    v_cvt_pk_bf16_f32 v161, v162, v163
    v_mfma_f32_32x32x16_bf16 v[12:27], v[140:143], v[156:159], v[12:27]
    ds_read_b64_tr_b16 v[140:141], v84 offset:36864
    ds_read_b64_tr_b16 v[142:143], v84 offset:37888
    s_lshl_b32 s70, s22, 11
    s_add_u32 m0, s89, 16384
    s_add_u32 s70, s70, s65
    buffer_load_dwordx4 v0, s[24:27], s70 offen sc1 lds
    v_exp_f32 v167, v167
    v_cvt_pk_bf16_f32 v162, v164, v165
    v_exp_f32 v168, v168
    v_mfma_f32_32x32x8_bf16 v[176:191], v[116:117], v[106:107], v[176:191]
    ds_read_b128 v[152:155], v83 offset:24576
    buffer_load_dwordx4 v0, s[24:27], s70 offen offset:1024 sc1 lds
    v_cvt_pk_bf16_f32 v163, v166, v167
    v_exp_f32 v169, v169
    v_exp_f32 v170, v170
    v_mfma_f32_32x32x16_bf16 v[192:207], v[124:127], v[160:163], v[192:207]
    s_mul_i32 s71, s22, 36864
    s_add_u32 m0, s72, 24576
    s_add_u32 s71, s71, s64
    buffer_load_dwordx4 v89, s[28:31], s71 offen lds
    v_exp_f32 v171, v171
    v_exp_f32 v172, v172
    v_exp_f32 v173, v173
    v_mfma_f32_32x32x16_bf16 v[28:43], v[144:147], v[156:159], v[28:43]
    ds_read_b64_tr_b16 v[144:145], v85 offset:36864
    ds_read_b64_tr_b16 v[146:147], v85 offset:37888
    s_add_u32 m0, s72, 28544
    s_nop 0
    buffer_load_dwordx4 v89, s[28:31], s71 offen offset:128 lds
    v_cvt_pk_bf16_f32 v168, v168, v169
    v_exp_f32 v174, v174
    v_cvt_pk_bf16_f32 v169, v170, v171
    v_exp_f32 v175, v175
    v_mfma_f32_32x32x16_bf16 v[44:59], v[148:151], v[156:159], v[44:59]
    ds_read_b64_tr_b16 v[148:149], v84 offset:40960
    ds_read_b64_tr_b16 v[150:151], v84 offset:41984
    s_add_u32 m0, s72, 32512
    s_nop 0
    buffer_load_dwordx4 v89, s[28:31], s71 offen offset:256 lds
    v_cvt_pk_bf16_f32 v170, v172, v173
    v_cvt_pk_bf16_f32 v171, v174, v175
    v_exp_f32 v176, v176
    v_exp_f32 v177, v177
    v_mfma_f32_32x32x16_bf16 v[192:207], v[128:131], v[168:171], v[192:207]
    s_add_u32 m0, s73, 10240
    s_add_u32 s71, s21, s57
    buffer_load_dword v90, s[24:27], s21 offen sc1 lds
    v_exp_f32 v178, v178
    v_exp_f32 v179, v179
    v_exp_f32 v180, v180
    s_waitcnt lgkmcnt(4)
    v_mfma_f32_32x32x16_bf16 v[160:175], v[118:121], v[96:99], 0
    s_add_u32 m0, m0, s57
    s_nop 0
    buffer_load_dwordx4 v0, s[24:27], s71 offen sc1 lds
    v_exp_f32 v181, v181
    v_cvt_pk_bf16_f32 v176, v176, v177
    v_exp_f32 v182, v182
    v_cvt_pk_bf16_f32 v177, v178, v179
    v_mfma_f32_32x32x16_bf16 v[12:27], v[140:143], v[152:155], v[12:27]
    ds_read_b64_tr_b16 v[140:141], v84 offset:38912
    ds_read_b64_tr_b16 v[142:143], v84 offset:39936
    s_cmp_lg_u32 s20, 18
    s_cbranch_scc1 L_al_49_6
    s_add_u32 s43, s34, 4096
    buffer_load_dwordx4 v[228:231], v0, s[24:27], s43 offen offset:2048 sc1
L_al_49_6:
    v_exp_f32 v183, v183
    v_cvt_pk_bf16_f32 v178, v180, v181
    v_exp_f32 v184, v184
    v_mfma_f32_32x32x8_bf16 v[160:175], v[122:123], v[100:101], v[160:175]
    ds_read_b128 v[156:159], v83 offset:25600
    s_cmp_lg_u32 s20, 18
    s_cbranch_scc1 L_al_49_7
    s_add_u32 s43, s34, 4096
    buffer_load_dwordx4 v[232:235], v0, s[24:27], s43 offen offset:3072 sc1
L_al_49_7:
    v_cvt_pk_bf16_f32 v179, v182, v183
    v_exp_f32 v185, v185
    v_exp_f32 v186, v186
    v_mfma_f32_32x32x16_bf16 v[208:223], v[124:127], v[176:179], v[208:223]
    s_cmp_lg_u32 s20, 18
    s_cbranch_scc1 L_al_49_8
    s_add_u32 s43, s34, 8192
    buffer_load_dwordx4 v[236:239], v0, s[24:27], s43 offen offset:0 sc1
L_al_49_8:
    v_exp_f32 v187, v187
    v_exp_f32 v188, v188
    v_exp_f32 v189, v189
    s_waitcnt lgkmcnt(3)
    v_mfma_f32_32x32x16_bf16 v[28:43], v[144:147], v[152:155], v[28:43]
    ds_read_b64_tr_b16 v[144:145], v85 offset:38912
    ds_read_b64_tr_b16 v[146:147], v85 offset:39936
    s_cmp_lg_u32 s20, s53
    s_cbranch_scc1 L_p2_pi
    buffer_load_dwordx2 v[92:93], v86, s[24:27], 0 offen sc1
L_p2_pi:
    v_cvt_pk_bf16_f32 v184, v184, v185
    v_exp_f32 v190, v190
    v_cvt_pk_bf16_f32 v185, v186, v187
    v_exp_f32 v191, v191
    v_mfma_f32_32x32x16_bf16 v[44:59], v[148:151], v[152:155], v[44:59]
    ds_read_b64_tr_b16 v[148:149], v84 offset:43008
    ds_read_b64_tr_b16 v[150:151], v84 offset:44032
    v_cvt_pk_bf16_f32 v186, v188, v189
    v_cvt_pk_bf16_f32 v187, v190, v191
    v_exp_f32 v160, v160
    v_exp_f32 v161, v161
    s_add_u32 s20, s20, 1
L_h0_g3:
    v_mfma_f32_32x32x16_bf16 v[208:223], v[128:131], v[184:187], v[208:223]
    v_exp_f32 v162, v162
    v_exp_f32 v163, v163
    v_exp_f32 v164, v164
    s_waitcnt vmcnt(14) lgkmcnt(0)
    s_barrier
    v_mfma_f32_32x32x16_bf16 v[176:191], v[118:121], v[102:105], 0
    ds_read_b128 v[112:115], v80 offset:0
    ds_read_b64 v[116:117], v81 offset:0
    ds_read_b128 v[124:127], v82 offset:0
    ds_read_b128 v[128:131], v82 offset:640
    v_readlane_b32 s21, v88, s74
    v_readlane_b32 s22, v87, s74
    s_add_u32 s74, s74, 1
    v_exp_f32 v165, v165
    v_cvt_pk_bf16_f32 v160, v160, v161
    v_exp_f32 v166, v166
    v_cvt_pk_bf16_f32 v161, v162, v163
    v_mfma_f32_32x32x16_bf16 v[12:27], v[140:143], v[156:159], v[12:27]
    ds_read_b64_tr_b16 v[140:141], v84 offset:0
    ds_read_b64_tr_b16 v[142:143], v84 offset:1024
    s_lshl_b32 s70, s22, 11
    s_add_u32 m0, s89, 24576
    s_add_u32 s70, s70, s65
    buffer_load_dwordx4 v0, s[24:27], s70 offen sc1 lds
    v_exp_f32 v167, v167
    v_cvt_pk_bf16_f32 v162, v164, v165
    v_exp_f32 v168, v168
    v_mfma_f32_32x32x8_bf16 v[176:191], v[122:123], v[106:107], v[176:191]
    ds_read_b128 v[152:155], v83 offset:0
    buffer_load_dwordx4 v0, s[24:27], s70 offen offset:1024 sc1 lds
    v_cvt_pk_bf16_f32 v163, v166, v167
    v_exp_f32 v169, v169
    v_exp_f32 v170, v170
    v_mfma_f32_32x32x16_bf16 v[192:207], v[132:135], v[160:163], v[192:207]
    s_mul_i32 s71, s22, 36864
    s_add_u32 m0, s72, 36864
    s_add_u32 s71, s71, s64
    buffer_load_dwordx4 v89, s[28:31], s71 offen lds
    v_exp_f32 v171, v171
    v_exp_f32 v172, v172
    v_exp_f32 v173, v173
    v_mfma_f32_32x32x16_bf16 v[28:43], v[144:147], v[156:159], v[28:43]
    ds_read_b64_tr_b16 v[144:145], v85 offset:0
    ds_read_b64_tr_b16 v[146:147], v85 offset:1024
    s_add_u32 m0, s72, 40832
    s_nop 0
    buffer_load_dwordx4 v89, s[28:31], s71 offen offset:128 lds
    v_cvt_pk_bf16_f32 v168, v168, v169
    v_exp_f32 v174, v174
    v_cvt_pk_bf16_f32 v169, v170, v171
    v_exp_f32 v175, v175
    v_mfma_f32_32x32x16_bf16 v[44:59], v[148:151], v[156:159], v[44:59]
    ds_read_b64_tr_b16 v[148:149], v84 offset:4096
    ds_read_b64_tr_b16 v[150:151], v84 offset:5120
    s_add_u32 m0, s72, 44800
    s_nop 0
    buffer_load_dwordx4 v89, s[28:31], s71 offen offset:256 lds
    v_cvt_pk_bf16_f32 v170, v172, v173
    v_cvt_pk_bf16_f32 v171, v174, v175
    v_exp_f32 v176, v176
    v_exp_f32 v177, v177
    v_mfma_f32_32x32x16_bf16 v[192:207], v[136:139], v[168:171], v[192:207]
    s_add_u32 m0, s73, 15360
    s_add_u32 s71, s21, s57
    buffer_load_dword v90, s[24:27], s21 offen sc1 lds
    v_exp_f32 v178, v178
    v_exp_f32 v179, v179
    v_exp_f32 v180, v180
    s_waitcnt lgkmcnt(4)
    v_mfma_f32_32x32x16_bf16 v[160:175], v[112:115], v[96:99], 0
    s_add_u32 m0, m0, s57
    s_nop 0
    buffer_load_dwordx4 v0, s[24:27], s71 offen sc1 lds
    v_exp_f32 v181, v181
    v_cvt_pk_bf16_f32 v176, v176, v177
    v_exp_f32 v182, v182
    v_cvt_pk_bf16_f32 v177, v178, v179
    v_mfma_f32_32x32x16_bf16 v[12:27], v[140:143], v[152:155], v[12:27]
    ds_read_b64_tr_b16 v[140:141], v84 offset:2048
    ds_read_b64_tr_b16 v[142:143], v84 offset:3072
    s_cmp_lg_u32 s20, 19
    s_cbranch_scc1 L_al_50_9
    s_add_u32 s43, s34, 36864
    buffer_load_dwordx4 v[240:243], v0, s[24:27], s43 offen offset:0 sc1
L_al_50_9:
    v_exp_f32 v183, v183
    v_cvt_pk_bf16_f32 v178, v180, v181
    v_exp_f32 v184, v184
    v_mfma_f32_32x32x8_bf16 v[160:175], v[116:117], v[100:101], v[160:175]
    ds_read_b128 v[156:159], v83 offset:1024
    s_cmp_lg_u32 s20, 19
    s_cbranch_scc1 L_al_50_10
    s_add_u32 s43, s34, 36864
    buffer_load_dwordx4 v[244:247], v0, s[24:27], s43 offen offset:1024 sc1
L_al_50_10:
    v_cvt_pk_bf16_f32 v179, v182, v183
    v_exp_f32 v185, v185
    v_exp_f32 v186, v186
    v_mfma_f32_32x32x16_bf16 v[208:223], v[132:135], v[176:179], v[208:223]
    s_cmp_lg_u32 s20, 19
    s_cbranch_scc1 L_al_50_11
    s_add_u32 s43, s34, 36864
    buffer_load_dwordx4 v[248:251], v0, s[24:27], s43 offen offset:2048 sc1
L_al_50_11:
    v_exp_f32 v187, v187
    v_exp_f32 v188, v188
    v_exp_f32 v189, v189
    s_waitcnt lgkmcnt(3)
    v_mfma_f32_32x32x16_bf16 v[28:43], v[144:147], v[152:155], v[28:43]
    ds_read_b64_tr_b16 v[144:145], v85 offset:2048
    ds_read_b64_tr_b16 v[146:147], v85 offset:3072
    v_cvt_pk_bf16_f32 v184, v184, v185
    v_exp_f32 v190, v190
    v_cvt_pk_bf16_f32 v185, v186, v187
    v_exp_f32 v191, v191
    v_mfma_f32_32x32x16_bf16 v[44:59], v[148:151], v[152:155], v[44:59]
    ds_read_b64_tr_b16 v[148:149], v84 offset:6144
    ds_read_b64_tr_b16 v[150:151], v84 offset:7168
    v_cvt_pk_bf16_f32 v186, v188, v189
    v_cvt_pk_bf16_f32 v187, v190, v191
    v_exp_f32 v160, v160
    v_exp_f32 v161, v161
    s_add_u32 s20, s20, 1
    s_branch L_h0_g0
L_h0_n0:
    v_mfma_f32_32x32x16_bf16 v[208:223], v[136:139], v[184:187], v[208:223]
    v_exp_f32 v162, v162
    v_exp_f32 v163, v163
    v_exp_f32 v164, v164
    s_waitcnt vmcnt(4) lgkmcnt(0)
    s_barrier
    v_mfma_f32_32x32x16_bf16 v[176:191], v[112:115], v[102:105], 0
    ds_read_b128 v[118:121], v80 offset:5120
    ds_read_b64 v[122:123], v81 offset:5120
    ds_read_b128 v[132:135], v82 offset:5120
    ds_read_b128 v[136:139], v82 offset:5760
    v_readlane_b32 s21, v88, s74
    s_add_u32 s74, s74, 1
    v_exp_f32 v165, v165
    v_cvt_pk_bf16_f32 v160, v160, v161
    v_exp_f32 v166, v166
    v_cvt_pk_bf16_f32 v161, v162, v163
    s_add_u32 m0, s73, 0
    s_add_u32 s71, s21, s57
    buffer_load_dword v90, s[24:27], s21 offen sc1 lds
    v_exp_f32 v167, v167
    v_cvt_pk_bf16_f32 v162, v164, v165
    v_exp_f32 v168, v168
    v_mfma_f32_32x32x8_bf16 v[176:191], v[116:117], v[106:107], v[176:191]
    s_add_u32 m0, m0, s57
    s_nop 0
    buffer_load_dwordx4 v0, s[24:27], s71 offen sc1 lds
    v_cvt_pk_bf16_f32 v163, v166, v167
    v_exp_f32 v169, v169
    v_exp_f32 v170, v170
    v_mfma_f32_32x32x16_bf16 v[192:207], v[124:127], v[160:163], v[192:207]
    v_exp_f32 v171, v171
    v_exp_f32 v172, v172
    v_exp_f32 v173, v173
    v_cvt_pk_bf16_f32 v168, v168, v169
    v_exp_f32 v174, v174
    v_cvt_pk_bf16_f32 v169, v170, v171
    v_exp_f32 v175, v175
    v_cvt_pk_bf16_f32 v170, v172, v173
    v_cvt_pk_bf16_f32 v171, v174, v175
    v_exp_f32 v176, v176
    v_exp_f32 v177, v177
    v_mfma_f32_32x32x16_bf16 v[192:207], v[128:131], v[168:171], v[192:207]
    v_exp_f32 v178, v178
    v_exp_f32 v179, v179
    v_exp_f32 v180, v180
    s_waitcnt lgkmcnt(0)
    v_mfma_f32_32x32x16_bf16 v[160:175], v[118:121], v[96:99], 0
    v_exp_f32 v181, v181
    v_cvt_pk_bf16_f32 v176, v176, v177
    v_exp_f32 v182, v182
    v_cvt_pk_bf16_f32 v177, v178, v179
    v_exp_f32 v183, v183
    v_cvt_pk_bf16_f32 v178, v180, v181
    v_exp_f32 v184, v184
    v_mfma_f32_32x32x8_bf16 v[160:175], v[122:123], v[100:101], v[160:175]
    v_cvt_pk_bf16_f32 v179, v182, v183
    v_exp_f32 v185, v185
    v_exp_f32 v186, v186
    v_mfma_f32_32x32x16_bf16 v[208:223], v[124:127], v[176:179], v[208:223]
    v_exp_f32 v187, v187
    v_exp_f32 v188, v188
    v_exp_f32 v189, v189
    v_cvt_pk_bf16_f32 v184, v184, v185
    v_exp_f32 v190, v190
    v_cvt_pk_bf16_f32 v185, v186, v187
    v_exp_f32 v191, v191
    v_cvt_pk_bf16_f32 v186, v188, v189
    v_cvt_pk_bf16_f32 v187, v190, v191
    v_exp_f32 v160, v160
    v_exp_f32 v161, v161
    s_add_u32 s20, s20, 1
L_h0_n1:
    v_mfma_f32_32x32x16_bf16 v[208:223], v[128:131], v[184:187], v[208:223]
    v_exp_f32 v162, v162
    v_exp_f32 v163, v163
    v_exp_f32 v164, v164
    s_waitcnt vmcnt(4) lgkmcnt(0)
    s_barrier
    v_mfma_f32_32x32x16_bf16 v[176:191], v[118:121], v[102:105], 0
    ds_read_b128 v[112:115], v80 offset:10240
    ds_read_b64 v[116:117], v81 offset:10240
    ds_read_b128 v[124:127], v82 offset:10240
    ds_read_b128 v[128:131], v82 offset:10880
    v_readlane_b32 s21, v88, s74
    s_add_u32 s74, s74, 1
    v_exp_f32 v165, v165
    v_cvt_pk_bf16_f32 v160, v160, v161
    v_exp_f32 v166, v166
    v_cvt_pk_bf16_f32 v161, v162, v163
    s_add_u32 m0, s73, 5120
    s_add_u32 s71, s21, s57
    buffer_load_dword v90, s[24:27], s21 offen sc1 lds
    v_exp_f32 v167, v167
    v_cvt_pk_bf16_f32 v162, v164, v165
    v_exp_f32 v168, v168
    v_mfma_f32_32x32x8_bf16 v[176:191], v[122:123], v[106:107], v[176:191]
    s_add_u32 m0, m0, s57
    s_nop 0
    buffer_load_dwordx4 v0, s[24:27], s71 offen sc1 lds
    v_cvt_pk_bf16_f32 v163, v166, v167
    v_exp_f32 v169, v169
    v_exp_f32 v170, v170
    v_mfma_f32_32x32x16_bf16 v[192:207], v[132:135], v[160:163], v[192:207]
    v_exp_f32 v171, v171
    v_exp_f32 v172, v172
    v_exp_f32 v173, v173
    v_cvt_pk_bf16_f32 v168, v168, v169
    v_exp_f32 v174, v174
    v_cvt_pk_bf16_f32 v169, v170, v171
    v_exp_f32 v175, v175
    v_cvt_pk_bf16_f32 v170, v172, v173
    v_cvt_pk_bf16_f32 v171, v174, v175
    v_exp_f32 v176, v176
    v_exp_f32 v177, v177
    v_mfma_f32_32x32x16_bf16 v[192:207], v[136:139], v[168:171], v[192:207]
    v_exp_f32 v178, v178
    v_exp_f32 v179, v179
    v_exp_f32 v180, v180
    s_waitcnt lgkmcnt(0)
    v_mfma_f32_32x32x16_bf16 v[160:175], v[112:115], v[96:99], 0
    v_exp_f32 v181, v181
    v_cvt_pk_bf16_f32 v176, v176, v177
    v_exp_f32 v182, v182
    v_cvt_pk_bf16_f32 v177, v178, v179
    v_exp_f32 v183, v183
    v_cvt_pk_bf16_f32 v178, v180, v181
    v_exp_f32 v184, v184
    v_mfma_f32_32x32x8_bf16 v[160:175], v[116:117], v[100:101], v[160:175]
    v_cvt_pk_bf16_f32 v179, v182, v183
    v_exp_f32 v185, v185
    v_exp_f32 v186, v186
    v_mfma_f32_32x32x16_bf16 v[208:223], v[132:135], v[176:179], v[208:223]
    v_exp_f32 v187, v187
    v_exp_f32 v188, v188
    v_exp_f32 v189, v189
    v_cvt_pk_bf16_f32 v184, v184, v185
    v_exp_f32 v190, v190
    v_cvt_pk_bf16_f32 v185, v186, v187
    v_exp_f32 v191, v191
    v_cvt_pk_bf16_f32 v186, v188, v189
    v_cvt_pk_bf16_f32 v187, v190, v191
    v_exp_f32 v160, v160
    v_exp_f32 v161, v161
    s_add_u32 s20, s20, 1
L_h0_n2:
    v_mfma_f32_32x32x16_bf16 v[208:223], v[136:139], v[184:187], v[208:223]
    v_exp_f32 v162, v162
    v_exp_f32 v163, v163
    v_exp_f32 v164, v164
    s_waitcnt vmcnt(4) lgkmcnt(0)
    s_barrier
    v_mfma_f32_32x32x16_bf16 v[176:191], v[112:115], v[102:105], 0
    ds_read_b128 v[118:121], v80 offset:15360
    ds_read_b64 v[122:123], v81 offset:15360
    ds_read_b128 v[132:135], v82 offset:15360
    ds_read_b128 v[136:139], v82 offset:16000
    v_readlane_b32 s21, v88, s74
    s_add_u32 s74, s74, 1
    v_exp_f32 v165, v165
    v_cvt_pk_bf16_f32 v160, v160, v161
    v_exp_f32 v166, v166
    v_cvt_pk_bf16_f32 v161, v162, v163
    s_add_u32 m0, s73, 10240
    s_add_u32 s71, s21, s57
    buffer_load_dword v90, s[24:27], s21 offen sc1 lds
    v_exp_f32 v167, v167
    v_cvt_pk_bf16_f32 v162, v164, v165
    v_exp_f32 v168, v168
    v_mfma_f32_32x32x8_bf16 v[176:191], v[116:117], v[106:107], v[176:191]
    s_add_u32 m0, m0, s57
    s_nop 0
    buffer_load_dwordx4 v0, s[24:27], s71 offen sc1 lds
    v_cvt_pk_bf16_f32 v163, v166, v167
    v_exp_f32 v169, v169
    v_exp_f32 v170, v170
    v_mfma_f32_32x32x16_bf16 v[192:207], v[124:127], v[160:163], v[192:207]
    v_exp_f32 v171, v171
    v_exp_f32 v172, v172
    v_exp_f32 v173, v173
    v_cvt_pk_bf16_f32 v168, v168, v169
    v_exp_f32 v174, v174
    v_cvt_pk_bf16_f32 v169, v170, v171
    v_exp_f32 v175, v175
    v_cvt_pk_bf16_f32 v170, v172, v173
    v_cvt_pk_bf16_f32 v171, v174, v175
    v_exp_f32 v176, v176
    v_exp_f32 v177, v177
    v_mfma_f32_32x32x16_bf16 v[192:207], v[128:131], v[168:171], v[192:207]
    v_exp_f32 v178, v178
    v_exp_f32 v179, v179
    v_exp_f32 v180, v180
    s_waitcnt lgkmcnt(0)
    v_mfma_f32_32x32x16_bf16 v[160:175], v[118:121], v[96:99], 0
    v_exp_f32 v181, v181
    v_cvt_pk_bf16_f32 v176, v176, v177
    v_exp_f32 v182, v182
    v_cvt_pk_bf16_f32 v177, v178, v179
    v_exp_f32 v183, v183
    v_cvt_pk_bf16_f32 v178, v180, v181
    v_exp_f32 v184, v184
    v_mfma_f32_32x32x8_bf16 v[160:175], v[122:123], v[100:101], v[160:175]
    v_cvt_pk_bf16_f32 v179, v182, v183
    v_exp_f32 v185, v185
    v_exp_f32 v186, v186
    v_mfma_f32_32x32x16_bf16 v[208:223], v[124:127], v[176:179], v[208:223]
    v_exp_f32 v187, v187
    v_exp_f32 v188, v188
    v_exp_f32 v189, v189
    v_cvt_pk_bf16_f32 v184, v184, v185
    v_exp_f32 v190, v190
    v_cvt_pk_bf16_f32 v185, v186, v187
    v_exp_f32 v191, v191
    v_cvt_pk_bf16_f32 v186, v188, v189
    v_cvt_pk_bf16_f32 v187, v190, v191
    v_exp_f32 v160, v160
    v_exp_f32 v161, v161
    s_add_u32 s20, s20, 1
L_h0_n3:
    v_mfma_f32_32x32x16_bf16 v[208:223], v[128:131], v[184:187], v[208:223]
    v_exp_f32 v162, v162
    v_exp_f32 v163, v163
    v_exp_f32 v164, v164
    s_waitcnt vmcnt(4) lgkmcnt(0)
    s_barrier
    v_mfma_f32_32x32x16_bf16 v[176:191], v[118:121], v[102:105], 0
    ds_read_b128 v[112:115], v80 offset:0
    ds_read_b64 v[116:117], v81 offset:0
    ds_read_b128 v[124:127], v82 offset:0
    ds_read_b128 v[128:131], v82 offset:640
    v_readlane_b32 s21, v88, s74
    s_add_u32 s74, s74, 1
    v_exp_f32 v165, v165
    v_cvt_pk_bf16_f32 v160, v160, v161
    v_exp_f32 v166, v166
    v_cvt_pk_bf16_f32 v161, v162, v163
    s_add_u32 m0, s73, 15360
    s_add_u32 s71, s21, s57
    buffer_load_dword v90, s[24:27], s21 offen sc1 lds
    v_exp_f32 v167, v167
    v_cvt_pk_bf16_f32 v162, v164, v165
    v_exp_f32 v168, v168
    v_mfma_f32_32x32x8_bf16 v[176:191], v[122:123], v[106:107], v[176:191]
    s_add_u32 m0, m0, s57
    s_nop 0
    buffer_load_dwordx4 v0, s[24:27], s71 offen sc1 lds
    v_cvt_pk_bf16_f32 v163, v166, v167
    v_exp_f32 v169, v169
    v_exp_f32 v170, v170
    v_mfma_f32_32x32x16_bf16 v[192:207], v[132:135], v[160:163], v[192:207]
    v_exp_f32 v171, v171
    v_exp_f32 v172, v172
    v_exp_f32 v173, v173
    v_cvt_pk_bf16_f32 v168, v168, v169
    v_exp_f32 v174, v174
    v_cvt_pk_bf16_f32 v169, v170, v171
    v_exp_f32 v175, v175
    v_cvt_pk_bf16_f32 v170, v172, v173
    v_cvt_pk_bf16_f32 v171, v174, v175
    v_exp_f32 v176, v176
    v_exp_f32 v177, v177
    v_mfma_f32_32x32x16_bf16 v[192:207], v[136:139], v[168:171], v[192:207]
    v_exp_f32 v178, v178
    v_exp_f32 v179, v179
    v_exp_f32 v180, v180
    s_waitcnt lgkmcnt(0)
    v_mfma_f32_32x32x16_bf16 v[160:175], v[112:115], v[96:99], 0
    v_exp_f32 v181, v181
    v_cvt_pk_bf16_f32 v176, v176, v177
    v_exp_f32 v182, v182
    v_cvt_pk_bf16_f32 v177, v178, v179
    v_exp_f32 v183, v183
    v_cvt_pk_bf16_f32 v178, v180, v181
    v_exp_f32 v184, v184
    v_mfma_f32_32x32x8_bf16 v[160:175], v[116:117], v[100:101], v[160:175]
    v_cvt_pk_bf16_f32 v179, v182, v183
    v_exp_f32 v185, v185
    v_exp_f32 v186, v186
    v_mfma_f32_32x32x16_bf16 v[208:223], v[132:135], v[176:179], v[208:223]
    v_exp_f32 v187, v187
    v_exp_f32 v188, v188
    v_exp_f32 v189, v189
    v_cvt_pk_bf16_f32 v184, v184, v185
    v_exp_f32 v190, v190
    v_cvt_pk_bf16_f32 v185, v186, v187
    v_exp_f32 v191, v191
    v_cvt_pk_bf16_f32 v186, v188, v189
    v_cvt_pk_bf16_f32 v187, v190, v191
    v_exp_f32 v160, v160
    v_exp_f32 v161, v161
    s_add_u32 s20, s20, 1
    s_cmp_lt_u32 s20, 32
    s_cbranch_scc1 L_h0_n0
    s_branch L_p2_fin
L_h0_t1:
    v_mfma_f32_32x32x16_bf16 v[208:223], v[128:131], v[184:187], v[208:223]
    v_exp_f32 v162, v162
    v_exp_f32 v163, v163
    v_exp_f32 v164, v164
    s_waitcnt vmcnt(7) lgkmcnt(0)
    s_barrier
    v_mfma_f32_32x32x16_bf16 v[176:191], v[118:121], v[102:105], 0
    ds_read_b128 v[112:115], v80 offset:10240
    ds_read_b64 v[116:117], v81 offset:10240
    ds_read_b128 v[124:127], v82 offset:10240
    ds_read_b128 v[128:131], v82 offset:10880
    v_exp_f32 v165, v165
    v_cvt_pk_bf16_f32 v160, v160, v161
    v_exp_f32 v166, v166
    v_cvt_pk_bf16_f32 v161, v162, v163
    v_mfma_f32_32x32x16_bf16 v[12:27], v[140:143], v[156:159], v[12:27]
    v_exp_f32 v167, v167
    v_cvt_pk_bf16_f32 v162, v164, v165
    v_exp_f32 v168, v168
    v_mfma_f32_32x32x8_bf16 v[176:191], v[122:123], v[106:107], v[176:191]
    v_cvt_pk_bf16_f32 v163, v166, v167
    v_exp_f32 v169, v169
    v_exp_f32 v170, v170
    v_mfma_f32_32x32x16_bf16 v[192:207], v[132:135], v[160:163], v[192:207]
    v_exp_f32 v171, v171
    v_exp_f32 v172, v172
    v_exp_f32 v173, v173
    v_mfma_f32_32x32x16_bf16 v[28:43], v[144:147], v[156:159], v[28:43]
    v_cvt_pk_bf16_f32 v168, v168, v169
    v_exp_f32 v174, v174
    v_cvt_pk_bf16_f32 v169, v170, v171
    v_exp_f32 v175, v175
    v_mfma_f32_32x32x16_bf16 v[44:59], v[148:151], v[156:159], v[44:59]
    v_cvt_pk_bf16_f32 v170, v172, v173
    v_cvt_pk_bf16_f32 v171, v174, v175
    v_exp_f32 v176, v176
    v_exp_f32 v177, v177
    v_mfma_f32_32x32x16_bf16 v[192:207], v[136:139], v[168:171], v[192:207]
    v_cvt_pk_bf16_f32 v12, v12, v13
    v_cvt_pk_bf16_f32 v13, v14, v15
    v_cvt_pk_bf16_f32 v14, v16, v17
    v_cvt_pk_bf16_f32 v15, v18, v19
    buffer_store_dwordx4 v[12:15], v0, s[24:27], s75 offen offset:0 sc1
    v_exp_f32 v178, v178
    v_exp_f32 v179, v179
    v_exp_f32 v180, v180
    s_waitcnt lgkmcnt(0)
    v_mfma_f32_32x32x16_bf16 v[160:175], v[112:115], v[96:99], 0
    v_cvt_pk_bf16_f32 v16, v20, v21
    v_cvt_pk_bf16_f32 v17, v22, v23
    v_cvt_pk_bf16_f32 v18, v24, v25
    v_cvt_pk_bf16_f32 v19, v26, v27
    buffer_store_dwordx4 v[16:19], v0, s[24:27], s75 offen offset:1024 sc1
    v_exp_f32 v181, v181
    v_cvt_pk_bf16_f32 v176, v176, v177
    v_exp_f32 v182, v182
    v_cvt_pk_bf16_f32 v177, v178, v179
    v_cvt_pk_bf16_f32 v28, v28, v29
    v_cvt_pk_bf16_f32 v29, v30, v31
    v_cvt_pk_bf16_f32 v30, v32, v33
    v_cvt_pk_bf16_f32 v31, v34, v35
    buffer_store_dwordx4 v[28:31], v0, s[24:27], s75 offen offset:2048 sc1
    v_exp_f32 v183, v183
    v_cvt_pk_bf16_f32 v178, v180, v181
    v_exp_f32 v184, v184
    v_mfma_f32_32x32x8_bf16 v[160:175], v[116:117], v[100:101], v[160:175]
    v_cvt_pk_bf16_f32 v32, v36, v37
    v_cvt_pk_bf16_f32 v33, v38, v39
    v_cvt_pk_bf16_f32 v34, v40, v41
    v_cvt_pk_bf16_f32 v35, v42, v43
    buffer_store_dwordx4 v[32:35], v0, s[24:27], s75 offen offset:3072 sc1
    v_cvt_pk_bf16_f32 v179, v182, v183
    v_exp_f32 v185, v185
    v_exp_f32 v186, v186
    v_mfma_f32_32x32x16_bf16 v[208:223], v[132:135], v[176:179], v[208:223]
    v_cvt_pk_bf16_f32 v44, v44, v45
    v_cvt_pk_bf16_f32 v45, v46, v47
    v_cvt_pk_bf16_f32 v46, v48, v49
    v_cvt_pk_bf16_f32 v47, v50, v51
    s_add_u32 s75, s75, 4096
    buffer_store_dwordx4 v[44:47], v0, s[24:27], s75 offen offset:0 sc1
    v_exp_f32 v187, v187
    v_exp_f32 v188, v188
    v_exp_f32 v189, v189
    v_cvt_pk_bf16_f32 v48, v52, v53
    v_cvt_pk_bf16_f32 v49, v54, v55
    v_cvt_pk_bf16_f32 v50, v56, v57
    v_cvt_pk_bf16_f32 v51, v58, v59
    buffer_store_dwordx4 v[48:51], v0, s[24:27], s75 offen offset:1024 sc1
    v_cvt_pk_bf16_f32 v184, v184, v185
    v_exp_f32 v190, v190
    v_cvt_pk_bf16_f32 v185, v186, v187
    v_exp_f32 v191, v191
    v_cvt_pk_bf16_f32 v186, v188, v189
    v_cvt_pk_bf16_f32 v187, v190, v191
    v_exp_f32 v160, v160
    v_exp_f32 v161, v161
    v_mfma_f32_32x32x16_bf16 v[208:223], v[136:139], v[184:187], v[208:223]
    v_exp_f32 v162, v162
    v_exp_f32 v163, v163
    v_exp_f32 v164, v164
    s_waitcnt vmcnt(63) lgkmcnt(0)
    s_barrier
    v_mfma_f32_32x32x16_bf16 v[176:191], v[112:115], v[102:105], 0
    ds_read_b128 v[118:121], v80 offset:15360
    ds_read_b64 v[122:123], v81 offset:15360
    ds_read_b128 v[132:135], v82 offset:15360
    ds_read_b128 v[136:139], v82 offset:16000
    v_exp_f32 v165, v165
    v_cvt_pk_bf16_f32 v160, v160, v161
    v_exp_f32 v166, v166
    v_cvt_pk_bf16_f32 v161, v162, v163
    v_exp_f32 v167, v167
    v_cvt_pk_bf16_f32 v162, v164, v165
    v_exp_f32 v168, v168
    v_mfma_f32_32x32x8_bf16 v[176:191], v[116:117], v[106:107], v[176:191]
    v_cvt_pk_bf16_f32 v163, v166, v167
    v_exp_f32 v169, v169
    v_exp_f32 v170, v170
    v_mfma_f32_32x32x16_bf16 v[192:207], v[124:127], v[160:163], v[192:207]
    v_exp_f32 v171, v171
    v_exp_f32 v172, v172
    v_exp_f32 v173, v173
    v_cvt_pk_bf16_f32 v168, v168, v169
    v_exp_f32 v174, v174
    v_cvt_pk_bf16_f32 v169, v170, v171
    v_exp_f32 v175, v175
    v_cvt_pk_bf16_f32 v170, v172, v173
    v_cvt_pk_bf16_f32 v171, v174, v175
    v_exp_f32 v176, v176
    v_exp_f32 v177, v177
    v_mfma_f32_32x32x16_bf16 v[192:207], v[128:131], v[168:171], v[192:207]
    v_exp_f32 v178, v178
    v_exp_f32 v179, v179
    v_exp_f32 v180, v180
    s_waitcnt lgkmcnt(0)
    v_mfma_f32_32x32x16_bf16 v[160:175], v[118:121], v[96:99], 0
    v_exp_f32 v181, v181
    v_cvt_pk_bf16_f32 v176, v176, v177
    v_exp_f32 v182, v182
    v_cvt_pk_bf16_f32 v177, v178, v179
    v_exp_f32 v183, v183
    v_cvt_pk_bf16_f32 v178, v180, v181
    v_exp_f32 v184, v184
    v_mfma_f32_32x32x8_bf16 v[160:175], v[122:123], v[100:101], v[160:175]
    v_cvt_pk_bf16_f32 v179, v182, v183
    v_exp_f32 v185, v185
    v_exp_f32 v186, v186
    v_mfma_f32_32x32x16_bf16 v[208:223], v[124:127], v[176:179], v[208:223]
    v_exp_f32 v187, v187
    v_exp_f32 v188, v188
    v_exp_f32 v189, v189
    v_cvt_pk_bf16_f32 v184, v184, v185
    v_exp_f32 v190, v190
    v_cvt_pk_bf16_f32 v185, v186, v187
    v_exp_f32 v191, v191
    v_cvt_pk_bf16_f32 v186, v188, v189
    v_cvt_pk_bf16_f32 v187, v190, v191
    v_exp_f32 v160, v160
    v_exp_f32 v161, v161
    s_branch L_h0_e3
L_h0_t2:
    v_mfma_f32_32x32x16_bf16 v[208:223], v[136:139], v[184:187], v[208:223]
    v_exp_f32 v162, v162
    v_exp_f32 v163, v163
    v_exp_f32 v164, v164
    s_waitcnt vmcnt(14) lgkmcnt(0)
    s_barrier
    v_mfma_f32_32x32x16_bf16 v[176:191], v[112:115], v[102:105], 0
    ds_read_b128 v[118:121], v80 offset:15360
    ds_read_b64 v[122:123], v81 offset:15360
    ds_read_b128 v[132:135], v82 offset:15360
    ds_read_b128 v[136:139], v82 offset:16000
    v_exp_f32 v165, v165
    v_cvt_pk_bf16_f32 v160, v160, v161
    v_exp_f32 v166, v166
    v_cvt_pk_bf16_f32 v161, v162, v163
    v_mfma_f32_32x32x16_bf16 v[12:27], v[140:143], v[156:159], v[12:27]
    v_exp_f32 v167, v167
    v_cvt_pk_bf16_f32 v162, v164, v165
    v_exp_f32 v168, v168
    v_mfma_f32_32x32x8_bf16 v[176:191], v[116:117], v[106:107], v[176:191]
    v_cvt_pk_bf16_f32 v163, v166, v167
    v_exp_f32 v169, v169
    v_exp_f32 v170, v170
    v_mfma_f32_32x32x16_bf16 v[192:207], v[124:127], v[160:163], v[192:207]
    v_exp_f32 v171, v171
    v_exp_f32 v172, v172
    v_exp_f32 v173, v173
    v_mfma_f32_32x32x16_bf16 v[28:43], v[144:147], v[156:159], v[28:43]
    v_cvt_pk_bf16_f32 v168, v168, v169
    v_exp_f32 v174, v174
    v_cvt_pk_bf16_f32 v169, v170, v171
    v_exp_f32 v175, v175
    v_mfma_f32_32x32x16_bf16 v[44:59], v[148:151], v[156:159], v[44:59]
    v_cvt_pk_bf16_f32 v170, v172, v173
    v_cvt_pk_bf16_f32 v171, v174, v175
    v_exp_f32 v176, v176
    v_exp_f32 v177, v177
    v_mfma_f32_32x32x16_bf16 v[192:207], v[128:131], v[168:171], v[192:207]
    v_cvt_pk_bf16_f32 v12, v12, v13
    v_cvt_pk_bf16_f32 v13, v14, v15
    v_cvt_pk_bf16_f32 v14, v16, v17
    v_cvt_pk_bf16_f32 v15, v18, v19
    buffer_store_dwordx4 v[12:15], v0, s[24:27], s75 offen offset:0 sc1
    v_exp_f32 v178, v178
    v_exp_f32 v179, v179
    v_exp_f32 v180, v180
    s_waitcnt lgkmcnt(0)
    v_mfma_f32_32x32x16_bf16 v[160:175], v[118:121], v[96:99], 0
    v_cvt_pk_bf16_f32 v16, v20, v21
    v_cvt_pk_bf16_f32 v17, v22, v23
    v_cvt_pk_bf16_f32 v18, v24, v25
    v_cvt_pk_bf16_f32 v19, v26, v27
    buffer_store_dwordx4 v[16:19], v0, s[24:27], s75 offen offset:1024 sc1
    v_exp_f32 v181, v181
    v_cvt_pk_bf16_f32 v176, v176, v177
    v_exp_f32 v182, v182
    v_cvt_pk_bf16_f32 v177, v178, v179
    v_cvt_pk_bf16_f32 v28, v28, v29
    v_cvt_pk_bf16_f32 v29, v30, v31
    v_cvt_pk_bf16_f32 v30, v32, v33
    v_cvt_pk_bf16_f32 v31, v34, v35
    buffer_store_dwordx4 v[28:31], v0, s[24:27], s75 offen offset:2048 sc1
    v_exp_f32 v183, v183
    v_cvt_pk_bf16_f32 v178, v180, v181
    v_exp_f32 v184, v184
    v_mfma_f32_32x32x8_bf16 v[160:175], v[122:123], v[100:101], v[160:175]
    v_cvt_pk_bf16_f32 v32, v36, v37
    v_cvt_pk_bf16_f32 v33, v38, v39
    v_cvt_pk_bf16_f32 v34, v40, v41
    v_cvt_pk_bf16_f32 v35, v42, v43
    buffer_store_dwordx4 v[32:35], v0, s[24:27], s75 offen offset:3072 sc1
    v_cvt_pk_bf16_f32 v179, v182, v183
    v_exp_f32 v185, v185
    v_exp_f32 v186, v186
    v_mfma_f32_32x32x16_bf16 v[208:223], v[124:127], v[176:179], v[208:223]
    v_cvt_pk_bf16_f32 v44, v44, v45
    v_cvt_pk_bf16_f32 v45, v46, v47
    v_cvt_pk_bf16_f32 v46, v48, v49
    v_cvt_pk_bf16_f32 v47, v50, v51
    s_add_u32 s75, s75, 4096
    buffer_store_dwordx4 v[44:47], v0, s[24:27], s75 offen offset:0 sc1
    v_exp_f32 v187, v187
    v_exp_f32 v188, v188
    v_exp_f32 v189, v189
    v_cvt_pk_bf16_f32 v48, v52, v53
    v_cvt_pk_bf16_f32 v49, v54, v55
    v_cvt_pk_bf16_f32 v50, v56, v57
    v_cvt_pk_bf16_f32 v51, v58, v59
    buffer_store_dwordx4 v[48:51], v0, s[24:27], s75 offen offset:1024 sc1
    v_cvt_pk_bf16_f32 v184, v184, v185
    v_exp_f32 v190, v190
    v_cvt_pk_bf16_f32 v185, v186, v187
    v_exp_f32 v191, v191
    v_cvt_pk_bf16_f32 v186, v188, v189
    v_cvt_pk_bf16_f32 v187, v190, v191
    v_exp_f32 v160, v160
    v_exp_f32 v161, v161
L_h0_e3:
    v_mfma_f32_32x32x16_bf16 v[208:223], v[128:131], v[184:187], v[208:223]
    v_exp_f32 v162, v162
    v_exp_f32 v163, v163
    v_exp_f32 v164, v164
    s_waitcnt vmcnt(63) lgkmcnt(0)
    s_barrier
    v_mfma_f32_32x32x16_bf16 v[176:191], v[118:121], v[102:105], 0
    ds_read_b128 v[112:115], v80 offset:0
    ds_read_b64 v[116:117], v81 offset:0
    ds_read_b128 v[124:127], v82 offset:0
    ds_read_b128 v[128:131], v82 offset:640
    v_exp_f32 v165, v165
    v_cvt_pk_bf16_f32 v160, v160, v161
    v_exp_f32 v166, v166
    v_cvt_pk_bf16_f32 v161, v162, v163
    v_exp_f32 v167, v167
    v_cvt_pk_bf16_f32 v162, v164, v165
    v_exp_f32 v168, v168
    v_mfma_f32_32x32x8_bf16 v[176:191], v[122:123], v[106:107], v[176:191]
    v_cvt_pk_bf16_f32 v163, v166, v167
    v_exp_f32 v169, v169
    v_exp_f32 v170, v170
    v_mfma_f32_32x32x16_bf16 v[192:207], v[132:135], v[160:163], v[192:207]
    v_exp_f32 v171, v171
    v_exp_f32 v172, v172
    v_exp_f32 v173, v173
    v_cvt_pk_bf16_f32 v168, v168, v169
    v_exp_f32 v174, v174
    v_cvt_pk_bf16_f32 v169, v170, v171
    v_exp_f32 v175, v175
    v_cvt_pk_bf16_f32 v170, v172, v173
    v_cvt_pk_bf16_f32 v171, v174, v175
    v_exp_f32 v176, v176
    v_exp_f32 v177, v177
    v_mfma_f32_32x32x16_bf16 v[192:207], v[136:139], v[168:171], v[192:207]
    v_exp_f32 v178, v178
    v_exp_f32 v179, v179
    v_exp_f32 v180, v180
    s_waitcnt lgkmcnt(0)
    v_mfma_f32_32x32x16_bf16 v[160:175], v[112:115], v[96:99], 0
    v_exp_f32 v181, v181
    v_cvt_pk_bf16_f32 v176, v176, v177
    v_exp_f32 v182, v182
    v_cvt_pk_bf16_f32 v177, v178, v179
    v_exp_f32 v183, v183
    v_cvt_pk_bf16_f32 v178, v180, v181
    v_exp_f32 v184, v184
    v_mfma_f32_32x32x8_bf16 v[160:175], v[116:117], v[100:101], v[160:175]
    v_cvt_pk_bf16_f32 v179, v182, v183
    v_exp_f32 v185, v185
    v_exp_f32 v186, v186
    v_mfma_f32_32x32x16_bf16 v[208:223], v[132:135], v[176:179], v[208:223]
    v_exp_f32 v187, v187
    v_exp_f32 v188, v188
    v_exp_f32 v189, v189
    v_cvt_pk_bf16_f32 v184, v184, v185
    v_exp_f32 v190, v190
    v_cvt_pk_bf16_f32 v185, v186, v187
    v_exp_f32 v191, v191
    v_cvt_pk_bf16_f32 v186, v188, v189
    v_cvt_pk_bf16_f32 v187, v190, v191
    v_exp_f32 v160, v160
    v_exp_f32 v161, v161
    s_branch L_p2_fin
L_p2_h1:
    s_nop 9
    v_exp_f32 v160, v160
    v_exp_f32 v161, v161
    v_exp_f32 v162, v162
    v_exp_f32 v163, v163
    v_exp_f32 v164, v164
    s_waitcnt vmcnt(63) lgkmcnt(0)
    s_barrier
    v_mfma_f32_32x32x16_bf16 v[176:191], v[112:115], v[102:105], 0
    ds_read_b128 v[118:121], v80 offset:5120
    ds_read_b64 v[122:123], v81 offset:5120
    ds_read_b128 v[132:135], v82 offset:5120
    ds_read_b128 v[136:139], v82 offset:5760
    v_exp_f32 v165, v165
    v_cvt_pk_bf16_f32 v160, v160, v161
    v_exp_f32 v166, v166
    v_cvt_pk_bf16_f32 v161, v162, v163
    v_exp_f32 v167, v167
    v_cvt_pk_bf16_f32 v162, v164, v165
    v_exp_f32 v168, v168
    v_mfma_f32_32x32x8_bf16 v[176:191], v[116:117], v[106:107], v[176:191]
    v_cvt_pk_bf16_f32 v163, v166, v167
    v_exp_f32 v169, v169
    v_exp_f32 v170, v170
    v_mfma_f32_32x32x16_bf16 v[192:207], v[124:127], v[160:163], 0
    v_exp_f32 v171, v171
    v_exp_f32 v172, v172
    v_exp_f32 v173, v173
    v_cvt_pk_bf16_f32 v168, v168, v169
    v_exp_f32 v174, v174
    v_cvt_pk_bf16_f32 v169, v170, v171
    v_exp_f32 v175, v175
    v_cvt_pk_bf16_f32 v170, v172, v173
    v_cvt_pk_bf16_f32 v171, v174, v175
    v_exp_f32 v176, v176
    v_exp_f32 v177, v177
    v_mfma_f32_32x32x16_bf16 v[192:207], v[128:131], v[168:171], v[192:207]
    v_exp_f32 v178, v178
    v_exp_f32 v179, v179
    v_exp_f32 v180, v180
    s_waitcnt lgkmcnt(0)
    v_mfma_f32_32x32x16_bf16 v[160:175], v[118:121], v[96:99], 0
    v_exp_f32 v181, v181
    v_cvt_pk_bf16_f32 v176, v176, v177
    v_exp_f32 v182, v182
    v_cvt_pk_bf16_f32 v177, v178, v179
    v_exp_f32 v183, v183
    v_cvt_pk_bf16_f32 v178, v180, v181
    v_exp_f32 v184, v184
    v_mfma_f32_32x32x8_bf16 v[160:175], v[122:123], v[100:101], v[160:175]
    v_cvt_pk_bf16_f32 v179, v182, v183
    v_exp_f32 v185, v185
    v_exp_f32 v186, v186
    v_mfma_f32_32x32x16_bf16 v[208:223], v[124:127], v[176:179], 0
    v_exp_f32 v187, v187
    v_exp_f32 v188, v188
    v_exp_f32 v189, v189
    v_cvt_pk_bf16_f32 v184, v184, v185
    v_exp_f32 v190, v190
    v_cvt_pk_bf16_f32 v185, v186, v187
    v_exp_f32 v191, v191
    v_cvt_pk_bf16_f32 v186, v188, v189
    v_cvt_pk_bf16_f32 v187, v190, v191
    v_exp_f32 v160, v160
    v_exp_f32 v161, v161
    v_mfma_f32_32x32x16_bf16 v[208:223], v[128:131], v[184:187], v[208:223]
    v_exp_f32 v162, v162
    v_exp_f32 v163, v163
    v_exp_f32 v164, v164
    s_waitcnt vmcnt(0) lgkmcnt(0)
    s_barrier
    v_mfma_f32_32x32x16_bf16 v[176:191], v[118:121], v[102:105], 0
    ds_read_b128 v[112:115], v80 offset:10240
    ds_read_b64 v[116:117], v81 offset:10240
    ds_read_b128 v[124:127], v82 offset:10240
    ds_read_b128 v[128:131], v82 offset:10880
    v_exp_f32 v165, v165
    v_cvt_pk_bf16_f32 v160, v160, v161
    v_exp_f32 v166, v166
    v_cvt_pk_bf16_f32 v161, v162, v163
    ds_read_b64_tr_b16 v[140:141], v84 offset:24576
    ds_read_b64_tr_b16 v[142:143], v84 offset:25600
    v_exp_f32 v167, v167
    v_cvt_pk_bf16_f32 v162, v164, v165
    v_exp_f32 v168, v168
    v_mfma_f32_32x32x8_bf16 v[176:191], v[122:123], v[106:107], v[176:191]
    ds_read_b128 v[152:155], v83 offset:16384
    v_cvt_pk_bf16_f32 v163, v166, v167
    v_exp_f32 v169, v169
    v_exp_f32 v170, v170
    v_mfma_f32_32x32x16_bf16 v[192:207], v[132:135], v[160:163], v[192:207]
    v_exp_f32 v171, v171
    v_exp_f32 v172, v172
    v_exp_f32 v173, v173
    ds_read_b64_tr_b16 v[144:145], v85 offset:24576
    ds_read_b64_tr_b16 v[146:147], v85 offset:25600
    v_cvt_pk_bf16_f32 v168, v168, v169
    v_exp_f32 v174, v174
    v_cvt_pk_bf16_f32 v169, v170, v171
    v_exp_f32 v175, v175
    ds_read_b64_tr_b16 v[148:149], v84 offset:28672
    ds_read_b64_tr_b16 v[150:151], v84 offset:29696
    v_cvt_pk_bf16_f32 v170, v172, v173
    v_cvt_pk_bf16_f32 v171, v174, v175
    v_exp_f32 v176, v176
    v_exp_f32 v177, v177
    v_mfma_f32_32x32x16_bf16 v[192:207], v[136:139], v[168:171], v[192:207]
    v_exp_f32 v178, v178
    v_exp_f32 v179, v179
    v_exp_f32 v180, v180
    s_waitcnt lgkmcnt(4)
    v_mfma_f32_32x32x16_bf16 v[160:175], v[112:115], v[96:99], 0
    v_exp_f32 v181, v181
    v_cvt_pk_bf16_f32 v176, v176, v177
    v_exp_f32 v182, v182
    v_cvt_pk_bf16_f32 v177, v178, v179
    v_mfma_f32_32x32x16_bf16 v[12:27], v[140:143], v[152:155], 0
    ds_read_b64_tr_b16 v[140:141], v84 offset:26624
    ds_read_b64_tr_b16 v[142:143], v84 offset:27648
    v_exp_f32 v183, v183
    v_cvt_pk_bf16_f32 v178, v180, v181
    v_exp_f32 v184, v184
    v_mfma_f32_32x32x8_bf16 v[160:175], v[116:117], v[100:101], v[160:175]
    ds_read_b128 v[156:159], v83 offset:17408
    v_cvt_pk_bf16_f32 v179, v182, v183
    v_exp_f32 v185, v185
    v_exp_f32 v186, v186
    v_mfma_f32_32x32x16_bf16 v[208:223], v[132:135], v[176:179], v[208:223]
    v_exp_f32 v187, v187
    v_exp_f32 v188, v188
    v_exp_f32 v189, v189
    s_waitcnt lgkmcnt(3)
    v_mfma_f32_32x32x16_bf16 v[28:43], v[144:147], v[152:155], 0
    ds_read_b64_tr_b16 v[144:145], v85 offset:26624
    ds_read_b64_tr_b16 v[146:147], v85 offset:27648
    v_cvt_pk_bf16_f32 v184, v184, v185
    v_exp_f32 v190, v190
    v_cvt_pk_bf16_f32 v185, v186, v187
    v_exp_f32 v191, v191
    v_mfma_f32_32x32x16_bf16 v[44:59], v[148:151], v[152:155], 0
    ds_read_b64_tr_b16 v[148:149], v84 offset:30720
    ds_read_b64_tr_b16 v[150:151], v84 offset:31744
    v_cvt_pk_bf16_f32 v186, v188, v189
    v_cvt_pk_bf16_f32 v187, v190, v191
    v_exp_f32 v160, v160
    v_exp_f32 v161, v161
    s_mov_b32 s20, 2
    s_add_u32 s23, s56, 1
    s_cmp_eq_u32 s56, 0
    s_cbranch_scc1 L_h1_n2
    s_branch L_h1_g2x
L_h1_g0:
    v_mfma_f32_32x32x16_bf16 v[208:223], v[136:139], v[184:187], v[208:223]
    v_exp_f32 v162, v162
    v_exp_f32 v163, v163
    v_exp_f32 v164, v164
    s_waitcnt vmcnt(63) lgkmcnt(0)
    s_barrier
    v_mfma_f32_32x32x16_bf16 v[176:191], v[112:115], v[102:105], 0
    ds_read_b128 v[118:121], v80 offset:5120
    ds_read_b64 v[122:123], v81 offset:5120
    ds_read_b128 v[132:135], v82 offset:5120
    ds_read_b128 v[136:139], v82 offset:5760
    v_exp_f32 v165, v165
    v_cvt_pk_bf16_f32 v160, v160, v161
    v_exp_f32 v166, v166
    v_cvt_pk_bf16_f32 v161, v162, v163
    v_mfma_f32_32x32x16_bf16 v[12:27], v[140:143], v[156:159], v[12:27]
    ds_read_b64_tr_b16 v[140:141], v84 offset:12288
    ds_read_b64_tr_b16 v[142:143], v84 offset:13312
    v_exp_f32 v167, v167
    v_cvt_pk_bf16_f32 v162, v164, v165
    v_exp_f32 v168, v168
    v_mfma_f32_32x32x8_bf16 v[176:191], v[116:117], v[106:107], v[176:191]
    ds_read_b128 v[152:155], v83 offset:8192
    v_cvt_pk_bf16_f32 v163, v166, v167
    v_exp_f32 v169, v169
    v_exp_f32 v170, v170
    v_mfma_f32_32x32x16_bf16 v[192:207], v[124:127], v[160:163], v[192:207]
    v_exp_f32 v171, v171
    v_exp_f32 v172, v172
    v_exp_f32 v173, v173
    v_mfma_f32_32x32x16_bf16 v[28:43], v[144:147], v[156:159], v[28:43]
    ds_read_b64_tr_b16 v[144:145], v85 offset:12288
    ds_read_b64_tr_b16 v[146:147], v85 offset:13312
    v_cvt_pk_bf16_f32 v168, v168, v169
    v_exp_f32 v174, v174
    v_cvt_pk_bf16_f32 v169, v170, v171
    v_exp_f32 v175, v175
    v_mfma_f32_32x32x16_bf16 v[44:59], v[148:151], v[156:159], v[44:59]
    ds_read_b64_tr_b16 v[148:149], v84 offset:16384
    ds_read_b64_tr_b16 v[150:151], v84 offset:17408
    v_cvt_pk_bf16_f32 v170, v172, v173
    v_cvt_pk_bf16_f32 v171, v174, v175
    v_exp_f32 v176, v176
    v_exp_f32 v177, v177
    v_mfma_f32_32x32x16_bf16 v[192:207], v[128:131], v[168:171], v[192:207]
    v_exp_f32 v178, v178
    v_exp_f32 v179, v179
    v_exp_f32 v180, v180
    s_waitcnt lgkmcnt(4)
    v_mfma_f32_32x32x16_bf16 v[160:175], v[118:121], v[96:99], 0
    v_exp_f32 v181, v181
    v_cvt_pk_bf16_f32 v176, v176, v177
    v_exp_f32 v182, v182
    v_cvt_pk_bf16_f32 v177, v178, v179
    v_mfma_f32_32x32x16_bf16 v[12:27], v[140:143], v[152:155], v[12:27]
    ds_read_b64_tr_b16 v[140:141], v84 offset:14336
    ds_read_b64_tr_b16 v[142:143], v84 offset:15360
    v_exp_f32 v183, v183
    v_cvt_pk_bf16_f32 v178, v180, v181
    v_exp_f32 v184, v184
    v_mfma_f32_32x32x8_bf16 v[160:175], v[122:123], v[100:101], v[160:175]
    ds_read_b128 v[156:159], v83 offset:9216
    v_cvt_pk_bf16_f32 v179, v182, v183
    v_exp_f32 v185, v185
    v_exp_f32 v186, v186
    v_mfma_f32_32x32x16_bf16 v[208:223], v[124:127], v[176:179], v[208:223]
    v_exp_f32 v187, v187
    v_exp_f32 v188, v188
    v_exp_f32 v189, v189
    s_waitcnt lgkmcnt(3)
    v_mfma_f32_32x32x16_bf16 v[28:43], v[144:147], v[152:155], v[28:43]
    ds_read_b64_tr_b16 v[144:145], v85 offset:14336
    ds_read_b64_tr_b16 v[146:147], v85 offset:15360
    v_cvt_pk_bf16_f32 v184, v184, v185
    v_exp_f32 v190, v190
    v_cvt_pk_bf16_f32 v185, v186, v187
    v_exp_f32 v191, v191
    v_mfma_f32_32x32x16_bf16 v[44:59], v[148:151], v[152:155], v[44:59]
    ds_read_b64_tr_b16 v[148:149], v84 offset:18432
    ds_read_b64_tr_b16 v[150:151], v84 offset:19456
    v_cvt_pk_bf16_f32 v186, v188, v189
    v_cvt_pk_bf16_f32 v187, v190, v191
    v_exp_f32 v160, v160
    v_exp_f32 v161, v161
    s_add_u32 s20, s20, 1
    s_cmp_eq_u32 s20, s23
L_h1_g1:
    s_cbranch_scc1 L_h1_t1
    v_mfma_f32_32x32x16_bf16 v[208:223], v[128:131], v[184:187], v[208:223]
    v_exp_f32 v162, v162
    v_exp_f32 v163, v163
    v_exp_f32 v164, v164
    s_waitcnt vmcnt(63) lgkmcnt(0)
    s_barrier
    v_mfma_f32_32x32x16_bf16 v[176:191], v[118:121], v[102:105], 0
    ds_read_b128 v[112:115], v80 offset:10240
    ds_read_b64 v[116:117], v81 offset:10240
    ds_read_b128 v[124:127], v82 offset:10240
    ds_read_b128 v[128:131], v82 offset:10880
    v_exp_f32 v165, v165
    v_cvt_pk_bf16_f32 v160, v160, v161
    v_exp_f32 v166, v166
    v_cvt_pk_bf16_f32 v161, v162, v163
    v_mfma_f32_32x32x16_bf16 v[12:27], v[140:143], v[156:159], v[12:27]
    ds_read_b64_tr_b16 v[140:141], v84 offset:24576
    ds_read_b64_tr_b16 v[142:143], v84 offset:25600
    v_exp_f32 v167, v167
    v_cvt_pk_bf16_f32 v162, v164, v165
    v_exp_f32 v168, v168
    v_mfma_f32_32x32x8_bf16 v[176:191], v[122:123], v[106:107], v[176:191]
    ds_read_b128 v[152:155], v83 offset:16384
    v_cvt_pk_bf16_f32 v163, v166, v167
    v_exp_f32 v169, v169
    v_exp_f32 v170, v170
    v_mfma_f32_32x32x16_bf16 v[192:207], v[132:135], v[160:163], v[192:207]
    v_exp_f32 v171, v171
    v_exp_f32 v172, v172
    v_exp_f32 v173, v173
    v_mfma_f32_32x32x16_bf16 v[28:43], v[144:147], v[156:159], v[28:43]
    ds_read_b64_tr_b16 v[144:145], v85 offset:24576
    ds_read_b64_tr_b16 v[146:147], v85 offset:25600
    v_cvt_pk_bf16_f32 v168, v168, v169
    v_exp_f32 v174, v174
    v_cvt_pk_bf16_f32 v169, v170, v171
    v_exp_f32 v175, v175
    v_mfma_f32_32x32x16_bf16 v[44:59], v[148:151], v[156:159], v[44:59]
    ds_read_b64_tr_b16 v[148:149], v84 offset:28672
    ds_read_b64_tr_b16 v[150:151], v84 offset:29696
    v_cvt_pk_bf16_f32 v170, v172, v173
    v_cvt_pk_bf16_f32 v171, v174, v175
    v_exp_f32 v176, v176
    v_exp_f32 v177, v177
    v_mfma_f32_32x32x16_bf16 v[192:207], v[136:139], v[168:171], v[192:207]
    v_exp_f32 v178, v178
    v_exp_f32 v179, v179
    v_exp_f32 v180, v180
    s_waitcnt lgkmcnt(4)
    v_mfma_f32_32x32x16_bf16 v[160:175], v[112:115], v[96:99], 0
    v_exp_f32 v181, v181
    v_cvt_pk_bf16_f32 v176, v176, v177
    v_exp_f32 v182, v182
    v_cvt_pk_bf16_f32 v177, v178, v179
    v_mfma_f32_32x32x16_bf16 v[12:27], v[140:143], v[152:155], v[12:27]
    ds_read_b64_tr_b16 v[140:141], v84 offset:26624
    ds_read_b64_tr_b16 v[142:143], v84 offset:27648
    v_exp_f32 v183, v183
    v_cvt_pk_bf16_f32 v178, v180, v181
    v_exp_f32 v184, v184
    v_mfma_f32_32x32x8_bf16 v[160:175], v[116:117], v[100:101], v[160:175]
    ds_read_b128 v[156:159], v83 offset:17408
    v_cvt_pk_bf16_f32 v179, v182, v183
    v_exp_f32 v185, v185
    v_exp_f32 v186, v186
    v_mfma_f32_32x32x16_bf16 v[208:223], v[132:135], v[176:179], v[208:223]
    v_exp_f32 v187, v187
    v_exp_f32 v188, v188
    v_exp_f32 v189, v189
    s_waitcnt lgkmcnt(3)
    v_mfma_f32_32x32x16_bf16 v[28:43], v[144:147], v[152:155], v[28:43]
    ds_read_b64_tr_b16 v[144:145], v85 offset:26624
    ds_read_b64_tr_b16 v[146:147], v85 offset:27648
    v_cvt_pk_bf16_f32 v184, v184, v185
    v_exp_f32 v190, v190
    v_cvt_pk_bf16_f32 v185, v186, v187
    v_exp_f32 v191, v191
    v_mfma_f32_32x32x16_bf16 v[44:59], v[148:151], v[152:155], v[44:59]
    ds_read_b64_tr_b16 v[148:149], v84 offset:30720
    ds_read_b64_tr_b16 v[150:151], v84 offset:31744
    v_cvt_pk_bf16_f32 v186, v188, v189
    v_cvt_pk_bf16_f32 v187, v190, v191
    v_exp_f32 v160, v160
    v_exp_f32 v161, v161
    s_add_u32 s20, s20, 1
    s_cmp_eq_u32 s20, s23
L_h1_g2:
    s_cbranch_scc1 L_h1_t2
L_h1_g2x:
    v_mfma_f32_32x32x16_bf16 v[208:223], v[136:139], v[184:187], v[208:223]
    v_exp_f32 v162, v162
    v_exp_f32 v163, v163
    v_exp_f32 v164, v164
    s_waitcnt vmcnt(63) lgkmcnt(0)
    s_barrier
    v_mfma_f32_32x32x16_bf16 v[176:191], v[112:115], v[102:105], 0
    ds_read_b128 v[118:121], v80 offset:15360
    ds_read_b64 v[122:123], v81 offset:15360
    ds_read_b128 v[132:135], v82 offset:15360
    ds_read_b128 v[136:139], v82 offset:16000
    v_exp_f32 v165, v165
    v_cvt_pk_bf16_f32 v160, v160, v161
    v_exp_f32 v166, v166
    v_cvt_pk_bf16_f32 v161, v162, v163
    v_mfma_f32_32x32x16_bf16 v[12:27], v[140:143], v[156:159], v[12:27]
    ds_read_b64_tr_b16 v[140:141], v84 offset:36864
    ds_read_b64_tr_b16 v[142:143], v84 offset:37888
    v_exp_f32 v167, v167
    v_cvt_pk_bf16_f32 v162, v164, v165
    v_exp_f32 v168, v168
    v_mfma_f32_32x32x8_bf16 v[176:191], v[116:117], v[106:107], v[176:191]
    ds_read_b128 v[152:155], v83 offset:24576
    v_cvt_pk_bf16_f32 v163, v166, v167
    v_exp_f32 v169, v169
    v_exp_f32 v170, v170
    v_mfma_f32_32x32x16_bf16 v[192:207], v[124:127], v[160:163], v[192:207]
    v_exp_f32 v171, v171
    v_exp_f32 v172, v172
    v_exp_f32 v173, v173
    v_mfma_f32_32x32x16_bf16 v[28:43], v[144:147], v[156:159], v[28:43]
    ds_read_b64_tr_b16 v[144:145], v85 offset:36864
    ds_read_b64_tr_b16 v[146:147], v85 offset:37888
    v_cvt_pk_bf16_f32 v168, v168, v169
    v_exp_f32 v174, v174
    v_cvt_pk_bf16_f32 v169, v170, v171
    v_exp_f32 v175, v175
    v_mfma_f32_32x32x16_bf16 v[44:59], v[148:151], v[156:159], v[44:59]
    ds_read_b64_tr_b16 v[148:149], v84 offset:40960
    ds_read_b64_tr_b16 v[150:151], v84 offset:41984
    v_cvt_pk_bf16_f32 v170, v172, v173
    v_cvt_pk_bf16_f32 v171, v174, v175
    v_exp_f32 v176, v176
    v_exp_f32 v177, v177
    v_mfma_f32_32x32x16_bf16 v[192:207], v[128:131], v[168:171], v[192:207]
    v_exp_f32 v178, v178
    v_exp_f32 v179, v179
    v_exp_f32 v180, v180
    s_waitcnt lgkmcnt(4)
    v_mfma_f32_32x32x16_bf16 v[160:175], v[118:121], v[96:99], 0
    v_exp_f32 v181, v181
    v_cvt_pk_bf16_f32 v176, v176, v177
    v_exp_f32 v182, v182
    v_cvt_pk_bf16_f32 v177, v178, v179
    v_mfma_f32_32x32x16_bf16 v[12:27], v[140:143], v[152:155], v[12:27]
    ds_read_b64_tr_b16 v[140:141], v84 offset:38912
    ds_read_b64_tr_b16 v[142:143], v84 offset:39936
    v_exp_f32 v183, v183
    v_cvt_pk_bf16_f32 v178, v180, v181
    v_exp_f32 v184, v184
    v_mfma_f32_32x32x8_bf16 v[160:175], v[122:123], v[100:101], v[160:175]
    ds_read_b128 v[156:159], v83 offset:25600
    v_cvt_pk_bf16_f32 v179, v182, v183
    v_exp_f32 v185, v185
    v_exp_f32 v186, v186
    v_mfma_f32_32x32x16_bf16 v[208:223], v[124:127], v[176:179], v[208:223]
    v_exp_f32 v187, v187
    v_exp_f32 v188, v188
    v_exp_f32 v189, v189
    s_waitcnt lgkmcnt(3)
    v_mfma_f32_32x32x16_bf16 v[28:43], v[144:147], v[152:155], v[28:43]
    ds_read_b64_tr_b16 v[144:145], v85 offset:38912
    ds_read_b64_tr_b16 v[146:147], v85 offset:39936
    v_cvt_pk_bf16_f32 v184, v184, v185
    v_exp_f32 v190, v190
    v_cvt_pk_bf16_f32 v185, v186, v187
    v_exp_f32 v191, v191
    v_mfma_f32_32x32x16_bf16 v[44:59], v[148:151], v[152:155], v[44:59]
    ds_read_b64_tr_b16 v[148:149], v84 offset:43008
    ds_read_b64_tr_b16 v[150:151], v84 offset:44032
    v_cvt_pk_bf16_f32 v186, v188, v189
    v_cvt_pk_bf16_f32 v187, v190, v191
    v_exp_f32 v160, v160
    v_exp_f32 v161, v161
    s_add_u32 s20, s20, 1
L_h1_g3:
    v_mfma_f32_32x32x16_bf16 v[208:223], v[128:131], v[184:187], v[208:223]
    v_exp_f32 v162, v162
    v_exp_f32 v163, v163
    v_exp_f32 v164, v164
    s_waitcnt vmcnt(63) lgkmcnt(0)
    s_barrier
    v_mfma_f32_32x32x16_bf16 v[176:191], v[118:121], v[102:105], 0
    ds_read_b128 v[112:115], v80 offset:0
    ds_read_b64 v[116:117], v81 offset:0
    ds_read_b128 v[124:127], v82 offset:0
    ds_read_b128 v[128:131], v82 offset:640
    v_exp_f32 v165, v165
    v_cvt_pk_bf16_f32 v160, v160, v161
    v_exp_f32 v166, v166
    v_cvt_pk_bf16_f32 v161, v162, v163
    v_mfma_f32_32x32x16_bf16 v[12:27], v[140:143], v[156:159], v[12:27]
    ds_read_b64_tr_b16 v[140:141], v84 offset:0
    ds_read_b64_tr_b16 v[142:143], v84 offset:1024
    v_exp_f32 v167, v167
    v_cvt_pk_bf16_f32 v162, v164, v165
    v_exp_f32 v168, v168
    v_mfma_f32_32x32x8_bf16 v[176:191], v[122:123], v[106:107], v[176:191]
    ds_read_b128 v[152:155], v83 offset:0
    v_cvt_pk_bf16_f32 v163, v166, v167
    v_exp_f32 v169, v169
    v_exp_f32 v170, v170
    v_mfma_f32_32x32x16_bf16 v[192:207], v[132:135], v[160:163], v[192:207]
    v_exp_f32 v171, v171
    v_exp_f32 v172, v172
    v_exp_f32 v173, v173
    v_mfma_f32_32x32x16_bf16 v[28:43], v[144:147], v[156:159], v[28:43]
    ds_read_b64_tr_b16 v[144:145], v85 offset:0
    ds_read_b64_tr_b16 v[146:147], v85 offset:1024
    v_cvt_pk_bf16_f32 v168, v168, v169
    v_exp_f32 v174, v174
    v_cvt_pk_bf16_f32 v169, v170, v171
    v_exp_f32 v175, v175
    v_mfma_f32_32x32x16_bf16 v[44:59], v[148:151], v[156:159], v[44:59]
    ds_read_b64_tr_b16 v[148:149], v84 offset:4096
    ds_read_b64_tr_b16 v[150:151], v84 offset:5120
    v_cvt_pk_bf16_f32 v170, v172, v173
    v_cvt_pk_bf16_f32 v171, v174, v175
    v_exp_f32 v176, v176
    v_exp_f32 v177, v177
    v_mfma_f32_32x32x16_bf16 v[192:207], v[136:139], v[168:171], v[192:207]
    v_exp_f32 v178, v178
    v_exp_f32 v179, v179
    v_exp_f32 v180, v180
    s_waitcnt lgkmcnt(4)
    v_mfma_f32_32x32x16_bf16 v[160:175], v[112:115], v[96:99], 0
    v_exp_f32 v181, v181
    v_cvt_pk_bf16_f32 v176, v176, v177
    v_exp_f32 v182, v182
    v_cvt_pk_bf16_f32 v177, v178, v179
    v_mfma_f32_32x32x16_bf16 v[12:27], v[140:143], v[152:155], v[12:27]
    ds_read_b64_tr_b16 v[140:141], v84 offset:2048
    ds_read_b64_tr_b16 v[142:143], v84 offset:3072
    v_exp_f32 v183, v183
    v_cvt_pk_bf16_f32 v178, v180, v181
    v_exp_f32 v184, v184
    v_mfma_f32_32x32x8_bf16 v[160:175], v[116:117], v[100:101], v[160:175]
    ds_read_b128 v[156:159], v83 offset:1024
    v_cvt_pk_bf16_f32 v179, v182, v183
    v_exp_f32 v185, v185
    v_exp_f32 v186, v186
    v_mfma_f32_32x32x16_bf16 v[208:223], v[132:135], v[176:179], v[208:223]
    v_exp_f32 v187, v187
    v_exp_f32 v188, v188
    v_exp_f32 v189, v189
    s_waitcnt lgkmcnt(3)
    v_mfma_f32_32x32x16_bf16 v[28:43], v[144:147], v[152:155], v[28:43]
    ds_read_b64_tr_b16 v[144:145], v85 offset:2048
    ds_read_b64_tr_b16 v[146:147], v85 offset:3072
    v_cvt_pk_bf16_f32 v184, v184, v185
    v_exp_f32 v190, v190
    v_cvt_pk_bf16_f32 v185, v186, v187
    v_exp_f32 v191, v191
    v_mfma_f32_32x32x16_bf16 v[44:59], v[148:151], v[152:155], v[44:59]
    ds_read_b64_tr_b16 v[148:149], v84 offset:6144
    ds_read_b64_tr_b16 v[150:151], v84 offset:7168
    v_cvt_pk_bf16_f32 v186, v188, v189
    v_cvt_pk_bf16_f32 v187, v190, v191
    v_exp_f32 v160, v160
    v_exp_f32 v161, v161
    s_add_u32 s20, s20, 1
    s_branch L_h1_g0
L_h1_n0:
    v_mfma_f32_32x32x16_bf16 v[208:223], v[136:139], v[184:187], v[208:223]
    v_exp_f32 v162, v162
    v_exp_f32 v163, v163
    v_exp_f32 v164, v164
    s_waitcnt vmcnt(63) lgkmcnt(0)
    s_barrier
    v_mfma_f32_32x32x16_bf16 v[176:191], v[112:115], v[102:105], 0
    ds_read_b128 v[118:121], v80 offset:5120
    ds_read_b64 v[122:123], v81 offset:5120
    ds_read_b128 v[132:135], v82 offset:5120
    ds_read_b128 v[136:139], v82 offset:5760
    v_exp_f32 v165, v165
    v_cvt_pk_bf16_f32 v160, v160, v161
    v_exp_f32 v166, v166
    v_cvt_pk_bf16_f32 v161, v162, v163
    v_exp_f32 v167, v167
    v_cvt_pk_bf16_f32 v162, v164, v165
    v_exp_f32 v168, v168
    v_mfma_f32_32x32x8_bf16 v[176:191], v[116:117], v[106:107], v[176:191]
    v_cvt_pk_bf16_f32 v163, v166, v167
    v_exp_f32 v169, v169
    v_exp_f32 v170, v170
    v_mfma_f32_32x32x16_bf16 v[192:207], v[124:127], v[160:163], v[192:207]
    v_exp_f32 v171, v171
    v_exp_f32 v172, v172
    v_exp_f32 v173, v173
    v_cvt_pk_bf16_f32 v168, v168, v169
    v_exp_f32 v174, v174
    v_cvt_pk_bf16_f32 v169, v170, v171
    v_exp_f32 v175, v175
    v_cvt_pk_bf16_f32 v170, v172, v173
    v_cvt_pk_bf16_f32 v171, v174, v175
    v_exp_f32 v176, v176
    v_exp_f32 v177, v177
    v_mfma_f32_32x32x16_bf16 v[192:207], v[128:131], v[168:171], v[192:207]
    v_exp_f32 v178, v178
    v_exp_f32 v179, v179
    v_exp_f32 v180, v180
    s_waitcnt lgkmcnt(0)
    v_mfma_f32_32x32x16_bf16 v[160:175], v[118:121], v[96:99], 0
    v_exp_f32 v181, v181
    v_cvt_pk_bf16_f32 v176, v176, v177
    v_exp_f32 v182, v182
    v_cvt_pk_bf16_f32 v177, v178, v179
    v_exp_f32 v183, v183
    v_cvt_pk_bf16_f32 v178, v180, v181
    v_exp_f32 v184, v184
    v_mfma_f32_32x32x8_bf16 v[160:175], v[122:123], v[100:101], v[160:175]
    v_cvt_pk_bf16_f32 v179, v182, v183
    v_exp_f32 v185, v185
    v_exp_f32 v186, v186
    v_mfma_f32_32x32x16_bf16 v[208:223], v[124:127], v[176:179], v[208:223]
    v_exp_f32 v187, v187
    v_exp_f32 v188, v188
    v_exp_f32 v189, v189
    v_cvt_pk_bf16_f32 v184, v184, v185
    v_exp_f32 v190, v190
    v_cvt_pk_bf16_f32 v185, v186, v187
    v_exp_f32 v191, v191
    v_cvt_pk_bf16_f32 v186, v188, v189
    v_cvt_pk_bf16_f32 v187, v190, v191
    v_exp_f32 v160, v160
    v_exp_f32 v161, v161
    s_add_u32 s20, s20, 1
L_h1_n1:
    v_mfma_f32_32x32x16_bf16 v[208:223], v[128:131], v[184:187], v[208:223]
    v_exp_f32 v162, v162
    v_exp_f32 v163, v163
    v_exp_f32 v164, v164
    s_waitcnt vmcnt(63) lgkmcnt(0)
    s_barrier
    v_mfma_f32_32x32x16_bf16 v[176:191], v[118:121], v[102:105], 0
    ds_read_b128 v[112:115], v80 offset:10240
    ds_read_b64 v[116:117], v81 offset:10240
    ds_read_b128 v[124:127], v82 offset:10240
    ds_read_b128 v[128:131], v82 offset:10880
    v_exp_f32 v165, v165
    v_cvt_pk_bf16_f32 v160, v160, v161
    v_exp_f32 v166, v166
    v_cvt_pk_bf16_f32 v161, v162, v163
    v_exp_f32 v167, v167
    v_cvt_pk_bf16_f32 v162, v164, v165
    v_exp_f32 v168, v168
    v_mfma_f32_32x32x8_bf16 v[176:191], v[122:123], v[106:107], v[176:191]
    v_cvt_pk_bf16_f32 v163, v166, v167
    v_exp_f32 v169, v169
    v_exp_f32 v170, v170
    v_mfma_f32_32x32x16_bf16 v[192:207], v[132:135], v[160:163], v[192:207]
    v_exp_f32 v171, v171
    v_exp_f32 v172, v172
    v_exp_f32 v173, v173
    v_cvt_pk_bf16_f32 v168, v168, v169
    v_exp_f32 v174, v174
    v_cvt_pk_bf16_f32 v169, v170, v171
    v_exp_f32 v175, v175
    v_cvt_pk_bf16_f32 v170, v172, v173
    v_cvt_pk_bf16_f32 v171, v174, v175
    v_exp_f32 v176, v176
    v_exp_f32 v177, v177
    v_mfma_f32_32x32x16_bf16 v[192:207], v[136:139], v[168:171], v[192:207]
    v_exp_f32 v178, v178
    v_exp_f32 v179, v179
    v_exp_f32 v180, v180
    s_waitcnt lgkmcnt(0)
    v_mfma_f32_32x32x16_bf16 v[160:175], v[112:115], v[96:99], 0
    v_exp_f32 v181, v181
    v_cvt_pk_bf16_f32 v176, v176, v177
    v_exp_f32 v182, v182
    v_cvt_pk_bf16_f32 v177, v178, v179
    v_exp_f32 v183, v183
    v_cvt_pk_bf16_f32 v178, v180, v181
    v_exp_f32 v184, v184
    v_mfma_f32_32x32x8_bf16 v[160:175], v[116:117], v[100:101], v[160:175]
    v_cvt_pk_bf16_f32 v179, v182, v183
    v_exp_f32 v185, v185
    v_exp_f32 v186, v186
    v_mfma_f32_32x32x16_bf16 v[208:223], v[132:135], v[176:179], v[208:223]
    v_exp_f32 v187, v187
    v_exp_f32 v188, v188
    v_exp_f32 v189, v189
    v_cvt_pk_bf16_f32 v184, v184, v185
    v_exp_f32 v190, v190
    v_cvt_pk_bf16_f32 v185, v186, v187
    v_exp_f32 v191, v191
    v_cvt_pk_bf16_f32 v186, v188, v189
    v_cvt_pk_bf16_f32 v187, v190, v191
    v_exp_f32 v160, v160
    v_exp_f32 v161, v161
    s_add_u32 s20, s20, 1
L_h1_n2:
    v_mfma_f32_32x32x16_bf16 v[208:223], v[136:139], v[184:187], v[208:223]
    v_exp_f32 v162, v162
    v_exp_f32 v163, v163
    v_exp_f32 v164, v164
    s_waitcnt vmcnt(63) lgkmcnt(0)
    s_barrier
    v_mfma_f32_32x32x16_bf16 v[176:191], v[112:115], v[102:105], 0
    ds_read_b128 v[118:121], v80 offset:15360
    ds_read_b64 v[122:123], v81 offset:15360
    ds_read_b128 v[132:135], v82 offset:15360
    ds_read_b128 v[136:139], v82 offset:16000
    v_exp_f32 v165, v165
    v_cvt_pk_bf16_f32 v160, v160, v161
    v_exp_f32 v166, v166
    v_cvt_pk_bf16_f32 v161, v162, v163
    v_exp_f32 v167, v167
    v_cvt_pk_bf16_f32 v162, v164, v165
    v_exp_f32 v168, v168
    v_mfma_f32_32x32x8_bf16 v[176:191], v[116:117], v[106:107], v[176:191]
    v_cvt_pk_bf16_f32 v163, v166, v167
    v_exp_f32 v169, v169
    v_exp_f32 v170, v170
    v_mfma_f32_32x32x16_bf16 v[192:207], v[124:127], v[160:163], v[192:207]
    v_exp_f32 v171, v171
    v_exp_f32 v172, v172
    v_exp_f32 v173, v173
    v_cvt_pk_bf16_f32 v168, v168, v169
    v_exp_f32 v174, v174
    v_cvt_pk_bf16_f32 v169, v170, v171
    v_exp_f32 v175, v175
    v_cvt_pk_bf16_f32 v170, v172, v173
    v_cvt_pk_bf16_f32 v171, v174, v175
    v_exp_f32 v176, v176
    v_exp_f32 v177, v177
    v_mfma_f32_32x32x16_bf16 v[192:207], v[128:131], v[168:171], v[192:207]
    v_exp_f32 v178, v178
    v_exp_f32 v179, v179
    v_exp_f32 v180, v180
    s_waitcnt lgkmcnt(0)
    v_mfma_f32_32x32x16_bf16 v[160:175], v[118:121], v[96:99], 0
    v_exp_f32 v181, v181
    v_cvt_pk_bf16_f32 v176, v176, v177
    v_exp_f32 v182, v182
    v_cvt_pk_bf16_f32 v177, v178, v179
    v_exp_f32 v183, v183
    v_cvt_pk_bf16_f32 v178, v180, v181
    v_exp_f32 v184, v184
    v_mfma_f32_32x32x8_bf16 v[160:175], v[122:123], v[100:101], v[160:175]
    v_cvt_pk_bf16_f32 v179, v182, v183
    v_exp_f32 v185, v185
    v_exp_f32 v186, v186
    v_mfma_f32_32x32x16_bf16 v[208:223], v[124:127], v[176:179], v[208:223]
    v_exp_f32 v187, v187
    v_exp_f32 v188, v188
    v_exp_f32 v189, v189
    v_cvt_pk_bf16_f32 v184, v184, v185
    v_exp_f32 v190, v190
    v_cvt_pk_bf16_f32 v185, v186, v187
    v_exp_f32 v191, v191
    v_cvt_pk_bf16_f32 v186, v188, v189
    v_cvt_pk_bf16_f32 v187, v190, v191
    v_exp_f32 v160, v160
    v_exp_f32 v161, v161
    s_add_u32 s20, s20, 1
L_h1_n3:
    v_mfma_f32_32x32x16_bf16 v[208:223], v[128:131], v[184:187], v[208:223]
    v_exp_f32 v162, v162
    v_exp_f32 v163, v163
    v_exp_f32 v164, v164
    s_waitcnt vmcnt(63) lgkmcnt(0)
    s_barrier
    v_mfma_f32_32x32x16_bf16 v[176:191], v[118:121], v[102:105], 0
    ds_read_b128 v[112:115], v80 offset:0
    ds_read_b64 v[116:117], v81 offset:0
    ds_read_b128 v[124:127], v82 offset:0
    ds_read_b128 v[128:131], v82 offset:640
    v_exp_f32 v165, v165
    v_cvt_pk_bf16_f32 v160, v160, v161
    v_exp_f32 v166, v166
    v_cvt_pk_bf16_f32 v161, v162, v163
    v_exp_f32 v167, v167
    v_cvt_pk_bf16_f32 v162, v164, v165
    v_exp_f32 v168, v168
    v_mfma_f32_32x32x8_bf16 v[176:191], v[122:123], v[106:107], v[176:191]
    v_cvt_pk_bf16_f32 v163, v166, v167
    v_exp_f32 v169, v169
    v_exp_f32 v170, v170
    v_mfma_f32_32x32x16_bf16 v[192:207], v[132:135], v[160:163], v[192:207]
    v_exp_f32 v171, v171
    v_exp_f32 v172, v172
    v_exp_f32 v173, v173
    v_cvt_pk_bf16_f32 v168, v168, v169
    v_exp_f32 v174, v174
    v_cvt_pk_bf16_f32 v169, v170, v171
    v_exp_f32 v175, v175
    v_cvt_pk_bf16_f32 v170, v172, v173
    v_cvt_pk_bf16_f32 v171, v174, v175
    v_exp_f32 v176, v176
    v_exp_f32 v177, v177
    v_mfma_f32_32x32x16_bf16 v[192:207], v[136:139], v[168:171], v[192:207]
    v_exp_f32 v178, v178
    v_exp_f32 v179, v179
    v_exp_f32 v180, v180
    s_waitcnt lgkmcnt(0)
    v_mfma_f32_32x32x16_bf16 v[160:175], v[112:115], v[96:99], 0
    v_exp_f32 v181, v181
    v_cvt_pk_bf16_f32 v176, v176, v177
    v_exp_f32 v182, v182
    v_cvt_pk_bf16_f32 v177, v178, v179
    v_exp_f32 v183, v183
    v_cvt_pk_bf16_f32 v178, v180, v181
    v_exp_f32 v184, v184
    v_mfma_f32_32x32x8_bf16 v[160:175], v[116:117], v[100:101], v[160:175]
    v_cvt_pk_bf16_f32 v179, v182, v183
    v_exp_f32 v185, v185
    v_exp_f32 v186, v186
    v_mfma_f32_32x32x16_bf16 v[208:223], v[132:135], v[176:179], v[208:223]
    v_exp_f32 v187, v187
    v_exp_f32 v188, v188
    v_exp_f32 v189, v189
    v_cvt_pk_bf16_f32 v184, v184, v185
    v_exp_f32 v190, v190
    v_cvt_pk_bf16_f32 v185, v186, v187
    v_exp_f32 v191, v191
    v_cvt_pk_bf16_f32 v186, v188, v189
    v_cvt_pk_bf16_f32 v187, v190, v191
    v_exp_f32 v160, v160
    v_exp_f32 v161, v161
    s_add_u32 s20, s20, 1
    s_cmp_lt_u32 s20, 32
    s_cbranch_scc1 L_h1_n0
    s_branch L_p2_fin
L_h1_t1:
    v_mfma_f32_32x32x16_bf16 v[208:223], v[128:131], v[184:187], v[208:223]
    v_exp_f32 v162, v162
    v_exp_f32 v163, v163
    v_exp_f32 v164, v164
    s_waitcnt vmcnt(63) lgkmcnt(0)
    s_barrier
    v_mfma_f32_32x32x16_bf16 v[176:191], v[118:121], v[102:105], 0
    ds_read_b128 v[112:115], v80 offset:10240
    ds_read_b64 v[116:117], v81 offset:10240
    ds_read_b128 v[124:127], v82 offset:10240
    ds_read_b128 v[128:131], v82 offset:10880
    v_exp_f32 v165, v165
    v_cvt_pk_bf16_f32 v160, v160, v161
    v_exp_f32 v166, v166
    v_cvt_pk_bf16_f32 v161, v162, v163
    v_mfma_f32_32x32x16_bf16 v[12:27], v[140:143], v[156:159], v[12:27]
    v_exp_f32 v167, v167
    v_cvt_pk_bf16_f32 v162, v164, v165
    v_exp_f32 v168, v168
    v_mfma_f32_32x32x8_bf16 v[176:191], v[122:123], v[106:107], v[176:191]
    v_cvt_pk_bf16_f32 v163, v166, v167
    v_exp_f32 v169, v169
    v_exp_f32 v170, v170
    v_mfma_f32_32x32x16_bf16 v[192:207], v[132:135], v[160:163], v[192:207]
    v_exp_f32 v171, v171
    v_exp_f32 v172, v172
    v_exp_f32 v173, v173
    v_mfma_f32_32x32x16_bf16 v[28:43], v[144:147], v[156:159], v[28:43]
    v_cvt_pk_bf16_f32 v168, v168, v169
    v_exp_f32 v174, v174
    v_cvt_pk_bf16_f32 v169, v170, v171
    v_exp_f32 v175, v175
    v_mfma_f32_32x32x16_bf16 v[44:59], v[148:151], v[156:159], v[44:59]
    v_cvt_pk_bf16_f32 v170, v172, v173
    v_cvt_pk_bf16_f32 v171, v174, v175
    v_exp_f32 v176, v176
    v_exp_f32 v177, v177
    v_mfma_f32_32x32x16_bf16 v[192:207], v[136:139], v[168:171], v[192:207]
    v_cvt_pk_bf16_f32 v12, v12, v13
    v_cvt_pk_bf16_f32 v13, v14, v15
    v_cvt_pk_bf16_f32 v14, v16, v17
    v_cvt_pk_bf16_f32 v15, v18, v19
    buffer_store_dwordx4 v[12:15], v0, s[24:27], s75 offen offset:0 sc1
    v_exp_f32 v178, v178
    v_exp_f32 v179, v179
    v_exp_f32 v180, v180
    s_waitcnt lgkmcnt(0)
    v_mfma_f32_32x32x16_bf16 v[160:175], v[112:115], v[96:99], 0
    v_cvt_pk_bf16_f32 v16, v20, v21
    v_cvt_pk_bf16_f32 v17, v22, v23
    v_cvt_pk_bf16_f32 v18, v24, v25
    v_cvt_pk_bf16_f32 v19, v26, v27
    buffer_store_dwordx4 v[16:19], v0, s[24:27], s75 offen offset:1024 sc1
    v_exp_f32 v181, v181
    v_cvt_pk_bf16_f32 v176, v176, v177
    v_exp_f32 v182, v182
    v_cvt_pk_bf16_f32 v177, v178, v179
    v_cvt_pk_bf16_f32 v28, v28, v29
    v_cvt_pk_bf16_f32 v29, v30, v31
    v_cvt_pk_bf16_f32 v30, v32, v33
    v_cvt_pk_bf16_f32 v31, v34, v35
    buffer_store_dwordx4 v[28:31], v0, s[24:27], s75 offen offset:2048 sc1
    v_exp_f32 v183, v183
    v_cvt_pk_bf16_f32 v178, v180, v181
    v_exp_f32 v184, v184
    v_mfma_f32_32x32x8_bf16 v[160:175], v[116:117], v[100:101], v[160:175]
    v_cvt_pk_bf16_f32 v32, v36, v37
    v_cvt_pk_bf16_f32 v33, v38, v39
    v_cvt_pk_bf16_f32 v34, v40, v41
    v_cvt_pk_bf16_f32 v35, v42, v43
    buffer_store_dwordx4 v[32:35], v0, s[24:27], s75 offen offset:3072 sc1
    v_cvt_pk_bf16_f32 v179, v182, v183
    v_exp_f32 v185, v185
    v_exp_f32 v186, v186
    v_mfma_f32_32x32x16_bf16 v[208:223], v[132:135], v[176:179], v[208:223]
    v_cvt_pk_bf16_f32 v44, v44, v45
    v_cvt_pk_bf16_f32 v45, v46, v47
    v_cvt_pk_bf16_f32 v46, v48, v49
    v_cvt_pk_bf16_f32 v47, v50, v51
    s_add_u32 s75, s75, 4096
    buffer_store_dwordx4 v[44:47], v0, s[24:27], s75 offen offset:0 sc1
    v_exp_f32 v187, v187
    v_exp_f32 v188, v188
    v_exp_f32 v189, v189
    v_cvt_pk_bf16_f32 v48, v52, v53
    v_cvt_pk_bf16_f32 v49, v54, v55
    v_cvt_pk_bf16_f32 v50, v56, v57
    v_cvt_pk_bf16_f32 v51, v58, v59
    buffer_store_dwordx4 v[48:51], v0, s[24:27], s75 offen offset:1024 sc1
    v_cvt_pk_bf16_f32 v184, v184, v185
    v_exp_f32 v190, v190
    v_cvt_pk_bf16_f32 v185, v186, v187
    v_exp_f32 v191, v191
    v_cvt_pk_bf16_f32 v186, v188, v189
    v_cvt_pk_bf16_f32 v187, v190, v191
    v_exp_f32 v160, v160
    v_exp_f32 v161, v161
    v_mfma_f32_32x32x16_bf16 v[208:223], v[136:139], v[184:187], v[208:223]
    v_exp_f32 v162, v162
    v_exp_f32 v163, v163
    v_exp_f32 v164, v164
    s_waitcnt vmcnt(63) lgkmcnt(0)
    s_barrier
    v_mfma_f32_32x32x16_bf16 v[176:191], v[112:115], v[102:105], 0
    ds_read_b128 v[118:121], v80 offset:15360
    ds_read_b64 v[122:123], v81 offset:15360
    ds_read_b128 v[132:135], v82 offset:15360
    ds_read_b128 v[136:139], v82 offset:16000
    v_exp_f32 v165, v165
    v_cvt_pk_bf16_f32 v160, v160, v161
    v_exp_f32 v166, v166
    v_cvt_pk_bf16_f32 v161, v162, v163
    v_exp_f32 v167, v167
    v_cvt_pk_bf16_f32 v162, v164, v165
    v_exp_f32 v168, v168
    v_mfma_f32_32x32x8_bf16 v[176:191], v[116:117], v[106:107], v[176:191]
    v_cvt_pk_bf16_f32 v163, v166, v167
    v_exp_f32 v169, v169
    v_exp_f32 v170, v170
    v_mfma_f32_32x32x16_bf16 v[192:207], v[124:127], v[160:163], v[192:207]
    v_exp_f32 v171, v171
    v_exp_f32 v172, v172
    v_exp_f32 v173, v173
    v_cvt_pk_bf16_f32 v168, v168, v169
    v_exp_f32 v174, v174
    v_cvt_pk_bf16_f32 v169, v170, v171
    v_exp_f32 v175, v175
    v_cvt_pk_bf16_f32 v170, v172, v173
    v_cvt_pk_bf16_f32 v171, v174, v175
    v_exp_f32 v176, v176
    v_exp_f32 v177, v177
    v_mfma_f32_32x32x16_bf16 v[192:207], v[128:131], v[168:171], v[192:207]
    v_exp_f32 v178, v178
    v_exp_f32 v179, v179
    v_exp_f32 v180, v180
    s_waitcnt lgkmcnt(0)
    v_mfma_f32_32x32x16_bf16 v[160:175], v[118:121], v[96:99], 0
    v_exp_f32 v181, v181
    v_cvt_pk_bf16_f32 v176, v176, v177
    v_exp_f32 v182, v182
    v_cvt_pk_bf16_f32 v177, v178, v179
    v_exp_f32 v183, v183
    v_cvt_pk_bf16_f32 v178, v180, v181
    v_exp_f32 v184, v184
    v_mfma_f32_32x32x8_bf16 v[160:175], v[122:123], v[100:101], v[160:175]
    v_cvt_pk_bf16_f32 v179, v182, v183
    v_exp_f32 v185, v185
    v_exp_f32 v186, v186
    v_mfma_f32_32x32x16_bf16 v[208:223], v[124:127], v[176:179], v[208:223]
    v_exp_f32 v187, v187
    v_exp_f32 v188, v188
    v_exp_f32 v189, v189
    v_cvt_pk_bf16_f32 v184, v184, v185
    v_exp_f32 v190, v190
    v_cvt_pk_bf16_f32 v185, v186, v187
    v_exp_f32 v191, v191
    v_cvt_pk_bf16_f32 v186, v188, v189
    v_cvt_pk_bf16_f32 v187, v190, v191
    v_exp_f32 v160, v160
    v_exp_f32 v161, v161
    s_branch L_h1_e3
L_h1_t2:
    v_mfma_f32_32x32x16_bf16 v[208:223], v[136:139], v[184:187], v[208:223]
    v_exp_f32 v162, v162
    v_exp_f32 v163, v163
    v_exp_f32 v164, v164
    s_waitcnt vmcnt(63) lgkmcnt(0)
    s_barrier
    v_mfma_f32_32x32x16_bf16 v[176:191], v[112:115], v[102:105], 0
    ds_read_b128 v[118:121], v80 offset:15360
    ds_read_b64 v[122:123], v81 offset:15360
    ds_read_b128 v[132:135], v82 offset:15360
    ds_read_b128 v[136:139], v82 offset:16000
    v_exp_f32 v165, v165
    v_cvt_pk_bf16_f32 v160, v160, v161
    v_exp_f32 v166, v166
    v_cvt_pk_bf16_f32 v161, v162, v163
    v_mfma_f32_32x32x16_bf16 v[12:27], v[140:143], v[156:159], v[12:27]
    v_exp_f32 v167, v167
    v_cvt_pk_bf16_f32 v162, v164, v165
    v_exp_f32 v168, v168
    v_mfma_f32_32x32x8_bf16 v[176:191], v[116:117], v[106:107], v[176:191]
    v_cvt_pk_bf16_f32 v163, v166, v167
    v_exp_f32 v169, v169
    v_exp_f32 v170, v170
    v_mfma_f32_32x32x16_bf16 v[192:207], v[124:127], v[160:163], v[192:207]
    v_exp_f32 v171, v171
    v_exp_f32 v172, v172
    v_exp_f32 v173, v173
    v_mfma_f32_32x32x16_bf16 v[28:43], v[144:147], v[156:159], v[28:43]
    v_cvt_pk_bf16_f32 v168, v168, v169
    v_exp_f32 v174, v174
    v_cvt_pk_bf16_f32 v169, v170, v171
    v_exp_f32 v175, v175
    v_mfma_f32_32x32x16_bf16 v[44:59], v[148:151], v[156:159], v[44:59]
    v_cvt_pk_bf16_f32 v170, v172, v173
    v_cvt_pk_bf16_f32 v171, v174, v175
    v_exp_f32 v176, v176
    v_exp_f32 v177, v177
    v_mfma_f32_32x32x16_bf16 v[192:207], v[128:131], v[168:171], v[192:207]
    v_cvt_pk_bf16_f32 v12, v12, v13
    v_cvt_pk_bf16_f32 v13, v14, v15
    v_cvt_pk_bf16_f32 v14, v16, v17
    v_cvt_pk_bf16_f32 v15, v18, v19
    buffer_store_dwordx4 v[12:15], v0, s[24:27], s75 offen offset:0 sc1
    v_exp_f32 v178, v178
    v_exp_f32 v179, v179
    v_exp_f32 v180, v180
    s_waitcnt lgkmcnt(0)
    v_mfma_f32_32x32x16_bf16 v[160:175], v[118:121], v[96:99], 0
    v_cvt_pk_bf16_f32 v16, v20, v21
    v_cvt_pk_bf16_f32 v17, v22, v23
    v_cvt_pk_bf16_f32 v18, v24, v25
    v_cvt_pk_bf16_f32 v19, v26, v27
    buffer_store_dwordx4 v[16:19], v0, s[24:27], s75 offen offset:1024 sc1
    v_exp_f32 v181, v181
    v_cvt_pk_bf16_f32 v176, v176, v177
    v_exp_f32 v182, v182
    v_cvt_pk_bf16_f32 v177, v178, v179
    v_cvt_pk_bf16_f32 v28, v28, v29
    v_cvt_pk_bf16_f32 v29, v30, v31
    v_cvt_pk_bf16_f32 v30, v32, v33
    v_cvt_pk_bf16_f32 v31, v34, v35
    buffer_store_dwordx4 v[28:31], v0, s[24:27], s75 offen offset:2048 sc1
    v_exp_f32 v183, v183
    v_cvt_pk_bf16_f32 v178, v180, v181
    v_exp_f32 v184, v184
    v_mfma_f32_32x32x8_bf16 v[160:175], v[122:123], v[100:101], v[160:175]
    v_cvt_pk_bf16_f32 v32, v36, v37
    v_cvt_pk_bf16_f32 v33, v38, v39
    v_cvt_pk_bf16_f32 v34, v40, v41
    v_cvt_pk_bf16_f32 v35, v42, v43
    buffer_store_dwordx4 v[32:35], v0, s[24:27], s75 offen offset:3072 sc1
    v_cvt_pk_bf16_f32 v179, v182, v183
    v_exp_f32 v185, v185
    v_exp_f32 v186, v186
    v_mfma_f32_32x32x16_bf16 v[208:223], v[124:127], v[176:179], v[208:223]
    v_cvt_pk_bf16_f32 v44, v44, v45
    v_cvt_pk_bf16_f32 v45, v46, v47
    v_cvt_pk_bf16_f32 v46, v48, v49
    v_cvt_pk_bf16_f32 v47, v50, v51
    s_add_u32 s75, s75, 4096
    buffer_store_dwordx4 v[44:47], v0, s[24:27], s75 offen offset:0 sc1
    v_exp_f32 v187, v187
    v_exp_f32 v188, v188
    v_exp_f32 v189, v189
    v_cvt_pk_bf16_f32 v48, v52, v53
    v_cvt_pk_bf16_f32 v49, v54, v55
    v_cvt_pk_bf16_f32 v50, v56, v57
    v_cvt_pk_bf16_f32 v51, v58, v59
    buffer_store_dwordx4 v[48:51], v0, s[24:27], s75 offen offset:1024 sc1
    v_cvt_pk_bf16_f32 v184, v184, v185
    v_exp_f32 v190, v190
    v_cvt_pk_bf16_f32 v185, v186, v187
    v_exp_f32 v191, v191
    v_cvt_pk_bf16_f32 v186, v188, v189
    v_cvt_pk_bf16_f32 v187, v190, v191
    v_exp_f32 v160, v160
    v_exp_f32 v161, v161
L_h1_e3:
    v_mfma_f32_32x32x16_bf16 v[208:223], v[128:131], v[184:187], v[208:223]
    v_exp_f32 v162, v162
    v_exp_f32 v163, v163
    v_exp_f32 v164, v164
    s_waitcnt vmcnt(63) lgkmcnt(0)
    s_barrier
    v_mfma_f32_32x32x16_bf16 v[176:191], v[118:121], v[102:105], 0
    ds_read_b128 v[112:115], v80 offset:0
    ds_read_b64 v[116:117], v81 offset:0
    ds_read_b128 v[124:127], v82 offset:0
    ds_read_b128 v[128:131], v82 offset:640
    v_exp_f32 v165, v165
    v_cvt_pk_bf16_f32 v160, v160, v161
    v_exp_f32 v166, v166
    v_cvt_pk_bf16_f32 v161, v162, v163
    v_exp_f32 v167, v167
    v_cvt_pk_bf16_f32 v162, v164, v165
    v_exp_f32 v168, v168
    v_mfma_f32_32x32x8_bf16 v[176:191], v[122:123], v[106:107], v[176:191]
    v_cvt_pk_bf16_f32 v163, v166, v167
    v_exp_f32 v169, v169
    v_exp_f32 v170, v170
    v_mfma_f32_32x32x16_bf16 v[192:207], v[132:135], v[160:163], v[192:207]
    v_exp_f32 v171, v171
    v_exp_f32 v172, v172
    v_exp_f32 v173, v173
    v_cvt_pk_bf16_f32 v168, v168, v169
    v_exp_f32 v174, v174
    v_cvt_pk_bf16_f32 v169, v170, v171
    v_exp_f32 v175, v175
    v_cvt_pk_bf16_f32 v170, v172, v173
    v_cvt_pk_bf16_f32 v171, v174, v175
    v_exp_f32 v176, v176
    v_exp_f32 v177, v177
    v_mfma_f32_32x32x16_bf16 v[192:207], v[136:139], v[168:171], v[192:207]
    v_exp_f32 v178, v178
    v_exp_f32 v179, v179
    v_exp_f32 v180, v180
    s_waitcnt lgkmcnt(0)
    v_mfma_f32_32x32x16_bf16 v[160:175], v[112:115], v[96:99], 0
    v_exp_f32 v181, v181
    v_cvt_pk_bf16_f32 v176, v176, v177
    v_exp_f32 v182, v182
    v_cvt_pk_bf16_f32 v177, v178, v179
    v_exp_f32 v183, v183
    v_cvt_pk_bf16_f32 v178, v180, v181
    v_exp_f32 v184, v184
    v_mfma_f32_32x32x8_bf16 v[160:175], v[116:117], v[100:101], v[160:175]
    v_cvt_pk_bf16_f32 v179, v182, v183
    v_exp_f32 v185, v185
    v_exp_f32 v186, v186
    v_mfma_f32_32x32x16_bf16 v[208:223], v[132:135], v[176:179], v[208:223]
    v_exp_f32 v187, v187
    v_exp_f32 v188, v188
    v_exp_f32 v189, v189
    v_cvt_pk_bf16_f32 v184, v184, v185
    v_exp_f32 v190, v190
    v_cvt_pk_bf16_f32 v185, v186, v187
    v_exp_f32 v191, v191
    v_cvt_pk_bf16_f32 v186, v188, v189
    v_cvt_pk_bf16_f32 v187, v190, v191
    v_exp_f32 v160, v160
    v_exp_f32 v161, v161
    s_branch L_p2_fin
L_p2_chk:
    s_mov_b32 s55, 0
L_poll_51:
    buffer_load_dwordx2 v[92:93], v86, s[24:27], 0 offen sc1
    s_add_u32 s55, s55, 1
    s_waitcnt vmcnt(0)
    v_cmp_ne_u64 vcc, s[98:99], v[92:93]
    s_cbranch_vccz L_poll_51_d
    s_cmp_lt_u32 s55, 0x100000
    s_cbranch_scc1 L_poll_51
L_poll_51_d:
    s_branch L_p2_chk_r
L_p2_slow0:
    v_mov_b32 v110, 0xff61b1e6
    v_mov_b32 v111, 0xff61b1e6
    s_mov_b32 s66, 25165824
    s_mov_b32 s67, 0
L_p2_slow:
    buffer_load_dwordx4 v[140:143], v0, s[24:27], s66 offen offset:0 sc1
    buffer_load_dwordx4 v[144:147], v0, s[24:27], s66 offen offset:1024 sc1
    s_add_u32 s68, s66, 4608
    buffer_load_dwordx2 v[148:149], v81, s[24:27], s68 offen offset:0 sc1
    buffer_load_dwordx2 v[150:151], v81, s[24:27], s68 offen offset:256 sc1
    s_waitcnt vmcnt(0)
    v_mfma_f32_32x32x16_bf16 v[160:175], v[140:143], v[96:99], 0
    v_mfma_f32_32x32x8_bf16 v[160:175], v[148:149], v[100:101], v[160:175]
    s_nop 15
    v_max3_f32 v110, v160, v161, v110
    v_max3_f32 v110, v162, v163, v110
    v_max3_f32 v110, v164, v165, v110
    v_max3_f32 v110, v166, v167, v110
    v_max3_f32 v110, v168, v169, v110
    v_max3_f32 v110, v170, v171, v110
    v_max3_f32 v110, v172, v173, v110
    v_max3_f32 v110, v174, v175, v110
    s_nop 7
    v_mfma_f32_32x32x16_bf16 v[160:175], v[140:143], v[102:105], 0
    v_mfma_f32_32x32x8_bf16 v[160:175], v[148:149], v[106:107], v[160:175]
    s_nop 15
    v_max3_f32 v111, v160, v161, v111
    v_max3_f32 v111, v162, v163, v111
    v_max3_f32 v111, v164, v165, v111
    v_max3_f32 v111, v166, v167, v111
    v_max3_f32 v111, v168, v169, v111
    v_max3_f32 v111, v170, v171, v111
    v_max3_f32 v111, v172, v173, v111
    v_max3_f32 v111, v174, v175, v111
    s_nop 7
    v_mfma_f32_32x32x16_bf16 v[160:175], v[144:147], v[96:99], 0
    v_mfma_f32_32x32x8_bf16 v[160:175], v[150:151], v[100:101], v[160:175]
    s_nop 15
    v_max3_f32 v110, v160, v161, v110
    v_max3_f32 v110, v162, v163, v110
    v_max3_f32 v110, v164, v165, v110
    v_max3_f32 v110, v166, v167, v110
    v_max3_f32 v110, v168, v169, v110
    v_max3_f32 v110, v170, v171, v110
    v_max3_f32 v110, v172, v173, v110
    v_max3_f32 v110, v174, v175, v110
    s_nop 7
    v_mfma_f32_32x32x16_bf16 v[160:175], v[144:147], v[102:105], 0
    v_mfma_f32_32x32x8_bf16 v[160:175], v[150:151], v[106:107], v[160:175]
    s_nop 15
    v_max3_f32 v111, v160, v161, v111
    v_max3_f32 v111, v162, v163, v111
    v_max3_f32 v111, v164, v165, v111
    v_max3_f32 v111, v166, v167, v111
    v_max3_f32 v111, v168, v169, v111
    v_max3_f32 v111, v170, v171, v111
    v_max3_f32 v111, v172, v173, v111
    v_max3_f32 v111, v174, v175, v111
    s_nop 7
    s_add_u32 s66, s66, 5120
    s_add_u32 s67, s67, 1
    s_cmp_lt_u32 s67, 32
    s_cbranch_scc1 L_p2_slow
    v_cmp_gt_u32 vcc, 512, v0
    v_mov_b32 v108, v110
    s_nop 1
    v_permlane32_swap_b32 v110, v108
    v_max_f32 v110, v110, v108
    v_sub_f32 v110, 0, v110
    v_cvt_pk_bf16_f32 v108, v110, v110
    v_lshlrev_b32 v108, 16, v108
    v_sub_f32 v109, v110, v108
    v_cvt_pk_bf16_f32 v108, v108, v109
    v_cndmask_b32 v101, 0, v108, vcc
    v_mov_b32 v108, v111
    s_nop 1
    v_permlane32_swap_b32 v111, v108
    v_max_f32 v111, v111, v108
    v_sub_f32 v111, 0, v111
    v_cvt_pk_bf16_f32 v108, v111, v111
    v_lshlrev_b32 v108, 16, v108
    v_sub_f32 v109, v111, v108
    v_cvt_pk_bf16_f32 v108, v108, v109
    v_cndmask_b32 v107, 0, v108, vcc
    s_branch L_p2_fast
L_p2_fin:
    v_mfma_f32_32x32x16_bf16 v[208:223], v[136:139], v[184:187], v[208:223]
    s_setprio 0
    s_waitcnt lgkmcnt(0)
    s_mul_i32 s66, s3, 3072
    s_add_u32 s66, s66, 81920
    v_add_u32 v108, s66, v0
    s_xor_b32 s66, s3, 4
    s_mul_i32 s66, s66, 3072
    s_add_u32 s66, s66, 81920
    v_add_u32 v109, s66, v0
    s_nop 7
    s_cmp_eq_u32 s63, 0
    s_cbranch_scc1 L_p2_x0
    ds_write_b128 v108, v[192:195] offset:0
    ds_write_b128 v108, v[196:199] offset:1024
    ds_write_b128 v108, v[200:203] offset:2048
    v_mov_b32 v192, v208
    v_mov_b32 v193, v209
    v_mov_b32 v194, v210
    v_mov_b32 v195, v211
    v_mov_b32 v196, v212
    v_mov_b32 v197, v213
    v_mov_b32 v198, v214
    v_mov_b32 v199, v215
    v_mov_b32 v200, v216
    v_mov_b32 v201, v217
    v_mov_b32 v202, v218
    v_mov_b32 v203, v219
    s_branch L_p2_x1
L_p2_x0:
    ds_write_b128 v108, v[208:211] offset:0
    ds_write_b128 v108, v[212:215] offset:1024
    ds_write_b128 v108, v[216:219] offset:2048
L_p2_x1:
    s_waitcnt lgkmcnt(0)
    s_barrier
    ds_read_b128 v[160:163], v109 offset:0
    ds_read_b128 v[164:167], v109 offset:1024
    ds_read_b128 v[168:171], v109 offset:2048
    s_add_u32 s52, s52, s63
    v_cmp_gt_u32 vcc, 512, v0
    v_mov_b32 v110, 1073741824
    s_lshr_b32 s68, s52, 3
    s_add_u32 s66, s52, s68
    s_lshl_b32 s66, s66, 10
    s_add_u32 s66, s66, s51
    s_mul_i32 s67, s68, 9216
    s_and_b32 s68, s52, 7
    s_lshl_b32 s68, s68, 7
    s_add_u32 s67, s67, s68
    s_add_u32 s67, s67, s51
    s_add_u32 s67, s67, 8192
    v_cndmask_b32 v110, v110, v90, vcc
    s_waitcnt lgkmcnt(0)
    v_add_f32 v192, v192, v160
    v_add_f32 v193, v193, v161
    v_add_f32 v194, v194, v162
    v_add_f32 v195, v195, v163
    v_add_f32 v196, v196, v164
    v_add_f32 v197, v197, v165
    v_add_f32 v198, v198, v166
    v_add_f32 v199, v199, v167
    v_add_f32 v200, v200, v168
    v_add_f32 v201, v201, v169
    v_add_f32 v202, v202, v170
    v_mov_b32 v108, v202
    v_mov_b32 v109, v202
    s_nop 1
    v_permlane32_swap_b32 v108, v109
    v_rcp_f32 v108, v108
    s_nop 0
    v_mul_f32 v192, v192, v108
    v_mul_f32 v193, v193, v108
    v_mul_f32 v194, v194, v108
    v_mul_f32 v195, v195, v108
    v_mul_f32 v196, v196, v108
    v_mul_f32 v197, v197, v108
    v_mul_f32 v198, v198, v108
    v_mul_f32 v199, v199, v108
    v_mul_f32 v200, v200, v108
    v_mul_f32 v201, v201, v108
    v_cvt_pk_bf16_f32 v192, v192, v193
    v_cvt_pk_bf16_f32 v193, v194, v195
    v_cvt_pk_bf16_f32 v194, v196, v197
    v_cvt_pk_bf16_f32 v195, v198, v199
    v_cvt_pk_bf16_f32 v196, v200, v201
    buffer_store_dwordx4 v[192:195], v0, s[24:27], s66 offen sc1
    buffer_store_dword v196, v110, s[24:27], s67 offen sc1
    s_cmp_lg_u32 s56, 0
    s_cbranch_scc1 L_p2_np
    s_mov_b32 s55, 0
L_poll_52:
    buffer_load_dwordx2 v[92:93], v86, s[24:27], 0 offen sc1
    s_add_u32 s55, s55, 1
    s_waitcnt vmcnt(0)
    v_cmp_ne_u64 vcc, s[98:99], v[92:93]
    s_cbranch_vccz L_poll_52_d
    s_cmp_lt_u32 s55, 0x100000
    s_cbranch_scc1 L_poll_52
L_poll_52_d:
L_p2_np:
    v_mov_b32 v3, v0
    v_lshrrev_b32 v0, 4, v0
    s_load_dwordx2 s[60:61], s[0:1], 0
    s_load_dwordx2 s[64:65], s[0:1], 72
    v_and_b32 v4, 31, v0
    v_lshrrev_b32 v6, 5, v0
    s_lshl_b32 s11, s4, 1
    s_add_u32 s35, s11, s9
    s_cmp_ge_u32 s3, 4
    s_cbranch_scc1 L_p3_r
    v_lshlrev_b32 v4, 2, v4
    v_lshl_add_u32 v4, v6, 9, v4
    s_xor_b32 s36, s35, 1
    s_mul_i32 s38, s35, 36864
    s_add_u32 s38, s38, s33
    s_add_u32 s38, s38, 26214400
    s_lshl_b32 s43, s35, 2
    s_add_u32 s43, s43, s10
    s_lshl_b32 s43, s43, 7
    s_add_u32 s43, s43, 49381376
    v_mov_b32 v8, s43
    s_mul_i32 s39, s36, 36864
    s_add_u32 s39, s39, s33
    s_add_u32 s39, s39, 26214400
    s_lshl_b32 s43, s36, 2
    s_add_u32 s43, s43, s10
    s_lshl_b32 s43, s43, 7
    s_add_u32 s43, s43, 49381376
    v_mov_b32 v9, s43
    s_lshl_b32 s43, s10, 12
    s_lshl_b32 s40, s9, 15
    s_add_u32 s40, s40, s43
    v_add_u32 v6, s40, v3
    s_xor_b32 s40, s40, 0x8000
    v_add_u32 v7, s40, v3
    s_add_u32 s43, s43, 0x10000
    v_add_u32 v10, s43, v3
    s_waitcnt vmcnt(0) lgkmcnt(0)
    s_barrier
    s_cmp_lg_u32 s3, 0
    s_cbranch_scc1 L_p3_w
    v_mov_b32 v220, s98
    v_mov_b32 v221, s99
    v_mov_b32 v222, s98
    v_mov_b32 v223, s99
    s_lshl_b32 s55, s2, 7
    s_add_u32 s55, s55, 49381376
    s_mov_b64 exec, 0xff
    buffer_store_dwordx4 v[220:223], v3, s[24:27], s55 offen sc1
    s_mov_b64 exec, -1
L_p3_w:
    s_cmp_lg_u32 s56, 0
    s_cbranch_scc1 L_p3_havea
    s_add_u32 s43, s34, 0
    buffer_load_dwordx4 v[60:63], v3, s[24:27], s43 offen offset:0 sc1
    s_add_u32 s43, s34, 0
    buffer_load_dwordx4 v[64:67], v3, s[24:27], s43 offen offset:1024 sc1
    s_add_u32 s43, s34, 0
    buffer_load_dwordx4 v[68:71], v3, s[24:27], s43 offen offset:2048 sc1
    s_add_u32 s43, s34, 0
    buffer_load_dwordx4 v[72:75], v3, s[24:27], s43 offen offset:3072 sc1
    s_add_u32 s43, s34, 4096
    buffer_load_dwordx4 v[76:79], v3, s[24:27], s43 offen offset:0 sc1
    s_add_u32 s43, s34, 4096
    buffer_load_dwordx4 v[224:227], v3, s[24:27], s43 offen offset:1024 sc1
    s_add_u32 s43, s34, 4096
    buffer_load_dwordx4 v[228:231], v3, s[24:27], s43 offen offset:2048 sc1
    s_add_u32 s43, s34, 4096
    buffer_load_dwordx4 v[232:235], v3, s[24:27], s43 offen offset:3072 sc1
    s_add_u32 s43, s34, 8192
    buffer_load_dwordx4 v[236:239], v3, s[24:27], s43 offen offset:0 sc1
    s_add_u32 s43, s34, 36864
    buffer_load_dwordx4 v[240:243], v3, s[24:27], s43 offen offset:0 sc1
    s_add_u32 s43, s34, 36864
    buffer_load_dwordx4 v[244:247], v3, s[24:27], s43 offen offset:1024 sc1
    s_add_u32 s43, s34, 36864
    buffer_load_dwordx4 v[248:251], v3, s[24:27], s43 offen offset:2048 sc1
L_p3_havea:
    s_add_u32 s43, s34, 36864
    buffer_load_dwordx4 v[12:15], v3, s[24:27], s43 offen offset:3072 sc1
    s_add_u32 s43, s34, 40960
    buffer_load_dwordx4 v[16:19], v3, s[24:27], s43 offen offset:0 sc1
    s_add_u32 s43, s34, 40960
    buffer_load_dwordx4 v[20:23], v3, s[24:27], s43 offen offset:1024 sc1
    s_add_u32 s43, s34, 40960
    buffer_load_dwordx4 v[24:27], v3, s[24:27], s43 offen offset:2048 sc1
    s_add_u32 s43, s34, 40960
    buffer_load_dwordx4 v[28:31], v3, s[24:27], s43 offen offset:3072 sc1
    s_add_u32 s43, s34, 45056
    buffer_load_dwordx4 v[32:35], v3, s[24:27], s43 offen offset:0 sc1
    s_cmp_eq_u32 s8, 0
    s_cbranch_scc1 L_p3_ne1
    s_add_u32 s43, s42, 0
    buffer_load_dwordx4 v[36:39], v3, s[24:27], s43 offen offset:0 sc1
    s_add_u32 s43, s42, 0
    buffer_load_dwordx4 v[40:43], v3, s[24:27], s43 offen offset:1024 sc1
    s_add_u32 s43, s42, 0
    buffer_load_dwordx4 v[44:47], v3, s[24:27], s43 offen offset:2048 sc1
    s_add_u32 s43, s42, 0
    buffer_load_dwordx4 v[48:51], v3, s[24:27], s43 offen offset:3072 sc1
    s_add_u32 s43, s42, 4096
    buffer_load_dwordx4 v[52:55], v3, s[24:27], s43 offen offset:0 sc1
    s_add_u32 s43, s42, 4096
    buffer_load_dwordx4 v[56:59], v3, s[24:27], s43 offen offset:1024 sc1
    s_add_u32 s43, s42, 4096
    buffer_load_dwordx4 v[80:83], v3, s[24:27], s43 offen offset:2048 sc1
    s_add_u32 s43, s42, 4096
    buffer_load_dwordx4 v[84:87], v3, s[24:27], s43 offen offset:3072 sc1
    s_add_u32 s43, s42, 8192
    buffer_load_dwordx4 v[88:91], v3, s[24:27], s43 offen offset:0 sc1
L_p3_ne1:
    v_cmp_gt_u32 vcc, 32, v0
    s_nop 1
    v_cndmask_b32 v8, v9, v8, vcc
    s_mov_b32 s55, 0
L_poll_53:
    buffer_load_dwordx2 v[212:213], v8, s[24:27], 0 offen sc1
    s_add_u32 s55, s55, 1
    s_waitcnt vmcnt(0)
    v_cmp_ne_u64 vcc, s[98:99], v[212:213]
    s_cbranch_vccz L_poll_53_d
    s_cmp_lt_u32 s55, 0x100000
    s_cbranch_scc1 L_poll_53
L_poll_53_d:
    buffer_load_dwordx4 v[92:95], v3, s[24:27], s38 offen offset:0 sc1
    buffer_load_dwordx4 v[96:99], v3, s[24:27], s38 offen offset:1024 sc1
    buffer_load_dwordx4 v[100:103], v3, s[24:27], s38 offen offset:2048 sc1
    buffer_load_dwordx4 v[104:107], v3, s[24:27], s38 offen offset:3072 sc1
    s_add_u32 s38, s38, 4096
    buffer_load_dwordx4 v[108:111], v3, s[24:27], s38 offen offset:0 sc1
    buffer_load_dwordx4 v[112:115], v3, s[24:27], s38 offen offset:1024 sc1
    buffer_load_dwordx4 v[116:119], v3, s[24:27], s38 offen offset:2048 sc1
    buffer_load_dwordx4 v[120:123], v3, s[24:27], s38 offen offset:3072 sc1
    s_add_u32 s38, s38, 4096
    buffer_load_dword v124, v4, s[24:27], s38 offen offset:0 sc1
    buffer_load_dword v125, v4, s[24:27], s38 offen offset:128 sc1
    buffer_load_dword v126, v4, s[24:27], s38 offen offset:256 sc1
    buffer_load_dword v127, v4, s[24:27], s38 offen offset:384 sc1
    buffer_load_dwordx4 v[128:131], v3, s[24:27], s39 offen offset:0 sc1
    buffer_load_dwordx4 v[132:135], v3, s[24:27], s39 offen offset:1024 sc1
    buffer_load_dwordx4 v[136:139], v3, s[24:27], s39 offen offset:2048 sc1
    buffer_load_dwordx4 v[140:143], v3, s[24:27], s39 offen offset:3072 sc1
    s_add_u32 s39, s39, 4096
    buffer_load_dwordx4 v[144:147], v3, s[24:27], s39 offen offset:0 sc1
    buffer_load_dwordx4 v[148:151], v3, s[24:27], s39 offen offset:1024 sc1
    buffer_load_dwordx4 v[152:155], v3, s[24:27], s39 offen offset:2048 sc1
    buffer_load_dwordx4 v[156:159], v3, s[24:27], s39 offen offset:3072 sc1
    s_add_u32 s39, s39, 4096
    buffer_load_dword v160, v4, s[24:27], s39 offen offset:0 sc1
    buffer_load_dword v161, v4, s[24:27], s39 offen offset:128 sc1
    buffer_load_dword v162, v4, s[24:27], s39 offen offset:256 sc1
    buffer_load_dword v163, v4, s[24:27], s39 offen offset:384 sc1
    s_waitcnt vmcnt(23)
    v_mfma_f32_32x32x16_bf16 v[164:179], v[60:63], v[92:95], 0
    v_mfma_f32_32x32x16_bf16 v[180:195], v[240:243], v[92:95], 0
    s_waitcnt vmcnt(22)
    v_mfma_f32_32x32x16_bf16 v[164:179], v[64:67], v[96:99], v[164:179]
    v_mfma_f32_32x32x16_bf16 v[180:195], v[244:247], v[96:99], v[180:195]
    s_waitcnt vmcnt(21)
    v_mfma_f32_32x32x16_bf16 v[164:179], v[68:71], v[100:103], v[164:179]
    v_mfma_f32_32x32x16_bf16 v[180:195], v[248:251], v[100:103], v[180:195]
    s_waitcnt vmcnt(20)
    v_mfma_f32_32x32x16_bf16 v[164:179], v[72:75], v[104:107], v[164:179]
    v_mfma_f32_32x32x16_bf16 v[180:195], v[12:15], v[104:107], v[180:195]
    s_waitcnt vmcnt(19)
    v_mfma_f32_32x32x16_bf16 v[164:179], v[76:79], v[108:111], v[164:179]
    v_mfma_f32_32x32x16_bf16 v[180:195], v[16:19], v[108:111], v[180:195]
    s_waitcnt vmcnt(18)
    v_mfma_f32_32x32x16_bf16 v[164:179], v[224:227], v[112:115], v[164:179]
    v_mfma_f32_32x32x16_bf16 v[180:195], v[20:23], v[112:115], v[180:195]
    s_waitcnt vmcnt(17)
    v_mfma_f32_32x32x16_bf16 v[164:179], v[228:231], v[116:119], v[164:179]
    v_mfma_f32_32x32x16_bf16 v[180:195], v[24:27], v[116:119], v[180:195]
    s_waitcnt vmcnt(16)
    v_mfma_f32_32x32x16_bf16 v[164:179], v[232:235], v[120:123], v[164:179]
    v_mfma_f32_32x32x16_bf16 v[180:195], v[28:31], v[120:123], v[180:195]
    s_waitcnt vmcnt(12)
    v_mfma_f32_32x32x16_bf16 v[164:179], v[236:239], v[124:127], v[164:179]
    v_mfma_f32_32x32x16_bf16 v[180:195], v[32:35], v[124:127], v[180:195]
    s_cmp_eq_u32 s8, 0
    s_cbranch_scc1 L_p3_ne2
    v_mfma_f32_32x32x16_bf16 v[196:211], v[36:39], v[92:95], 0
    v_mfma_f32_32x32x16_bf16 v[196:211], v[40:43], v[96:99], v[196:211]
    v_mfma_f32_32x32x16_bf16 v[196:211], v[44:47], v[100:103], v[196:211]
    v_mfma_f32_32x32x16_bf16 v[196:211], v[48:51], v[104:107], v[196:211]
    v_mfma_f32_32x32x16_bf16 v[196:211], v[52:55], v[108:111], v[196:211]
    v_mfma_f32_32x32x16_bf16 v[196:211], v[56:59], v[112:115], v[196:211]
    v_mfma_f32_32x32x16_bf16 v[196:211], v[80:83], v[116:119], v[196:211]
    v_mfma_f32_32x32x16_bf16 v[196:211], v[84:87], v[120:123], v[196:211]
    v_mfma_f32_32x32x16_bf16 v[196:211], v[88:91], v[124:127], v[196:211]
L_p3_ne2:
    s_waitcnt vmcnt(11)
    v_mfma_f32_32x32x16_bf16 v[92:107], v[60:63], v[128:131], 0
    v_mfma_f32_32x32x16_bf16 v[108:123], v[240:243], v[128:131], 0
    s_waitcnt vmcnt(10)
    v_mfma_f32_32x32x16_bf16 v[92:107], v[64:67], v[132:135], v[92:107]
    v_mfma_f32_32x32x16_bf16 v[108:123], v[244:247], v[132:135], v[108:123]
    s_waitcnt vmcnt(9)
    v_mfma_f32_32x32x16_bf16 v[92:107], v[68:71], v[136:139], v[92:107]
    v_mfma_f32_32x32x16_bf16 v[108:123], v[248:251], v[136:139], v[108:123]
    s_waitcnt vmcnt(8)
    v_mfma_f32_32x32x16_bf16 v[92:107], v[72:75], v[140:143], v[92:107]
    v_mfma_f32_32x32x16_bf16 v[108:123], v[12:15], v[140:143], v[108:123]
    s_waitcnt vmcnt(7)
    v_mfma_f32_32x32x16_bf16 v[92:107], v[76:79], v[144:147], v[92:107]
    v_mfma_f32_32x32x16_bf16 v[108:123], v[16:19], v[144:147], v[108:123]
    s_waitcnt vmcnt(6)
    v_mfma_f32_32x32x16_bf16 v[92:107], v[224:227], v[148:151], v[92:107]
    v_mfma_f32_32x32x16_bf16 v[108:123], v[20:23], v[148:151], v[108:123]
    ds_write_b128 v6, v[164:167] offset:0
    ds_write_b128 v6, v[168:171] offset:1024
    s_waitcnt vmcnt(5)
    v_mfma_f32_32x32x16_bf16 v[92:107], v[228:231], v[152:155], v[92:107]
    v_mfma_f32_32x32x16_bf16 v[108:123], v[24:27], v[152:155], v[108:123]
    ds_write_b128 v6, v[172:175] offset:2048
    ds_write_b128 v6, v[176:179] offset:3072
    s_waitcnt vmcnt(4)
    v_mfma_f32_32x32x16_bf16 v[92:107], v[232:235], v[156:159], v[92:107]
    v_mfma_f32_32x32x16_bf16 v[108:123], v[28:31], v[156:159], v[108:123]
    ds_write_b128 v6, v[180:183] offset:16384
    ds_write_b128 v6, v[184:187] offset:17408
    s_waitcnt vmcnt(0)
    v_mfma_f32_32x32x16_bf16 v[92:107], v[236:239], v[160:163], v[92:107]
    v_mfma_f32_32x32x16_bf16 v[108:123], v[32:35], v[160:163], v[108:123]
    ds_write_b128 v6, v[188:191] offset:18432
    ds_write_b128 v6, v[192:195] offset:19456
    s_cmp_eq_u32 s8, 0
    s_cbranch_scc1 L_p3_ne3
    ds_write_b128 v10, v[196:199] offset:0
    ds_write_b128 v10, v[200:203] offset:1024
    ds_write_b128 v10, v[204:207] offset:2048
    ds_write_b128 v10, v[208:211] offset:3072
L_p3_ne3:
    s_nop 11
    ds_write_b128 v7, v[92:95] offset:0
    ds_write_b128 v7, v[96:99] offset:1024
    ds_write_b128 v7, v[100:103] offset:2048
    ds_write_b128 v7, v[104:107] offset:3072
    ds_write_b128 v7, v[108:111] offset:16384
    ds_write_b128 v7, v[112:115] offset:17408
    ds_write_b128 v7, v[116:119] offset:18432
    ds_write_b128 v7, v[120:123] offset:19456
    s_waitcnt lgkmcnt(0)
    s_barrier
    s_endpgm
L_p3_r:
    v_mul_u32_u24 v5, 1152, v4
    v_lshl_add_u32 v9, v6, 3, v5
    v_lshl_add_u32 v5, v6, 4, v5
    s_lshr_b32 s36, s10, 1
    s_add_u32 s36, s36, s11
    s_and_b32 s37, s10, 1
    s_lshl_b32 s40, s7, 1
    s_add_u32 s40, s40, s37
    s_mul_i32 s38, s36, 36864
    s_lshl_b32 s43, s40, 11
    s_add_u32 s38, s38, s43
    s_add_u32 s38, s38, 30408704
    s_mul_i32 s41, s36, 36864
    s_lshl_b32 s43, s40, 6
    s_add_u32 s41, s41, s43
    s_mul_i32 s39, s35, 36864
    s_lshl_b32 s43, s48, 6
    s_add_u32 s44, s39, s43
    s_lshl_b32 s43, s10, 4
    s_add_u32 s44, s44, s43
    s_lshl_b32 s43, s48, 11
    s_add_u32 s39, s39, s43
    s_lshr_b32 s43, s10, 1
    s_lshl_b32 s43, s43, 10
    s_add_u32 s39, s39, s43
    s_lshl_b32 s43, s37, 3
    s_add_u32 s39, s39, s43
    s_add_u32 s39, s39, 30408704
    s_cmp_eq_u32 s8, 0
    s_cselect_b32 s39, 1073741824, s39
    s_cselect_b32 s44, 1073741824, s44
    s_mul_i32 s43, s7, 43
    s_lshr_b32 s43, s43, 7
    v_and_b32 v7, 8, v0
    v_cmp_eq_u32 vcc, 8, v7
    v_mov_b32 v11, s43
    v_and_b32 v8, 7, v0
    v_cndmask_b32 v11, v11, 2, vcc
    v_min_u32 v8, 4, v8
    s_lshr_b32 s43, s4, 1
    v_lshl_add_u32 v8, v8, 4, s43
    v_mul_u32_u24 v10, 205, v8
    v_lshrrev_b32 v10, 11, v10
    v_mul_u32_u24 v7, 10, v10
    v_sub_u32 v8, v8, v7
    v_mad_u32_u24 v8, v8, 3, v11
    v_lshl_add_u32 v8, v8, 3, v10
    v_lshlrev_b32 v8, 7, v8
    v_add_u32 v8, 49381376, v8
    s_lshl_b32 s43, s10, 14
    v_add_u32 v7, s43, v3
    s_lshl_b32 s43, s10, 10
    s_add_u32 s43, s43, 0x10000
    v_add_u32 v10, s43, v3
    s_waitcnt vmcnt(0) lgkmcnt(0)
    s_barrier
    s_mov_b32 s12, s60
    s_mov_b32 s13, s61
    s_mov_b32 s14, 2359296
    s_mov_b32 s15, 0x00020000
    s_mov_b32 s16, s64
    s_mov_b32 s17, s65
    s_mov_b32 s18, 2359296
    s_mov_b32 s19, 0x00020000
    s_mov_b32 s46, 0x3ef5fdf0
    s_mov_b32 s47, 0x3ef5fdf0
    buffer_load_dwordx4 v[12:15], v5, s[12:15], s41 offen offset:0
    buffer_load_dwordx4 v[16:19], v5, s[12:15], s41 offen offset:32
    buffer_load_dwordx2 v[60:61], v9, s[12:15], s44 offen
    s_mov_b32 s55, 0
L_poll_54:
    buffer_load_dwordx2 v[212:213], v8, s[24:27], 0 offen sc1
    s_add_u32 s55, s55, 1
    s_waitcnt vmcnt(0)
    v_cmp_ne_u64 vcc, s[98:99], v[212:213]
    s_cbranch_vccz L_poll_54_d
    s_cmp_lt_u32 s55, 0x100000
    s_cbranch_scc1 L_poll_54
L_poll_54_d:
    s_waitcnt vmcnt(2)
    buffer_load_dwordx4 v[20:23], v3, s[24:27], s38 offen offset:0 sc1
    buffer_load_dwordx4 v[24:27], v3, s[24:27], s38 offen offset:1024 sc1
    buffer_load_dwordx2 v[62:63], v3, s[24:27], s39 offen sc1
    s_add_u32 s38, s38, 2359296
    s_add_u32 s39, s39, 2359296
    buffer_load_dwordx4 v[28:31], v3, s[24:27], s38 offen offset:0 sc1
    buffer_load_dwordx4 v[32:35], v3, s[24:27], s38 offen offset:1024 sc1
    buffer_load_dwordx2 v[64:65], v3, s[24:27], s39 offen sc1
    s_add_u32 s38, s38, 2359296
    s_add_u32 s39, s39, 2359296
    buffer_load_dwordx4 v[36:39], v3, s[24:27], s38 offen offset:0 sc1
    buffer_load_dwordx4 v[40:43], v3, s[24:27], s38 offen offset:1024 sc1
    buffer_load_dwordx2 v[66:67], v3, s[24:27], s39 offen sc1
    s_add_u32 s38, s38, 2359296
    s_add_u32 s39, s39, 2359296
    buffer_load_dwordx4 v[44:47], v3, s[24:27], s38 offen offset:0 sc1
    buffer_load_dwordx4 v[48:51], v3, s[24:27], s38 offen offset:1024 sc1
    buffer_load_dwordx2 v[68:69], v3, s[24:27], s39 offen sc1
    s_add_u32 s38, s38, 2359296
    s_add_u32 s39, s39, 2359296
    buffer_load_dwordx4 v[52:55], v3, s[24:27], s38 offen offset:0 sc1
    buffer_load_dwordx4 v[56:59], v3, s[24:27], s38 offen offset:1024 sc1
    buffer_load_dwordx2 v[70:71], v3, s[24:27], s39 offen sc1
    v_permlane32_swap_b32 v12, v14
    v_permlane32_swap_b32 v13, v15
    v_permlane32_swap_b32 v16, v18
    v_permlane32_swap_b32 v17, v19
    v_lshlrev_b32 v72, 16, v12
    v_and_b32 v73, 0xffff0000, v12
    v_lshlrev_b32 v74, 16, v13
    v_and_b32 v75, 0xffff0000, v13
    v_lshlrev_b32 v76, 16, v14
    v_and_b32 v77, 0xffff0000, v14
    v_lshlrev_b32 v78, 16, v15
    v_and_b32 v79, 0xffff0000, v15
    v_lshlrev_b32 v80, 16, v16
    v_and_b32 v81, 0xffff0000, v16
    v_lshlrev_b32 v82, 16, v17
    v_and_b32 v83, 0xffff0000, v17
    v_lshlrev_b32 v84, 16, v18
    v_and_b32 v85, 0xffff0000, v18
    v_lshlrev_b32 v86, 16, v19
    v_and_b32 v87, 0xffff0000, v19
    v_lshlrev_b32 v88, 16, v60
    v_and_b32 v89, 0xffff0000, v60
    v_lshlrev_b32 v90, 16, v61
    v_and_b32 v91, 0xffff0000, v61
    s_waitcnt vmcnt(12)
    v_lshlrev_b32 v96, 16, v20
    v_and_b32 v97, 0xffff0000, v20
    v_lshlrev_b32 v98, 16, v21
    v_and_b32 v99, 0xffff0000, v21
    v_lshlrev_b32 v100, 16, v22
    v_and_b32 v101, 0xffff0000, v22
    v_lshlrev_b32 v102, 16, v23
    v_and_b32 v103, 0xffff0000, v23
    v_lshlrev_b32 v104, 16, v24
    v_and_b32 v105, 0xffff0000, v24
    v_lshlrev_b32 v106, 16, v25
    v_and_b32 v107, 0xffff0000, v25
    v_lshlrev_b32 v108, 16, v26
    v_and_b32 v109, 0xffff0000, v26
    v_lshlrev_b32 v110, 16, v27
    v_and_b32 v111, 0xffff0000, v27
    v_lshlrev_b32 v112, 16, v62
    v_and_b32 v113, 0xffff0000, v62
    v_lshlrev_b32 v114, 16, v63
    v_and_b32 v115, 0xffff0000, v63
    v_pk_add_f32 v[72:73], v[72:73], v[96:97]
    v_pk_add_f32 v[74:75], v[74:75], v[98:99]
    v_pk_add_f32 v[76:77], v[76:77], v[100:101]
    v_pk_add_f32 v[78:79], v[78:79], v[102:103]
    v_pk_add_f32 v[80:81], v[80:81], v[104:105]
    v_pk_add_f32 v[82:83], v[82:83], v[106:107]
    v_pk_add_f32 v[84:85], v[84:85], v[108:109]
    v_pk_add_f32 v[86:87], v[86:87], v[110:111]
    v_pk_add_f32 v[88:89], v[88:89], v[112:113]
    v_pk_add_f32 v[90:91], v[90:91], v[114:115]
    s_waitcnt vmcnt(9)
    v_lshlrev_b32 v96, 16, v28
    v_and_b32 v97, 0xffff0000, v28
    v_lshlrev_b32 v98, 16, v29
    v_and_b32 v99, 0xffff0000, v29
    v_lshlrev_b32 v100, 16, v30
    v_and_b32 v101, 0xffff0000, v30
    v_lshlrev_b32 v102, 16, v31
    v_and_b32 v103, 0xffff0000, v31
    v_lshlrev_b32 v104, 16, v32
    v_and_b32 v105, 0xffff0000, v32
    v_lshlrev_b32 v106, 16, v33
    v_and_b32 v107, 0xffff0000, v33
    v_lshlrev_b32 v108, 16, v34
    v_and_b32 v109, 0xffff0000, v34
    v_lshlrev_b32 v110, 16, v35
    v_and_b32 v111, 0xffff0000, v35
    v_lshlrev_b32 v112, 16, v64
    v_and_b32 v113, 0xffff0000, v64
    v_lshlrev_b32 v114, 16, v65
    v_and_b32 v115, 0xffff0000, v65
    v_pk_add_f32 v[72:73], v[72:73], v[96:97]
    v_pk_add_f32 v[74:75], v[74:75], v[98:99]
    v_pk_add_f32 v[76:77], v[76:77], v[100:101]
    v_pk_add_f32 v[78:79], v[78:79], v[102:103]
    v_pk_add_f32 v[80:81], v[80:81], v[104:105]
    v_pk_add_f32 v[82:83], v[82:83], v[106:107]
    v_pk_add_f32 v[84:85], v[84:85], v[108:109]
    v_pk_add_f32 v[86:87], v[86:87], v[110:111]
    v_pk_add_f32 v[88:89], v[88:89], v[112:113]
    v_pk_add_f32 v[90:91], v[90:91], v[114:115]
    s_waitcnt vmcnt(6)
    v_lshlrev_b32 v96, 16, v36
    v_and_b32 v97, 0xffff0000, v36
    v_lshlrev_b32 v98, 16, v37
    v_and_b32 v99, 0xffff0000, v37
    v_lshlrev_b32 v100, 16, v38
    v_and_b32 v101, 0xffff0000, v38
    v_lshlrev_b32 v102, 16, v39
    v_and_b32 v103, 0xffff0000, v39
    v_lshlrev_b32 v104, 16, v40
    v_and_b32 v105, 0xffff0000, v40
    v_lshlrev_b32 v106, 16, v41
    v_and_b32 v107, 0xffff0000, v41
    v_lshlrev_b32 v108, 16, v42
    v_and_b32 v109, 0xffff0000, v42
    v_lshlrev_b32 v110, 16, v43
    v_and_b32 v111, 0xffff0000, v43
    v_lshlrev_b32 v112, 16, v66
    v_and_b32 v113, 0xffff0000, v66
    v_lshlrev_b32 v114, 16, v67
    v_and_b32 v115, 0xffff0000, v67
    v_pk_add_f32 v[72:73], v[72:73], v[96:97]
    v_pk_add_f32 v[74:75], v[74:75], v[98:99]
    v_pk_add_f32 v[76:77], v[76:77], v[100:101]
    v_pk_add_f32 v[78:79], v[78:79], v[102:103]
    v_pk_add_f32 v[80:81], v[80:81], v[104:105]
    v_pk_add_f32 v[82:83], v[82:83], v[106:107]
    v_pk_add_f32 v[84:85], v[84:85], v[108:109]
    v_pk_add_f32 v[86:87], v[86:87], v[110:111]
    v_pk_add_f32 v[88:89], v[88:89], v[112:113]
    v_pk_add_f32 v[90:91], v[90:91], v[114:115]
    s_waitcnt vmcnt(3)
    v_lshlrev_b32 v96, 16, v44
    v_and_b32 v97, 0xffff0000, v44
    v_lshlrev_b32 v98, 16, v45
    v_and_b32 v99, 0xffff0000, v45
    v_lshlrev_b32 v100, 16, v46
    v_and_b32 v101, 0xffff0000, v46
    v_lshlrev_b32 v102, 16, v47
    v_and_b32 v103, 0xffff0000, v47
    v_lshlrev_b32 v104, 16, v48
    v_and_b32 v105, 0xffff0000, v48
    v_lshlrev_b32 v106, 16, v49
    v_and_b32 v107, 0xffff0000, v49
    v_lshlrev_b32 v108, 16, v50
    v_and_b32 v109, 0xffff0000, v50
    v_lshlrev_b32 v110, 16, v51
    v_and_b32 v111, 0xffff0000, v51
    v_lshlrev_b32 v112, 16, v68
    v_and_b32 v113, 0xffff0000, v68
    v_lshlrev_b32 v114, 16, v69
    v_and_b32 v115, 0xffff0000, v69
    v_pk_add_f32 v[72:73], v[72:73], v[96:97]
    v_pk_add_f32 v[74:75], v[74:75], v[98:99]
    v_pk_add_f32 v[76:77], v[76:77], v[100:101]
    v_pk_add_f32 v[78:79], v[78:79], v[102:103]
    v_pk_add_f32 v[80:81], v[80:81], v[104:105]
    v_pk_add_f32 v[82:83], v[82:83], v[106:107]
    v_pk_add_f32 v[84:85], v[84:85], v[108:109]
    v_pk_add_f32 v[86:87], v[86:87], v[110:111]
    v_pk_add_f32 v[88:89], v[88:89], v[112:113]
    v_pk_add_f32 v[90:91], v[90:91], v[114:115]
    s_waitcnt vmcnt(0)
    v_lshlrev_b32 v96, 16, v52
    v_and_b32 v97, 0xffff0000, v52
    v_lshlrev_b32 v98, 16, v53
    v_and_b32 v99, 0xffff0000, v53
    v_lshlrev_b32 v100, 16, v54
    v_and_b32 v101, 0xffff0000, v54
    v_lshlrev_b32 v102, 16, v55
    v_and_b32 v103, 0xffff0000, v55
    v_lshlrev_b32 v104, 16, v56
    v_and_b32 v105, 0xffff0000, v56
    v_lshlrev_b32 v106, 16, v57
    v_and_b32 v107, 0xffff0000, v57
    v_lshlrev_b32 v108, 16, v58
    v_and_b32 v109, 0xffff0000, v58
    v_lshlrev_b32 v110, 16, v59
    v_and_b32 v111, 0xffff0000, v59
    v_lshlrev_b32 v112, 16, v70
    v_and_b32 v113, 0xffff0000, v70
    v_lshlrev_b32 v114, 16, v71
    v_and_b32 v115, 0xffff0000, v71
    v_pk_add_f32 v[72:73], v[72:73], v[96:97]
    v_pk_add_f32 v[74:75], v[74:75], v[98:99]
    v_pk_add_f32 v[76:77], v[76:77], v[100:101]
    v_pk_add_f32 v[78:79], v[78:79], v[102:103]
    v_pk_add_f32 v[80:81], v[80:81], v[104:105]
    v_pk_add_f32 v[82:83], v[82:83], v[106:107]
    v_pk_add_f32 v[84:85], v[84:85], v[108:109]
    v_pk_add_f32 v[86:87], v[86:87], v[110:111]
    v_pk_add_f32 v[88:89], v[88:89], v[112:113]
    v_pk_add_f32 v[90:91], v[90:91], v[114:115]
    s_barrier
    ds_read_b128 v[96:99], v7 offset:0
    ds_read_b128 v[100:103], v7 offset:1024
    ds_read_b128 v[104:107], v7 offset:2048
    ds_read_b128 v[108:111], v7 offset:3072
    ds_read_b128 v[112:115], v7 offset:4096
    ds_read_b128 v[116:119], v7 offset:5120
    ds_read_b128 v[120:123], v7 offset:6144
    ds_read_b128 v[124:127], v7 offset:7168
    ds_read_b128 v[128:131], v7 offset:8192
    ds_read_b128 v[132:135], v7 offset:9216
    ds_read_b128 v[136:139], v7 offset:10240
    ds_read_b128 v[140:143], v7 offset:11264
    ds_read_b128 v[144:147], v7 offset:12288
    ds_read_b128 v[148:151], v7 offset:13312
    ds_read_b128 v[152:155], v7 offset:14336
    ds_read_b128 v[156:159], v7 offset:15360
    s_waitcnt lgkmcnt(12)
    v_pk_add_f32 v[72:73], v[72:73], v[96:97]
    v_pk_add_f32 v[74:75], v[74:75], v[98:99]
    v_pk_add_f32 v[76:77], v[76:77], v[100:101]
    v_pk_add_f32 v[78:79], v[78:79], v[102:103]
    v_pk_add_f32 v[80:81], v[80:81], v[104:105]
    v_pk_add_f32 v[82:83], v[82:83], v[106:107]
    v_pk_add_f32 v[84:85], v[84:85], v[108:109]
    v_pk_add_f32 v[86:87], v[86:87], v[110:111]
    s_waitcnt lgkmcnt(8)
    v_pk_add_f32 v[72:73], v[72:73], v[112:113]
    v_pk_add_f32 v[74:75], v[74:75], v[114:115]
    v_pk_add_f32 v[76:77], v[76:77], v[116:117]
    v_pk_add_f32 v[78:79], v[78:79], v[118:119]
    v_pk_add_f32 v[80:81], v[80:81], v[120:121]
    v_pk_add_f32 v[82:83], v[82:83], v[122:123]
    v_pk_add_f32 v[84:85], v[84:85], v[124:125]
    v_pk_add_f32 v[86:87], v[86:87], v[126:127]
    s_waitcnt lgkmcnt(4)
    ds_read_b128 v[160:163], v10 offset:0
    ds_read_b128 v[164:167], v10 offset:4096
    ds_read_b128 v[168:171], v10 offset:8192
    ds_read_b128 v[172:175], v10 offset:12288
    v_pk_add_f32 v[72:73], v[72:73], v[128:129]
    v_pk_add_f32 v[74:75], v[74:75], v[130:131]
    v_pk_add_f32 v[76:77], v[76:77], v[132:133]
    v_pk_add_f32 v[78:79], v[78:79], v[134:135]
    v_pk_add_f32 v[80:81], v[80:81], v[136:137]
    v_pk_add_f32 v[82:83], v[82:83], v[138:139]
    v_pk_add_f32 v[84:85], v[84:85], v[140:141]
    v_pk_add_f32 v[86:87], v[86:87], v[142:143]
    s_waitcnt lgkmcnt(4)
    v_pk_add_f32 v[72:73], v[72:73], v[144:145]
    v_pk_add_f32 v[74:75], v[74:75], v[146:147]
    v_pk_add_f32 v[76:77], v[76:77], v[148:149]
    v_pk_add_f32 v[78:79], v[78:79], v[150:151]
    v_pk_add_f32 v[80:81], v[80:81], v[152:153]
    v_pk_add_f32 v[82:83], v[82:83], v[154:155]
    v_pk_add_f32 v[84:85], v[84:85], v[156:157]
    v_pk_add_f32 v[86:87], v[86:87], v[158:159]
    v_cvt_pk_bf16_f32 v96, v72, v73
    v_cvt_pk_bf16_f32 v97, v74, v75
    v_cvt_pk_bf16_f32 v98, v76, v77
    v_cvt_pk_bf16_f32 v99, v78, v79
    v_cvt_pk_bf16_f32 v100, v80, v81
    v_cvt_pk_bf16_f32 v101, v82, v83
    v_cvt_pk_bf16_f32 v102, v84, v85
    v_cvt_pk_bf16_f32 v103, v86, v87
    s_nop 1
    v_permlane32_swap_b32 v96, v98
    v_permlane32_swap_b32 v97, v99
    v_permlane32_swap_b32 v100, v102
    v_permlane32_swap_b32 v101, v103
    buffer_store_dwordx4 v[96:99], v5, s[16:19], s41 offen offset:0
    buffer_store_dwordx4 v[100:103], v5, s[16:19], s41 offen offset:32
    s_waitcnt lgkmcnt(0)
    v_pk_add_f32 v[88:89], v[88:89], v[160:161]
    v_pk_add_f32 v[90:91], v[90:91], v[162:163]
    v_pk_add_f32 v[88:89], v[88:89], v[164:165]
    v_pk_add_f32 v[90:91], v[90:91], v[166:167]
    v_pk_add_f32 v[88:89], v[88:89], v[168:169]
    v_pk_add_f32 v[90:91], v[90:91], v[170:171]
    v_pk_add_f32 v[88:89], v[88:89], v[172:173]
    v_pk_add_f32 v[90:91], v[90:91], v[174:175]
    v_cvt_pk_bf16_f32 v112, v88, v89
    v_cvt_pk_bf16_f32 v113, v90, v91
    buffer_store_dwordx2 v[112:113], v9, s[16:19], s44 offen
L_end:
    s_endpgm
.section .rodata,"a"
.p2align 6
.amdhsa_kernel parallel_sum__grouped_kv_mqa__glu_gated_swiglu__prompt_kernel
  .amdhsa_next_free_vgpr 256
  .amdhsa_next_free_sgpr 102
  .amdhsa_accum_offset 256
  .amdhsa_group_segment_fixed_size 0
  .amdhsa_kernarg_size 96
  .amdhsa_user_sgpr_count 2
  .amdhsa_user_sgpr_kernarg_segment_ptr 1
  .amdhsa_system_sgpr_workgroup_id_x 1
.end_amdhsa_kernel
.text
```
